```python
import torch

def _softmax(x, axis=-1):
    return torch.softmax(x, dim=axis)
def _gelu(x):
    return torch.nn.functional.gelu(x, approximate="tanh")
def _silu(x):
    return torch.nn.functional.silu(x)
def _sigmoid(x):
    return torch.sigmoid(x)
def _layernorm(x, axis=-1, eps=1e-5):
    m = x.mean(dim=axis, keepdim=True)
    v = x.var(dim=axis, keepdim=True, unbiased=False)
    return (x - m) / torch.sqrt(v + eps)
def _scatter_add(tgt, idx, src, axis=0):
    return tgt.clone().index_add_(axis, idx, src)
def _segment_sum(src, seg, n):
    out = torch.zeros((n,) + src.shape[1:], dtype=src.dtype)
    return out.index_add_(0, seg, src)
def _pad(x, pw):
    flat = tuple(v for pair in reversed(pw) for v in pair)
    return torch.nn.functional.pad(x, flat)

kernel_name = 'gather_scatter__hybrid_graph_tf_graphgps__graph'

def setup_inputs():

    _w = (lambda a: (lambda t: t.to(torch.bfloat16) if t.is_floating_point() else t)(torch.as_tensor(a)))
    N, deg, D = 10000, 16, 128
    E = N * deg
    src = (lambda lo, hi, *s: torch.randint(lo, hi, s))(0, N, E).to(torch.int64)
    dst = (lambda lo, hi, *s: torch.randint(lo, hi, s))(0, N, E).to(torch.int64)
    deg_cnt = torch.bincount(dst, minlength=N).to(float) + 1.0
    sc = 1.0 / float(D) ** 0.5
    return {
        "x": _w((lambda *s: torch.randn(*s, dtype=torch.bfloat16) * 0.05)(N, D)),
        "src": _w(src),
        "dst": _w(dst),
        "deg_inv": _w((1.0 / deg_cnt).to(float)),
        "w_msg": _w((lambda *s: torch.randn(*s, dtype=torch.bfloat16) * 0.2)(D, D) * sc),
        "wq": _w((lambda *s: torch.randn(*s, dtype=torch.bfloat16) * 1.6)(D, D) * sc),
        "wk": _w((lambda *s: torch.randn(*s, dtype=torch.bfloat16) * 1.6)(D, D) * sc),
        "wv": _w((lambda *s: torch.randn(*s, dtype=torch.bfloat16) * 0.2)(D, D) * sc),
        "w_out": _w((lambda *s: torch.randn(*s, dtype=torch.bfloat16) * 0.2)(D, D) * sc),
    }

def reference(x, src, dst, deg_inv, w_msg, wq, wk, wv, w_out):
    N, D = x.shape[0], x.shape[1]
    h = _layernorm(x, axis=-1)
    m_e = torch.einsum('nd,de->ne', h, w_msg)
    h_local = _segment_sum(m_e[src], dst, N) * deg_inv[:, None]
    q = torch.einsum('nd,de->ne', h, wq)
    k = torch.einsum('nd,de->ne', h, wk)
    v = torch.einsum('nd,de->ne', h, wv)
    logits = torch.einsum('id,jd->ij', q, k) / (float(D) ** 0.5)
    attn = _softmax(logits, axis=-1)
    h_global = torch.einsum('ij,jd->id', attn, v)
    y = torch.einsum('nd,de->ne', h_local + h_global, w_out)
    return x + y
```

```asm
; @launch grid=(256,1,1) block=(256,1,1) lds=155648
.amdgcn_target "amdgcn-amd-amdhsa--gfx950"
.text
.globl gather_scatter__hybrid_graph_tf_graphgps__graph_kernel
.p2align 8
.type gather_scatter__hybrid_graph_tf_graphgps__graph_kernel,@function
gather_scatter__hybrid_graph_tf_graphgps__graph_kernel:
    s_cmp_ge_u32 s2, 256
    s_cbranch_scc1 L_k2_end
    s_load_dwordx2 s[4:5], s[0:1], 88
    s_load_dwordx2 s[72:73], s[0:1], 0
    s_load_dwordx2 s[24:25], s[0:1], 40
    s_load_dwordx2 s[28:29], s[0:1], 48
    s_load_dwordx2 s[58:59], s[0:1], 72
    s_load_dwordx2 s[96:97], s[0:1], 80
    s_load_dwordx2 s[100:101], s[0:1], 24
    v_lshrrev_b32 v1, 6, v0
    v_and_b32 v0, 63, v0
    v_readfirstlane_b32 s20, v1
    s_and_b32 s21, s2, 7
    s_lshl_b32 s21, s21, 2
    s_lshr_b32 s22, s2, 6
    s_add_u32 s21, s21, s22
    s_bfe_u32 s22, s2, 0x30003
    s_mul_i32 s23, s21, 20
    s_mul_i32 s33, s20, 5
    s_sub_u32 s35, s22, s33
    s_and_b32 s35, s35, 7
    s_cmp_lt_u32 s35, 5
    s_cselect_b32 s57, 1, 0
    s_cselect_b32 s35, s35, 4
    s_add_u32 s33, s33, s23
    s_cmp_lt_u32 s33, 625
    s_cselect_b32 s57, s57, 0
    s_add_u32 s36, s35, s33
    s_lshl_b32 s56, s36, 12
    s_sub_u32 s36, 625, s23
    s_min_u32 s39, s36, 20
    v_lshlrev_b32 v1, 4, v0
    v_and_b32 v3, 15, v0
    v_lshrrev_b32 v4, 4, v0
    v_lshlrev_b32 v5, 8, v3
    v_lshl_add_u32 v5, v4, 4, v5
    v_lshlrev_b32 v6, 1, v4
    v_xor_b32 v6, v6, v3
    v_lshlrev_b32 v6, 4, v6
    v_lshl_add_u32 v6, v4, 8, v6
    v_xor_b32 v2, 128, v6
    s_lshl_b32 s49, s20, 13
    s_add_u32 s50, s49, 4096
    s_lshl_b32 s6, s21, 3
    s_add_u32 s6, s6, s22
    s_mov_b32 s74, 2560000
    s_mov_b32 s75, 0x20000
    s_mov_b32 s26, 32768
    s_mov_b32 s27, 0x20000
    s_mov_b32 s30, 32768
    s_mov_b32 s31, 0x20000
    s_mov_b32 s98, 256
    s_mov_b32 s99, 0x20000
    s_cmp_eq_u32 s57, 1
    s_cbranch_scc0 L_km_free
    s_mov_b32 s7, 1
    s_waitcnt lgkmcnt(0)
    buffer_load_dwordx4 v[16:19], v5, s[72:75], s56 offen offset:0
    buffer_load_dwordx4 v[20:23], v5, s[72:75], s56 offen offset:64
    buffer_load_dwordx4 v[24:27], v5, s[72:75], s56 offen offset:128
    buffer_load_dwordx4 v[28:31], v5, s[72:75], s56 offen offset:192
    s_add_u32 m0, s49, 90112
    s_nop 0
    buffer_load_dwordx4 v6, s[24:27], s49 offen offset:0 lds
    buffer_load_dwordx4 v6, s[24:27], s49 offen offset:1024 lds
    buffer_load_dwordx4 v2, s[24:27], s49 offen offset:2048 lds
    buffer_load_dwordx4 v2, s[24:27], s49 offen offset:3072 lds
    s_add_u32 m0, s50, 90112
    s_nop 0
    buffer_load_dwordx4 v6, s[24:27], s50 offen offset:0 lds
    buffer_load_dwordx4 v6, s[24:27], s50 offen offset:1024 lds
    buffer_load_dwordx4 v2, s[24:27], s50 offen offset:2048 lds
    buffer_load_dwordx4 v2, s[24:27], s50 offen offset:3072 lds
    v_xor_b32 v7, v3, v4
    v_lshlrev_b32 v7, 4, v7
    v_lshl_add_u32 v7, v4, 8, v7
    v_xor_b32 v8, 64, v7
    v_xor_b32 v9, 128, v7
    v_xor_b32 v10, 192, v7
    s_mul_i32 s46, s20, 6144
    v_add_u32 v232, s46, v1
    s_mul_i32 s45, s22, 319488
    s_cmp_eq_u32 s35, 0
    s_cselect_b32 s36, 4, 0
    s_add_u32 s36, s36, s33
    s_lshl_b32 s52, s36, 12
    s_cmp_eq_u32 s35, 1
    s_cselect_b32 s36, 4, 1
    s_add_u32 s36, s36, s33
    s_lshl_b32 s53, s36, 12
    s_cmp_eq_u32 s35, 2
    s_cselect_b32 s36, 4, 2
    s_add_u32 s36, s36, s33
    s_lshl_b32 s54, s36, 12
    s_cmp_eq_u32 s35, 3
    s_cselect_b32 s36, 4, 3
    s_add_u32 s36, s36, s33
    s_lshl_b32 s55, s36, 12
    s_lshr_b32 s3, s22, 1
    s_lshl_b32 s32, s6, 2
    s_add_u32 s32, s32, s20
    s_getreg_b32 s44, hwreg(HW_REG_XCC_ID, 0, 16)
    v_lshlrev_b32 v11, 7, v0
    v_cmp_gt_u32 vcc, 20, v0
    s_mul_i32 s36, s22, 2560
    s_lshl_b32 s38, s33, 12
    s_add_u32 s51, s36, s38
    v_mov_b32 v12, 0x10000000
    v_cndmask_b32 v240, v12, v11, vcc
    s_mov_b32 s8, s4
    s_mov_b32 s9, s5
    s_mov_b32 s10, 0x271000
    s_mov_b32 s11, 0x20000
    s_add_u32 s12, s4, 0x280000
    s_addc_u32 s13, s5, 0
    s_mov_b32 s14, 0x271000
    s_mov_b32 s15, 0x20000
    s_add_u32 s16, s4, 0x1a00000
    s_addc_u32 s17, s5, 0
    s_mov_b32 s18, 0x2c000
    s_mov_b32 s19, 0x20000
    s_mov_b32 s76, s58
    s_mov_b32 s77, s59
    s_mov_b32 s78, 0x271000
    s_mov_b32 s79, 0x20000
    v_mov_b32 v252, 0
    v_mov_b32 v253, 0
    v_mov_b32 v254, 0
    v_mov_b32 v255, 0
    s_mov_b32 s38, 0
    v_and_b32 v244, 15, v0
    v_lshrrev_b32 v245, 4, v0
    v_lshrrev_b32 v250, 3, v244
    v_and_b32 v251, 7, v244
    v_lshlrev_b32 v251, 1, v251
    v_or_b32 v246, v251, v250
    v_lshlrev_b32 v250, 3, v250
    v_xor_b32 v246, v246, v250
    v_xor_b32 v246, v246, v245
    v_xor_b32 v247, 0, v246
    v_lshlrev_b32 v247, 4, v247
    v_lshl_add_u32 v220, v244, 8, v247
    v_add_u32 v220, s38, v220
    v_xor_b32 v247, 4, v246
    v_lshlrev_b32 v247, 4, v247
    v_lshl_add_u32 v221, v244, 8, v247
    v_add_u32 v221, s38, v221
    v_xor_b32 v247, 8, v246
    v_lshlrev_b32 v247, 4, v247
    v_lshl_add_u32 v222, v244, 8, v247
    v_add_u32 v222, s38, v222
    v_xor_b32 v247, 12, v246
    v_lshlrev_b32 v247, 4, v247
    v_lshl_add_u32 v223, v244, 8, v247
    v_add_u32 v223, s38, v223
    v_lshrrev_b32 v247, 2, v244
    v_lshl_add_u32 v247, v245, 2, v247
    v_lshrrev_b32 v250, 3, v247
    v_and_b32 v251, 7, v247
    v_lshlrev_b32 v251, 1, v251
    v_or_b32 v246, v251, v250
    v_lshlrev_b32 v250, 3, v250
    v_xor_b32 v246, v246, v250
    v_bfe_u32 v248, v0, 1, 1
    v_xor_b32 v246, v246, v248
    v_and_b32 v248, 1, v0
    v_lshlrev_b32 v248, 3, v248
    v_lshl_add_u32 v248, v247, 8, v248
    v_add_u32 v248, s38, v248
    v_xor_b32 v249, 0, v246
    v_lshl_add_u32 v224, v249, 4, v248
    v_xor_b32 v249, 2, v246
    v_lshl_add_u32 v225, v249, 4, v248
    v_xor_b32 v249, 4, v246
    v_lshl_add_u32 v226, v249, 4, v248
    v_xor_b32 v249, 6, v246
    v_lshl_add_u32 v227, v249, 4, v248
    v_xor_b32 v249, 8, v246
    v_lshl_add_u32 v228, v249, 4, v248
    v_xor_b32 v249, 10, v246
    v_lshl_add_u32 v229, v249, 4, v248
    v_xor_b32 v249, 12, v246
    v_lshl_add_u32 v230, v249, 4, v248
    v_xor_b32 v249, 14, v246
    v_lshl_add_u32 v231, v249, 4, v248
    v_mfma_f32_32x32x16_bf16 a[0:15], v[252:255], v[252:255], 0
    v_mfma_f32_32x32x16_bf16 a[16:31], v[252:255], v[252:255], 0
    v_mfma_f32_32x32x16_bf16 a[32:47], v[252:255], v[252:255], 0
    v_mfma_f32_32x32x16_bf16 a[48:63], v[252:255], v[252:255], 0
    v_mfma_f32_32x32x16_bf16 a[64:79], v[252:255], v[252:255], 0
    v_mfma_f32_32x32x16_bf16 a[80:95], v[252:255], v[252:255], 0
    v_mfma_f32_32x32x16_bf16 a[96:111], v[252:255], v[252:255], 0
    v_mfma_f32_32x32x16_bf16 a[112:127], v[252:255], v[252:255], 0
    v_mfma_f32_32x32x16_bf16 a[128:143], v[252:255], v[252:255], 0
    v_mfma_f32_32x32x16_bf16 a[144:159], v[252:255], v[252:255], 0
    v_bfe_u32 v32, v3, 3, 1
    v_mul_u32_u24 v32, 9, v32
    v_and_b32 v11, 7, v3
    v_lshlrev_b32 v11, 1, v11
    v_xor_b32 v11, v11, v32
    v_xor_b32 v11, v11, v4
    v_lshlrev_b32 v11, 4, v11
    v_lshl_add_u32 v44, v3, 8, v11
    v_xor_b32 v36, 0, v44
    v_xor_b32 v37, 64, v44
    v_xor_b32 v38, 128, v44
    v_xor_b32 v39, 192, v44
    v_lshrrev_b32 v40, 2, v3
    v_and_b32 v41, 3, v3
    v_and_b32 v42, 1, v4
    v_lshlrev_b32 v42, 2, v42
    v_or_b32 v42, v42, v40
    v_lshlrev_b32 v42, 1, v42
    v_lshrrev_b32 v43, 1, v41
    v_xor_b32 v42, v42, v43
    v_lshlrev_b32 v42, 4, v42
    v_and_b32 v43, 1, v41
    v_lshl_add_u32 v42, v43, 3, v42
    v_add_u32 v42, 90112, v42
    v_lshl_add_u32 v43, v4, 3, v40
    v_lshl_add_u32 v192, v43, 8, v42
    v_xor_b32 v193, 32, v192
    v_xor_b32 v194, 64, v192
    v_xor_b32 v195, 96, v192
    v_xor_b32 v196, 128, v192
    v_xor_b32 v197, 160, v192
    v_xor_b32 v198, 192, v192
    v_xor_b32 v199, 224, v192
    v_lshl_add_u32 v43, v40, 3, v41
    v_lshrrev_b32 v42, 1, v4
    v_xor_b32 v42, v3, v42
    v_lshlrev_b32 v42, 4, v42
    v_and_b32 v40, 1, v4
    v_lshl_add_u32 v42, v40, 3, v42
    v_add_u32 v42, 90112, v42
    v_lshl_add_u32 v200, v43, 8, v42
    v_xor_b32 v201, 32, v200
    v_xor_b32 v202, 64, v200
    v_xor_b32 v203, 96, v200
    v_xor_b32 v204, 128, v200
    v_xor_b32 v205, 160, v200
    v_xor_b32 v206, 192, v200
    v_xor_b32 v207, 224, v200
    v_mov_b32 v32, 0x3f803f80
    v_mov_b32 v33, 0x3f803f80
    v_mov_b32 v34, 0x3f803f80
    v_mov_b32 v35, 0x3f803f80
    s_mov_b32 s60, 0
    s_mov_b32 s61, 0xffff0000
    s_mov_b32 s62, 0x3c000000
    s_mov_b32 s63, 0x3727c5ac
    s_mov_b32 s64, 0x3dc69217
    s_waitcnt vmcnt(8)
    v_mfma_f32_16x16x32_bf16 v[44:47], v[32:35], v[16:19], 0
    v_mfma_f32_16x16x32_bf16 v[44:47], v[32:35], v[20:23], v[44:47]
    v_mfma_f32_16x16x32_bf16 v[44:47], v[32:35], v[24:27], v[44:47]
    v_mfma_f32_16x16x32_bf16 v[44:47], v[32:35], v[28:31], v[44:47]
    v_lshlrev_b32 v48, 16, v16
    v_and_b32 v49, s61, v16
    v_lshlrev_b32 v50, 16, v17
    v_and_b32 v51, s61, v17
    s_add_u32 m0, s49, 122880
    s_nop 0
    buffer_load_dwordx4 v7, s[28:31], s49 offen offset:0 lds
    v_lshlrev_b32 v52, 16, v18
    v_and_b32 v53, s61, v18
    v_lshlrev_b32 v54, 16, v19
    v_and_b32 v55, s61, v19
    buffer_load_dwordx4 v7, s[28:31], s49 offen offset:1024 lds
    v_lshlrev_b32 v56, 16, v20
    v_and_b32 v57, s61, v20
    v_lshlrev_b32 v58, 16, v21
    v_and_b32 v59, s61, v21
    buffer_load_dwordx4 v8, s[28:31], s49 offen offset:2048 lds
    v_lshlrev_b32 v60, 16, v22
    v_and_b32 v61, s61, v22
    v_lshlrev_b32 v62, 16, v23
    v_and_b32 v63, s61, v23
    buffer_load_dwordx4 v8, s[28:31], s49 offen offset:3072 lds
    v_lshlrev_b32 v64, 16, v24
    v_and_b32 v65, s61, v24
    v_lshlrev_b32 v66, 16, v25
    v_and_b32 v67, s61, v25
    s_add_u32 m0, s50, 122880
    s_nop 0
    buffer_load_dwordx4 v9, s[28:31], s50 offen offset:0 lds
    v_lshlrev_b32 v68, 16, v26
    v_and_b32 v69, s61, v26
    v_lshlrev_b32 v70, 16, v27
    v_and_b32 v71, s61, v27
    buffer_load_dwordx4 v9, s[28:31], s50 offen offset:1024 lds
    v_lshlrev_b32 v72, 16, v28
    v_and_b32 v73, s61, v28
    v_lshlrev_b32 v74, 16, v29
    v_and_b32 v75, s61, v29
    buffer_load_dwordx4 v10, s[28:31], s50 offen offset:2048 lds
    v_lshlrev_b32 v76, 16, v30
    v_and_b32 v77, s61, v30
    v_lshlrev_b32 v78, 16, v31
    v_and_b32 v79, s61, v31
    buffer_load_dwordx4 v10, s[28:31], s50 offen offset:3072 lds
    v_mul_f32 v44, s62, v44
    v_pk_add_f32 v[48:49], v[48:49], v[44:45] op_sel_hi:[1,0] neg_lo:[0,1] neg_hi:[0,1]
    v_pk_add_f32 v[50:51], v[50:51], v[44:45] op_sel_hi:[1,0] neg_lo:[0,1] neg_hi:[0,1]
    v_pk_add_f32 v[52:53], v[52:53], v[44:45] op_sel_hi:[1,0] neg_lo:[0,1] neg_hi:[0,1]
    v_pk_add_f32 v[54:55], v[54:55], v[44:45] op_sel_hi:[1,0] neg_lo:[0,1] neg_hi:[0,1]
    v_pk_add_f32 v[56:57], v[56:57], v[44:45] op_sel_hi:[1,0] neg_lo:[0,1] neg_hi:[0,1]
    v_pk_add_f32 v[58:59], v[58:59], v[44:45] op_sel_hi:[1,0] neg_lo:[0,1] neg_hi:[0,1]
    v_pk_add_f32 v[60:61], v[60:61], v[44:45] op_sel_hi:[1,0] neg_lo:[0,1] neg_hi:[0,1]
    v_pk_add_f32 v[62:63], v[62:63], v[44:45] op_sel_hi:[1,0] neg_lo:[0,1] neg_hi:[0,1]
    v_pk_add_f32 v[64:65], v[64:65], v[44:45] op_sel_hi:[1,0] neg_lo:[0,1] neg_hi:[0,1]
    v_pk_add_f32 v[66:67], v[66:67], v[44:45] op_sel_hi:[1,0] neg_lo:[0,1] neg_hi:[0,1]
    v_pk_add_f32 v[68:69], v[68:69], v[44:45] op_sel_hi:[1,0] neg_lo:[0,1] neg_hi:[0,1]
    v_pk_add_f32 v[70:71], v[70:71], v[44:45] op_sel_hi:[1,0] neg_lo:[0,1] neg_hi:[0,1]
    v_pk_add_f32 v[72:73], v[72:73], v[44:45] op_sel_hi:[1,0] neg_lo:[0,1] neg_hi:[0,1]
    v_pk_add_f32 v[74:75], v[74:75], v[44:45] op_sel_hi:[1,0] neg_lo:[0,1] neg_hi:[0,1]
    v_pk_add_f32 v[76:77], v[76:77], v[44:45] op_sel_hi:[1,0] neg_lo:[0,1] neg_hi:[0,1]
    v_pk_add_f32 v[78:79], v[78:79], v[44:45] op_sel_hi:[1,0] neg_lo:[0,1] neg_hi:[0,1]
    v_pk_mul_f32 v[44:45], v[48:49], v[48:49]
    v_pk_mul_f32 v[46:47], v[50:51], v[50:51]
    v_pk_fma_f32 v[44:45], v[52:53], v[52:53], v[44:45]
    v_pk_fma_f32 v[46:47], v[54:55], v[54:55], v[46:47]
    v_pk_fma_f32 v[44:45], v[56:57], v[56:57], v[44:45]
    v_pk_fma_f32 v[46:47], v[58:59], v[58:59], v[46:47]
    v_pk_fma_f32 v[44:45], v[60:61], v[60:61], v[44:45]
    v_pk_fma_f32 v[46:47], v[62:63], v[62:63], v[46:47]
    v_pk_fma_f32 v[44:45], v[64:65], v[64:65], v[44:45]
    v_pk_fma_f32 v[46:47], v[66:67], v[66:67], v[46:47]
    v_pk_fma_f32 v[44:45], v[68:69], v[68:69], v[44:45]
    v_pk_fma_f32 v[46:47], v[70:71], v[70:71], v[46:47]
    v_pk_fma_f32 v[44:45], v[72:73], v[72:73], v[44:45]
    v_pk_fma_f32 v[46:47], v[74:75], v[74:75], v[46:47]
    v_pk_fma_f32 v[44:45], v[76:77], v[76:77], v[44:45]
    v_pk_fma_f32 v[46:47], v[78:79], v[78:79], v[46:47]
    v_pk_add_f32 v[44:45], v[44:45], v[46:47]
    v_add_f32 v44, v44, v45
    v_mov_b32 v45, v44
    s_nop 1
    v_permlane32_swap_b32 v44, v45
    v_add_f32 v44, v44, v45
    v_mov_b32 v45, v44
    s_nop 1
    v_permlane16_swap_b32 v44, v45
    v_add_f32 v44, v44, v45
    v_mov_b32 v45, s63
    v_fma_f32 v44, v44, s62, v45
    v_rsq_f32 v44, v44
    s_nop 0
    v_pk_mul_f32 v[48:49], v[48:49], v[44:45] op_sel_hi:[1,0]
    v_pk_mul_f32 v[50:51], v[50:51], v[44:45] op_sel_hi:[1,0]
    v_pk_mul_f32 v[52:53], v[52:53], v[44:45] op_sel_hi:[1,0]
    v_pk_mul_f32 v[54:55], v[54:55], v[44:45] op_sel_hi:[1,0]
    v_pk_mul_f32 v[56:57], v[56:57], v[44:45] op_sel_hi:[1,0]
    v_pk_mul_f32 v[58:59], v[58:59], v[44:45] op_sel_hi:[1,0]
    v_pk_mul_f32 v[60:61], v[60:61], v[44:45] op_sel_hi:[1,0]
    v_pk_mul_f32 v[62:63], v[62:63], v[44:45] op_sel_hi:[1,0]
    v_pk_mul_f32 v[64:65], v[64:65], v[44:45] op_sel_hi:[1,0]
    v_pk_mul_f32 v[66:67], v[66:67], v[44:45] op_sel_hi:[1,0]
    v_pk_mul_f32 v[68:69], v[68:69], v[44:45] op_sel_hi:[1,0]
    v_pk_mul_f32 v[70:71], v[70:71], v[44:45] op_sel_hi:[1,0]
    v_pk_mul_f32 v[72:73], v[72:73], v[44:45] op_sel_hi:[1,0]
    v_pk_mul_f32 v[74:75], v[74:75], v[44:45] op_sel_hi:[1,0]
    v_pk_mul_f32 v[76:77], v[76:77], v[44:45] op_sel_hi:[1,0]
    v_pk_mul_f32 v[78:79], v[78:79], v[44:45] op_sel_hi:[1,0]
    v_mov_b32 v45, v79
    v_mov_b32 v44, v79
    s_nop 1
    v_permlane32_swap_b32 v45, v44
    v_mov_b32 v45, v44
    s_nop 1
    v_permlane16_swap_b32 v45, v44
    v_cvt_pk_bf16_f32 v80, v48, v49
    v_cvt_pk_bf16_f32 v81, v50, v51
    v_cvt_pk_bf16_f32 v82, v52, v53
    v_cvt_pk_bf16_f32 v83, v54, v55
    v_cvt_pk_bf16_f32 v84, v56, v57
    v_cvt_pk_bf16_f32 v85, v58, v59
    v_cvt_pk_bf16_f32 v86, v60, v61
    v_cvt_pk_bf16_f32 v87, v62, v63
    v_cvt_pk_bf16_f32 v88, v64, v65
    v_cvt_pk_bf16_f32 v89, v66, v67
    v_cvt_pk_bf16_f32 v90, v68, v69
    v_cvt_pk_bf16_f32 v91, v70, v71
    v_cvt_pk_bf16_f32 v92, v72, v73
    v_cvt_pk_bf16_f32 v93, v74, v75
    v_cvt_pk_bf16_f32 v94, v76, v77
    v_cvt_pk_bf16_f32 v95, v78, v79
    v_mul_f32 v44, s64, v44
    v_pk_add_f32 v[48:49], v[48:49], v[44:45] op_sel_hi:[1,0]
    v_pk_add_f32 v[50:51], v[50:51], v[44:45] op_sel_hi:[1,0]
    v_pk_add_f32 v[52:53], v[52:53], v[44:45] op_sel_hi:[1,0]
    v_pk_add_f32 v[54:55], v[54:55], v[44:45] op_sel_hi:[1,0]
    v_pk_add_f32 v[56:57], v[56:57], v[44:45] op_sel_hi:[1,0]
    v_pk_add_f32 v[58:59], v[58:59], v[44:45] op_sel_hi:[1,0]
    v_pk_add_f32 v[60:61], v[60:61], v[44:45] op_sel_hi:[1,0]
    v_pk_add_f32 v[62:63], v[62:63], v[44:45] op_sel_hi:[1,0]
    v_pk_add_f32 v[64:65], v[64:65], v[44:45] op_sel_hi:[1,0]
    v_pk_add_f32 v[66:67], v[66:67], v[44:45] op_sel_hi:[1,0]
    v_pk_add_f32 v[68:69], v[68:69], v[44:45] op_sel_hi:[1,0]
    v_pk_add_f32 v[70:71], v[70:71], v[44:45] op_sel_hi:[1,0]
    v_pk_add_f32 v[72:73], v[72:73], v[44:45] op_sel_hi:[1,0]
    v_pk_add_f32 v[74:75], v[74:75], v[44:45] op_sel_hi:[1,0]
    v_pk_add_f32 v[76:77], v[76:77], v[44:45] op_sel_hi:[1,0]
    v_pk_add_f32 v[78:79], v[78:79], v[44:45] op_sel_hi:[1,0]
    v_cndmask_b32 v79, v79, 1.0, s[60:61]
    v_cvt_pk_bf16_f32 v96, v48, v49
    v_cvt_pk_bf16_f32 v97, v50, v51
    v_cvt_pk_bf16_f32 v98, v52, v53
    v_cvt_pk_bf16_f32 v99, v54, v55
    v_cvt_pk_bf16_f32 v100, v56, v57
    v_cvt_pk_bf16_f32 v101, v58, v59
    v_cvt_pk_bf16_f32 v102, v60, v61
    v_cvt_pk_bf16_f32 v103, v62, v63
    v_cvt_pk_bf16_f32 v104, v64, v65
    v_cvt_pk_bf16_f32 v105, v66, v67
    v_cvt_pk_bf16_f32 v106, v68, v69
    v_cvt_pk_bf16_f32 v107, v70, v71
    v_cvt_pk_bf16_f32 v108, v72, v73
    v_cvt_pk_bf16_f32 v109, v74, v75
    v_cvt_pk_bf16_f32 v110, v76, v77
    v_cvt_pk_bf16_f32 v111, v78, v79
    buffer_store_dwordx4 v[96:99], v36, s[8:11], s56 offen sc1
    buffer_store_dwordx4 v[100:103], v37, s[8:11], s56 offen sc1
    buffer_store_dwordx4 v[104:107], v38, s[8:11], s56 offen sc1
    buffer_store_dwordx4 v[108:111], v39, s[8:11], s56 offen sc1
    v_mov_b32 v254, 89088
    s_waitcnt vmcnt(12) lgkmcnt(0)
    s_barrier
    buffer_load_dword v241, v240, s[12:15], s51 offen
    ds_read_b64_tr_b16 v[112:113], v192 offset:0
    ds_read_b64_tr_b16 v[114:115], v192 offset:1024
    ds_read_b64_tr_b16 v[116:117], v192 offset:8192
    ds_read_b64_tr_b16 v[118:119], v192 offset:9216
    ds_read_b64_tr_b16 v[120:121], v192 offset:16384
    ds_read_b64_tr_b16 v[122:123], v192 offset:17408
    ds_read_b64_tr_b16 v[124:125], v192 offset:24576
    ds_read_b64_tr_b16 v[126:127], v192 offset:25600
    ds_read_b64_tr_b16 v[128:129], v193 offset:0
    ds_read_b64_tr_b16 v[130:131], v193 offset:1024
    ds_read_b64_tr_b16 v[132:133], v193 offset:8192
    ds_read_b64_tr_b16 v[134:135], v193 offset:9216
    ds_read_b64_tr_b16 v[136:137], v193 offset:16384
    ds_read_b64_tr_b16 v[138:139], v193 offset:17408
    ds_read_b64_tr_b16 v[140:141], v193 offset:24576
    ds_read_b64_tr_b16 v[142:143], v193 offset:25600
    s_waitcnt lgkmcnt(8)
    v_mfma_f32_16x16x32_bf16 v[160:163], v[112:115], v[80:83], 0
    ds_read_b64_tr_b16 v[144:145], v194 offset:0
    ds_read_b64_tr_b16 v[146:147], v194 offset:1024
    v_mfma_f32_16x16x32_bf16 v[160:163], v[116:119], v[84:87], v[160:163]
    ds_read_b64_tr_b16 v[148:149], v194 offset:8192
    ds_read_b64_tr_b16 v[150:151], v194 offset:9216
    v_mfma_f32_16x16x32_bf16 v[160:163], v[120:123], v[88:91], v[160:163]
    ds_read_b64_tr_b16 v[152:153], v194 offset:16384
    ds_read_b64_tr_b16 v[154:155], v194 offset:17408
    v_mfma_f32_16x16x32_bf16 v[160:163], v[124:127], v[92:95], v[160:163]
    ds_read_b64_tr_b16 v[156:157], v194 offset:24576
    ds_read_b64_tr_b16 v[158:159], v194 offset:25600
    s_waitcnt lgkmcnt(8)
    v_mfma_f32_16x16x32_bf16 v[164:167], v[128:131], v[80:83], 0
    ds_read_b64_tr_b16 v[112:113], v195 offset:0
    ds_read_b64_tr_b16 v[114:115], v195 offset:1024
    v_mfma_f32_16x16x32_bf16 v[164:167], v[132:135], v[84:87], v[164:167]
    ds_read_b64_tr_b16 v[116:117], v195 offset:8192
    ds_read_b64_tr_b16 v[118:119], v195 offset:9216
    v_mfma_f32_16x16x32_bf16 v[164:167], v[136:139], v[88:91], v[164:167]
    ds_read_b64_tr_b16 v[120:121], v195 offset:16384
    ds_read_b64_tr_b16 v[122:123], v195 offset:17408
    v_mfma_f32_16x16x32_bf16 v[164:167], v[140:143], v[92:95], v[164:167]
    ds_read_b64_tr_b16 v[124:125], v195 offset:24576
    ds_read_b64_tr_b16 v[126:127], v195 offset:25600
    s_waitcnt lgkmcnt(8)
    v_mfma_f32_16x16x32_bf16 v[168:171], v[144:147], v[80:83], 0
    ds_read_b64_tr_b16 v[128:129], v196 offset:0
    ds_read_b64_tr_b16 v[130:131], v196 offset:1024
    v_mfma_f32_16x16x32_bf16 v[168:171], v[148:151], v[84:87], v[168:171]
    ds_read_b64_tr_b16 v[132:133], v196 offset:8192
    ds_read_b64_tr_b16 v[134:135], v196 offset:9216
    v_mfma_f32_16x16x32_bf16 v[168:171], v[152:155], v[88:91], v[168:171]
    ds_read_b64_tr_b16 v[136:137], v196 offset:16384
    ds_read_b64_tr_b16 v[138:139], v196 offset:17408
    v_mfma_f32_16x16x32_bf16 v[168:171], v[156:159], v[92:95], v[168:171]
    ds_read_b64_tr_b16 v[140:141], v196 offset:24576
    ds_read_b64_tr_b16 v[142:143], v196 offset:25600
    s_waitcnt lgkmcnt(8)
    v_mfma_f32_16x16x32_bf16 v[172:175], v[112:115], v[80:83], 0
    ds_read_b64_tr_b16 v[144:145], v197 offset:0
    ds_read_b64_tr_b16 v[146:147], v197 offset:1024
    v_mfma_f32_16x16x32_bf16 v[172:175], v[116:119], v[84:87], v[172:175]
    ds_read_b64_tr_b16 v[148:149], v197 offset:8192
    ds_read_b64_tr_b16 v[150:151], v197 offset:9216
    v_mfma_f32_16x16x32_bf16 v[172:175], v[120:123], v[88:91], v[172:175]
    ds_read_b64_tr_b16 v[152:153], v197 offset:16384
    ds_read_b64_tr_b16 v[154:155], v197 offset:17408
    v_mfma_f32_16x16x32_bf16 v[172:175], v[124:127], v[92:95], v[172:175]
    ds_read_b64_tr_b16 v[156:157], v197 offset:24576
    ds_read_b64_tr_b16 v[158:159], v197 offset:25600
    s_waitcnt lgkmcnt(8)
    v_mfma_f32_16x16x32_bf16 v[176:179], v[128:131], v[80:83], 0
    ds_read_b64_tr_b16 v[112:113], v198 offset:0
    ds_read_b64_tr_b16 v[114:115], v198 offset:1024
    v_mfma_f32_16x16x32_bf16 v[176:179], v[132:135], v[84:87], v[176:179]
    ds_read_b64_tr_b16 v[116:117], v198 offset:8192
    ds_read_b64_tr_b16 v[118:119], v198 offset:9216
    v_mfma_f32_16x16x32_bf16 v[176:179], v[136:139], v[88:91], v[176:179]
    ds_read_b64_tr_b16 v[120:121], v198 offset:16384
    ds_read_b64_tr_b16 v[122:123], v198 offset:17408
    v_mfma_f32_16x16x32_bf16 v[176:179], v[140:143], v[92:95], v[176:179]
    ds_read_b64_tr_b16 v[124:125], v198 offset:24576
    ds_read_b64_tr_b16 v[126:127], v198 offset:25600
    s_waitcnt lgkmcnt(8)
    v_mfma_f32_16x16x32_bf16 v[180:183], v[144:147], v[80:83], 0
    ds_read_b64_tr_b16 v[128:129], v199 offset:0
    ds_read_b64_tr_b16 v[130:131], v199 offset:1024
    v_mfma_f32_16x16x32_bf16 v[180:183], v[148:151], v[84:87], v[180:183]
    ds_read_b64_tr_b16 v[132:133], v199 offset:8192
    ds_read_b64_tr_b16 v[134:135], v199 offset:9216
    v_mfma_f32_16x16x32_bf16 v[180:183], v[152:155], v[88:91], v[180:183]
    ds_read_b64_tr_b16 v[136:137], v199 offset:16384
    ds_read_b64_tr_b16 v[138:139], v199 offset:17408
    v_mfma_f32_16x16x32_bf16 v[180:183], v[156:159], v[92:95], v[180:183]
    ds_read_b64_tr_b16 v[140:141], v199 offset:24576
    ds_read_b64_tr_b16 v[142:143], v199 offset:25600
    s_waitcnt vmcnt(1)
    s_barrier
    ds_read_b32 v2, v254
    s_waitcnt lgkmcnt(9)
    v_mfma_f32_16x16x32_bf16 v[184:187], v[112:115], v[80:83], 0
    ds_read_b64 v[144:145], v200 offset:32768
    ds_read_b64 v[146:147], v201 offset:32768
    v_mfma_f32_16x16x32_bf16 v[184:187], v[116:119], v[84:87], v[184:187]
    ds_read_b64 v[148:149], v202 offset:32768
    ds_read_b64 v[150:151], v203 offset:32768
    v_mfma_f32_16x16x32_bf16 v[184:187], v[120:123], v[88:91], v[184:187]
    ds_read_b64 v[152:153], v204 offset:32768
    ds_read_b64 v[154:155], v205 offset:32768
    v_mfma_f32_16x16x32_bf16 v[184:187], v[124:127], v[92:95], v[184:187]
    ds_read_b64 v[156:157], v206 offset:32768
    ds_read_b64 v[158:159], v207 offset:32768
    s_waitcnt lgkmcnt(9)
    v_mfma_f32_16x16x32_bf16 v[188:191], v[128:131], v[80:83], 0
    ds_read_b64 v[112:113], v200 offset:33792
    ds_read_b64 v[114:115], v201 offset:33792
    v_mfma_f32_16x16x32_bf16 v[188:191], v[132:135], v[84:87], v[188:191]
    ds_read_b64 v[116:117], v202 offset:33792
    ds_read_b64 v[118:119], v203 offset:33792
    v_mfma_f32_16x16x32_bf16 v[188:191], v[136:139], v[88:91], v[188:191]
    ds_read_b64 v[120:121], v204 offset:33792
    ds_read_b64 v[122:123], v205 offset:33792
    v_mfma_f32_16x16x32_bf16 v[188:191], v[140:143], v[92:95], v[188:191]
    ds_read_b64 v[124:125], v206 offset:33792
    ds_read_b64 v[126:127], v207 offset:33792
    v_cvt_pk_bf16_f32 v16, v160, v161
    v_cvt_pk_bf16_f32 v17, v162, v163
    v_cvt_pk_bf16_f32 v18, v164, v165
    v_cvt_pk_bf16_f32 v19, v166, v167
    v_cvt_pk_bf16_f32 v20, v168, v169
    v_cvt_pk_bf16_f32 v21, v170, v171
    v_cvt_pk_bf16_f32 v22, v172, v173
    v_cvt_pk_bf16_f32 v23, v174, v175
    v_cvt_pk_bf16_f32 v24, v176, v177
    v_cvt_pk_bf16_f32 v25, v178, v179
    v_cvt_pk_bf16_f32 v26, v180, v181
    v_cvt_pk_bf16_f32 v27, v182, v183
    v_cvt_pk_bf16_f32 v28, v184, v185
    v_cvt_pk_bf16_f32 v29, v186, v187
    v_cvt_pk_bf16_f32 v30, v188, v189
    v_cvt_pk_bf16_f32 v31, v190, v191
    s_waitcnt lgkmcnt(15)
    v_readfirstlane_b32 s34, v2
    s_waitcnt lgkmcnt(8)
    v_mfma_f32_16x16x32_bf16 v[48:51], v[144:147], v[16:19], 0
    ds_read_b64 v[128:129], v200 offset:40960
    ds_read_b64 v[130:131], v201 offset:40960
    v_mfma_f32_16x16x32_bf16 v[48:51], v[148:151], v[20:23], v[48:51]
    ds_read_b64 v[132:133], v202 offset:40960
    ds_read_b64 v[134:135], v203 offset:40960
    v_mfma_f32_16x16x32_bf16 v[48:51], v[152:155], v[24:27], v[48:51]
    ds_read_b64 v[136:137], v204 offset:40960
    ds_read_b64 v[138:139], v205 offset:40960
    v_mfma_f32_16x16x32_bf16 v[48:51], v[156:159], v[28:31], v[48:51]
    ds_read_b64 v[140:141], v206 offset:40960
    ds_read_b64 v[142:143], v207 offset:40960
    s_waitcnt lgkmcnt(8)
    v_mfma_f32_16x16x32_bf16 v[52:55], v[112:115], v[16:19], 0
    ds_read_b64 v[144:145], v200 offset:41984
    ds_read_b64 v[146:147], v201 offset:41984
    v_mfma_f32_16x16x32_bf16 v[52:55], v[116:119], v[20:23], v[52:55]
    ds_read_b64 v[148:149], v202 offset:41984
    ds_read_b64 v[150:151], v203 offset:41984
    v_mfma_f32_16x16x32_bf16 v[52:55], v[120:123], v[24:27], v[52:55]
    ds_read_b64 v[152:153], v204 offset:41984
    ds_read_b64 v[154:155], v205 offset:41984
    v_mfma_f32_16x16x32_bf16 v[52:55], v[124:127], v[28:31], v[52:55]
    ds_read_b64 v[156:157], v206 offset:41984
    ds_read_b64 v[158:159], v207 offset:41984
    s_waitcnt lgkmcnt(8)
    v_mfma_f32_16x16x32_bf16 v[56:59], v[128:131], v[16:19], 0
    ds_read_b64 v[112:113], v200 offset:49152
    ds_read_b64 v[114:115], v201 offset:49152
    v_mfma_f32_16x16x32_bf16 v[56:59], v[132:135], v[20:23], v[56:59]
    ds_read_b64 v[116:117], v202 offset:49152
    ds_read_b64 v[118:119], v203 offset:49152
    v_mfma_f32_16x16x32_bf16 v[56:59], v[136:139], v[24:27], v[56:59]
    ds_read_b64 v[120:121], v204 offset:49152
    ds_read_b64 v[122:123], v205 offset:49152
    v_mfma_f32_16x16x32_bf16 v[56:59], v[140:143], v[28:31], v[56:59]
    ds_read_b64 v[124:125], v206 offset:49152
    ds_read_b64 v[126:127], v207 offset:49152
    s_waitcnt lgkmcnt(8)
    v_mfma_f32_16x16x32_bf16 v[60:63], v[144:147], v[16:19], 0
    ds_read_b64 v[128:129], v200 offset:50176
    ds_read_b64 v[130:131], v201 offset:50176
    v_mfma_f32_16x16x32_bf16 v[60:63], v[148:151], v[20:23], v[60:63]
    ds_read_b64 v[132:133], v202 offset:50176
    ds_read_b64 v[134:135], v203 offset:50176
    v_mfma_f32_16x16x32_bf16 v[60:63], v[152:155], v[24:27], v[60:63]
    ds_read_b64 v[136:137], v204 offset:50176
    ds_read_b64 v[138:139], v205 offset:50176
    v_mfma_f32_16x16x32_bf16 v[60:63], v[156:159], v[28:31], v[60:63]
    ds_read_b64 v[140:141], v206 offset:50176
    ds_read_b64 v[142:143], v207 offset:50176
    s_waitcnt lgkmcnt(8)
    v_mfma_f32_16x16x32_bf16 v[64:67], v[112:115], v[16:19], 0
    ds_read_b64 v[144:145], v200 offset:57344
    ds_read_b64 v[146:147], v201 offset:57344
    v_mfma_f32_16x16x32_bf16 v[64:67], v[116:119], v[20:23], v[64:67]
    ds_read_b64 v[148:149], v202 offset:57344
    ds_read_b64 v[150:151], v203 offset:57344
    v_mfma_f32_16x16x32_bf16 v[64:67], v[120:123], v[24:27], v[64:67]
    ds_read_b64 v[152:153], v204 offset:57344
    ds_read_b64 v[154:155], v205 offset:57344
    v_mfma_f32_16x16x32_bf16 v[64:67], v[124:127], v[28:31], v[64:67]
    ds_read_b64 v[156:157], v206 offset:57344
    ds_read_b64 v[158:159], v207 offset:57344
    s_waitcnt lgkmcnt(8)
    v_mfma_f32_16x16x32_bf16 v[68:71], v[128:131], v[16:19], 0
    ds_read_b64 v[112:113], v200 offset:58368
    ds_read_b64 v[114:115], v201 offset:58368
    v_mfma_f32_16x16x32_bf16 v[68:71], v[132:135], v[20:23], v[68:71]
    ds_read_b64 v[116:117], v202 offset:58368
    ds_read_b64 v[118:119], v203 offset:58368
    v_mfma_f32_16x16x32_bf16 v[68:71], v[136:139], v[24:27], v[68:71]
    ds_read_b64 v[120:121], v204 offset:58368
    ds_read_b64 v[122:123], v205 offset:58368
    v_mfma_f32_16x16x32_bf16 v[68:71], v[140:143], v[28:31], v[68:71]
    ds_read_b64 v[124:125], v206 offset:58368
    ds_read_b64 v[126:127], v207 offset:58368
    s_waitcnt lgkmcnt(8)
    v_mfma_f32_16x16x32_bf16 v[72:75], v[144:147], v[16:19], 0
    v_mfma_f32_16x16x32_bf16 v[72:75], v[148:151], v[20:23], v[72:75]
    v_mfma_f32_16x16x32_bf16 v[72:75], v[152:155], v[24:27], v[72:75]
    v_mfma_f32_16x16x32_bf16 v[72:75], v[156:159], v[28:31], v[72:75]
    s_waitcnt lgkmcnt(0)
    v_mfma_f32_16x16x32_bf16 v[76:79], v[112:115], v[16:19], 0
    v_mfma_f32_16x16x32_bf16 v[76:79], v[116:119], v[20:23], v[76:79]
    v_mfma_f32_16x16x32_bf16 v[76:79], v[120:123], v[24:27], v[76:79]
    v_mfma_f32_16x16x32_bf16 v[76:79], v[124:127], v[28:31], v[76:79]
    s_mov_b32 s62, 0x3db504f3
    s_mov_b32 s63, 0x3e0293ee
    s_mov_b32 s64, 0xbc4a91dd
    s_mov_b32 s65, 0x42780000
    v_pk_add_f32 v[44:45], v[48:49], v[50:51]
    v_pk_add_f32 v[46:47], v[52:53], v[54:55]
    v_pk_add_f32 v[44:45], v[44:45], v[56:57]
    v_pk_add_f32 v[46:47], v[46:47], v[58:59]
    v_pk_add_f32 v[44:45], v[44:45], v[60:61]
    v_pk_add_f32 v[46:47], v[46:47], v[62:63]
    v_pk_add_f32 v[44:45], v[44:45], v[64:65]
    v_pk_add_f32 v[46:47], v[46:47], v[66:67]
    v_pk_add_f32 v[44:45], v[44:45], v[68:69]
    v_pk_add_f32 v[46:47], v[46:47], v[70:71]
    v_pk_add_f32 v[44:45], v[44:45], v[72:73]
    v_pk_add_f32 v[46:47], v[46:47], v[74:75]
    v_pk_add_f32 v[44:45], v[44:45], v[76:77]
    v_pk_add_f32 v[46:47], v[46:47], v[78:79]
    v_pk_add_f32 v[44:45], v[44:45], v[46:47]
    v_add_f32 v44, v44, v45
    v_mov_b32 v47, v79
    v_mov_b32 v46, v79
    s_nop 1
    v_permlane32_swap_b32 v47, v46
    v_mov_b32 v47, v46
    s_nop 1
    v_permlane16_swap_b32 v47, v46
    v_mov_b32 v45, v44
    s_nop 1
    v_permlane32_swap_b32 v44, v45
    v_add_f32 v44, v44, v45
    v_mov_b32 v45, v44
    s_nop 1
    v_permlane16_swap_b32 v44, v45
    v_add_f32 v44, v44, v45
    v_fma_f32 v44, v44, s62, -v46
    v_mul_f32 v44, s64, v44
    v_mov_b32 v46, s63
    v_pk_fma_f32 v[48:49], v[48:49], v[46:47], v[44:45] op_sel_hi:[1,0,0]
    v_pk_fma_f32 v[50:51], v[50:51], v[46:47], v[44:45] op_sel_hi:[1,0,0]
    v_pk_fma_f32 v[52:53], v[52:53], v[46:47], v[44:45] op_sel_hi:[1,0,0]
    v_pk_fma_f32 v[54:55], v[54:55], v[46:47], v[44:45] op_sel_hi:[1,0,0]
    v_pk_fma_f32 v[56:57], v[56:57], v[46:47], v[44:45] op_sel_hi:[1,0,0]
    v_pk_fma_f32 v[58:59], v[58:59], v[46:47], v[44:45] op_sel_hi:[1,0,0]
    v_pk_fma_f32 v[60:61], v[60:61], v[46:47], v[44:45] op_sel_hi:[1,0,0]
    v_pk_fma_f32 v[62:63], v[62:63], v[46:47], v[44:45] op_sel_hi:[1,0,0]
    v_pk_fma_f32 v[64:65], v[64:65], v[46:47], v[44:45] op_sel_hi:[1,0,0]
    v_pk_fma_f32 v[66:67], v[66:67], v[46:47], v[44:45] op_sel_hi:[1,0,0]
    v_pk_fma_f32 v[68:69], v[68:69], v[46:47], v[44:45] op_sel_hi:[1,0,0]
    v_pk_fma_f32 v[70:71], v[70:71], v[46:47], v[44:45] op_sel_hi:[1,0,0]
    v_pk_fma_f32 v[72:73], v[72:73], v[46:47], v[44:45] op_sel_hi:[1,0,0]
    v_pk_fma_f32 v[74:75], v[74:75], v[46:47], v[44:45] op_sel_hi:[1,0,0]
    v_pk_fma_f32 v[76:77], v[76:77], v[46:47], v[44:45] op_sel_hi:[1,0,0]
    v_pk_fma_f32 v[78:79], v[78:79], v[46:47], v[44:45] op_sel_hi:[1,0,0]
    v_cndmask_b32 v79, v79, 0, s[60:61]
    v_cvt_pk_bf16_f32 v80, v48, v49
    v_cvt_pk_bf16_f32 v81, v50, v51
    v_cvt_pk_bf16_f32 v82, v52, v53
    v_cvt_pk_bf16_f32 v83, v54, v55
    v_cvt_pk_bf16_f32 v84, v56, v57
    v_cvt_pk_bf16_f32 v85, v58, v59
    v_cvt_pk_bf16_f32 v86, v60, v61
    v_cvt_pk_bf16_f32 v87, v62, v63
    v_cvt_pk_bf16_f32 v88, v64, v65
    v_cvt_pk_bf16_f32 v89, v66, v67
    v_cvt_pk_bf16_f32 v90, v68, v69
    v_cvt_pk_bf16_f32 v91, v70, v71
    v_cvt_pk_bf16_f32 v92, v72, v73
    v_cvt_pk_bf16_f32 v93, v74, v75
    v_cvt_pk_bf16_f32 v94, v76, v77
    v_cvt_pk_bf16_f32 v95, v78, v79
    buffer_store_dwordx4 v[80:83], v1, s[12:15], s56 offen offset:0
    buffer_store_dwordx4 v[84:87], v1, s[12:15], s56 offen offset:1024
    buffer_store_dwordx4 v[88:91], v1, s[12:15], s56 offen offset:2048
    buffer_store_dwordx4 v[92:95], v1, s[12:15], s56 offen offset:3072
    v_pk_mul_f32 v[44:45], v[48:49], v[48:49]
    v_pk_mul_f32 v[46:47], v[50:51], v[50:51]
    v_pk_fma_f32 v[44:45], v[52:53], v[52:53], v[44:45]
    v_pk_fma_f32 v[46:47], v[54:55], v[54:55], v[46:47]
    v_pk_fma_f32 v[44:45], v[56:57], v[56:57], v[44:45]
    v_pk_fma_f32 v[46:47], v[58:59], v[58:59], v[46:47]
    v_pk_fma_f32 v[44:45], v[60:61], v[60:61], v[44:45]
    v_pk_fma_f32 v[46:47], v[62:63], v[62:63], v[46:47]
    v_pk_fma_f32 v[44:45], v[64:65], v[64:65], v[44:45]
    v_pk_fma_f32 v[46:47], v[66:67], v[66:67], v[46:47]
    v_pk_fma_f32 v[44:45], v[68:69], v[68:69], v[44:45]
    v_pk_fma_f32 v[46:47], v[70:71], v[70:71], v[46:47]
    v_pk_fma_f32 v[44:45], v[72:73], v[72:73], v[44:45]
    v_pk_fma_f32 v[46:47], v[74:75], v[74:75], v[46:47]
    v_pk_fma_f32 v[44:45], v[76:77], v[76:77], v[44:45]
    v_pk_fma_f32 v[46:47], v[78:79], v[78:79], v[46:47]
    v_pk_add_f32 v[44:45], v[44:45], v[46:47]
    v_add_f32 v44, v44, v45
    v_mov_b32 v45, v44
    s_nop 1
    v_permlane32_swap_b32 v44, v45
    v_add_f32 v44, v44, v45
    v_mov_b32 v45, v44
    s_nop 1
    v_permlane16_swap_b32 v44, v45
    v_add_f32 v44, v44, v45
    v_cmp_nge_f32 vcc, s65, v44
    s_cmp_lg_u64 vcc, 0
    s_cselect_b32 s66, 4, 0
    s_or_b32 s43, s66, s34
    s_lshr_b32 s36, s56, 12
    s_sub_u32 s36, s36, s23
    s_lshl_b32 s36, s36, 3
    s_lshl_b32 s38, s21, 10
    s_add_u32 s36, s36, s38
    s_add_u32 s36, s36, 147968
    v_lshl_add_u32 v5, v0, 24, s36
    v_mov_b32 v2, s43
    v_mov_b32 v3, s44
    s_waitcnt vmcnt(0)
    buffer_store_dwordx2 v[2:3], v5, s[16:19], 0 offen
    s_branch L_km_attn
L_km_free:
    s_mov_b32 s47, 0
    s_add_u32 s36, s22, 0
    s_cmp_lt_u32 s36, s39
    s_cselect_b32 s36, s36, 20
    s_mul_i32 s36, s36, 52
    s_lshr_b32 s36, s36, 8
    s_bitset1_b32 s47, s36
    s_add_u32 s36, s22, 8
    s_cmp_lt_u32 s36, s39
    s_cselect_b32 s36, s36, 20
    s_mul_i32 s36, s36, 52
    s_lshr_b32 s36, s36, 8
    s_bitset1_b32 s47, s36
    s_add_u32 s36, s22, 16
    s_cmp_lt_u32 s36, s39
    s_cselect_b32 s36, s36, 20
    s_mul_i32 s36, s36, 52
    s_lshr_b32 s36, s36, 8
    s_bitset1_b32 s47, s36
    s_andn2_b32 s47, 15, s47
    s_bfm_b32 s36, s20, 0
    s_and_b32 s36, s36, s47
    s_bcnt1_i32_b32 s7, s36
    s_waitcnt lgkmcnt(0)
    s_cmp_eq_u32 s7, 0
    s_cbranch_scc0 L_km_free1
    v_lshlrev_b32 v14, 24, v0
    s_cmp_eq_u32 s6, 32
    s_cbranch_scc0 L_km_notag
    s_memrealtime s[40:41]
    s_waitcnt lgkmcnt(0)
    s_lshl_b32 s40, s40, 3
    s_or_b32 s40, s40, 1
    v_mov_b32 v16, s40
    v_mov_b32 v17, 0
    buffer_atomic_cmpswap v[16:17], v14, s[96:99], 0 offen sc1
L_km_notag:
    s_cmp_eq_u32 s47, 15
    s_cselect_b32 s47, 0, s47
    s_bcnt1_i32_b32 s48, s47
    s_bitcmp1_b32 s47, 0
    s_cbranch_scc0 L_km_a0
    s_mov_b32 s49, 0
    s_mov_b32 s50, 4096
    s_add_u32 m0, s49, 90112
    s_nop 0
    buffer_load_dwordx4 v6, s[24:27], s49 offen offset:0 lds
    buffer_load_dwordx4 v6, s[24:27], s49 offen offset:1024 lds
    buffer_load_dwordx4 v2, s[24:27], s49 offen offset:2048 lds
    buffer_load_dwordx4 v2, s[24:27], s49 offen offset:3072 lds
    s_add_u32 m0, s50, 90112
    s_nop 0
    buffer_load_dwordx4 v6, s[24:27], s50 offen offset:0 lds
    buffer_load_dwordx4 v6, s[24:27], s50 offen offset:1024 lds
    buffer_load_dwordx4 v2, s[24:27], s50 offen offset:2048 lds
    buffer_load_dwordx4 v2, s[24:27], s50 offen offset:3072 lds
L_km_a0:
    s_bitcmp1_b32 s47, 1
    s_cbranch_scc0 L_km_a1
    s_mov_b32 s49, 8192
    s_mov_b32 s50, 12288
    s_add_u32 m0, s49, 90112
    s_nop 0
    buffer_load_dwordx4 v6, s[24:27], s49 offen offset:0 lds
    buffer_load_dwordx4 v6, s[24:27], s49 offen offset:1024 lds
    buffer_load_dwordx4 v2, s[24:27], s49 offen offset:2048 lds
    buffer_load_dwordx4 v2, s[24:27], s49 offen offset:3072 lds
    s_add_u32 m0, s50, 90112
    s_nop 0
    buffer_load_dwordx4 v6, s[24:27], s50 offen offset:0 lds
    buffer_load_dwordx4 v6, s[24:27], s50 offen offset:1024 lds
    buffer_load_dwordx4 v2, s[24:27], s50 offen offset:2048 lds
    buffer_load_dwordx4 v2, s[24:27], s50 offen offset:3072 lds
L_km_a1:
    s_bitcmp1_b32 s47, 2
    s_cbranch_scc0 L_km_a2
    s_mov_b32 s49, 16384
    s_mov_b32 s50, 20480
    s_add_u32 m0, s49, 90112
    s_nop 0
    buffer_load_dwordx4 v6, s[24:27], s49 offen offset:0 lds
    buffer_load_dwordx4 v6, s[24:27], s49 offen offset:1024 lds
    buffer_load_dwordx4 v2, s[24:27], s49 offen offset:2048 lds
    buffer_load_dwordx4 v2, s[24:27], s49 offen offset:3072 lds
    s_add_u32 m0, s50, 90112
    s_nop 0
    buffer_load_dwordx4 v6, s[24:27], s50 offen offset:0 lds
    buffer_load_dwordx4 v6, s[24:27], s50 offen offset:1024 lds
    buffer_load_dwordx4 v2, s[24:27], s50 offen offset:2048 lds
    buffer_load_dwordx4 v2, s[24:27], s50 offen offset:3072 lds
L_km_a2:
    s_bitcmp1_b32 s47, 3
    s_cbranch_scc0 L_km_a3
    s_mov_b32 s49, 24576
    s_mov_b32 s50, 28672
    s_add_u32 m0, s49, 90112
    s_nop 0
    buffer_load_dwordx4 v6, s[24:27], s49 offen offset:0 lds
    buffer_load_dwordx4 v6, s[24:27], s49 offen offset:1024 lds
    buffer_load_dwordx4 v2, s[24:27], s49 offen offset:2048 lds
    buffer_load_dwordx4 v2, s[24:27], s49 offen offset:3072 lds
    s_add_u32 m0, s50, 90112
    s_nop 0
    buffer_load_dwordx4 v6, s[24:27], s50 offen offset:0 lds
    buffer_load_dwordx4 v6, s[24:27], s50 offen offset:1024 lds
    buffer_load_dwordx4 v2, s[24:27], s50 offen offset:2048 lds
    buffer_load_dwordx4 v2, s[24:27], s50 offen offset:3072 lds
L_km_a3:
    v_xor_b32 v7, v3, v4
    v_lshlrev_b32 v7, 4, v7
    v_lshl_add_u32 v7, v4, 8, v7
    v_xor_b32 v8, 64, v7
    v_xor_b32 v9, 128, v7
    v_xor_b32 v10, 192, v7
    s_bitcmp1_b32 s47, 0
    s_cbranch_scc0 L_km_c0
    s_mov_b32 s49, 0
    s_mov_b32 s50, 4096
    s_add_u32 m0, s49, 122880
    s_nop 0
    buffer_load_dwordx4 v7, s[28:31], s49 offen offset:0 lds
    buffer_load_dwordx4 v7, s[28:31], s49 offen offset:1024 lds
    buffer_load_dwordx4 v8, s[28:31], s49 offen offset:2048 lds
    buffer_load_dwordx4 v8, s[28:31], s49 offen offset:3072 lds
    s_add_u32 m0, s50, 122880
    s_nop 0
    buffer_load_dwordx4 v9, s[28:31], s50 offen offset:0 lds
    buffer_load_dwordx4 v9, s[28:31], s50 offen offset:1024 lds
    buffer_load_dwordx4 v10, s[28:31], s50 offen offset:2048 lds
    buffer_load_dwordx4 v10, s[28:31], s50 offen offset:3072 lds
L_km_c0:
    s_bitcmp1_b32 s47, 1
    s_cbranch_scc0 L_km_c1
    s_mov_b32 s49, 8192
    s_mov_b32 s50, 12288
    s_add_u32 m0, s49, 122880
    s_nop 0
    buffer_load_dwordx4 v7, s[28:31], s49 offen offset:0 lds
    buffer_load_dwordx4 v7, s[28:31], s49 offen offset:1024 lds
    buffer_load_dwordx4 v8, s[28:31], s49 offen offset:2048 lds
    buffer_load_dwordx4 v8, s[28:31], s49 offen offset:3072 lds
    s_add_u32 m0, s50, 122880
    s_nop 0
    buffer_load_dwordx4 v9, s[28:31], s50 offen offset:0 lds
    buffer_load_dwordx4 v9, s[28:31], s50 offen offset:1024 lds
    buffer_load_dwordx4 v10, s[28:31], s50 offen offset:2048 lds
    buffer_load_dwordx4 v10, s[28:31], s50 offen offset:3072 lds
L_km_c1:
    s_bitcmp1_b32 s47, 2
    s_cbranch_scc0 L_km_c2
    s_mov_b32 s49, 16384
    s_mov_b32 s50, 20480
    s_add_u32 m0, s49, 122880
    s_nop 0
    buffer_load_dwordx4 v7, s[28:31], s49 offen offset:0 lds
    buffer_load_dwordx4 v7, s[28:31], s49 offen offset:1024 lds
    buffer_load_dwordx4 v8, s[28:31], s49 offen offset:2048 lds
    buffer_load_dwordx4 v8, s[28:31], s49 offen offset:3072 lds
    s_add_u32 m0, s50, 122880
    s_nop 0
    buffer_load_dwordx4 v9, s[28:31], s50 offen offset:0 lds
    buffer_load_dwordx4 v9, s[28:31], s50 offen offset:1024 lds
    buffer_load_dwordx4 v10, s[28:31], s50 offen offset:2048 lds
    buffer_load_dwordx4 v10, s[28:31], s50 offen offset:3072 lds
L_km_c2:
    s_bitcmp1_b32 s47, 3
    s_cbranch_scc0 L_km_c3
    s_mov_b32 s49, 24576
    s_mov_b32 s50, 28672
    s_add_u32 m0, s49, 122880
    s_nop 0
    buffer_load_dwordx4 v7, s[28:31], s49 offen offset:0 lds
    buffer_load_dwordx4 v7, s[28:31], s49 offen offset:1024 lds
    buffer_load_dwordx4 v8, s[28:31], s49 offen offset:2048 lds
    buffer_load_dwordx4 v8, s[28:31], s49 offen offset:3072 lds
    s_add_u32 m0, s50, 122880
    s_nop 0
    buffer_load_dwordx4 v9, s[28:31], s50 offen offset:0 lds
    buffer_load_dwordx4 v9, s[28:31], s50 offen offset:1024 lds
    buffer_load_dwordx4 v10, s[28:31], s50 offen offset:2048 lds
    buffer_load_dwordx4 v10, s[28:31], s50 offen offset:3072 lds
L_km_c3:
    s_mul_i32 s46, s20, 6144
    v_add_u32 v232, s46, v1
    s_mul_i32 s45, s22, 319488
    s_cmp_eq_u32 s35, 0
    s_cselect_b32 s36, 4, 0
    s_add_u32 s36, s36, s33
    s_lshl_b32 s52, s36, 12
    s_cmp_eq_u32 s35, 1
    s_cselect_b32 s36, 4, 1
    s_add_u32 s36, s36, s33
    s_lshl_b32 s53, s36, 12
    s_cmp_eq_u32 s35, 2
    s_cselect_b32 s36, 4, 2
    s_add_u32 s36, s36, s33
    s_lshl_b32 s54, s36, 12
    s_cmp_eq_u32 s35, 3
    s_cselect_b32 s36, 4, 3
    s_add_u32 s36, s36, s33
    s_lshl_b32 s55, s36, 12
    s_lshr_b32 s3, s22, 1
    s_lshl_b32 s32, s6, 2
    s_add_u32 s32, s32, s20
    s_getreg_b32 s44, hwreg(HW_REG_XCC_ID, 0, 16)
    v_lshlrev_b32 v11, 7, v0
    v_cmp_gt_u32 vcc, 20, v0
    s_mul_i32 s36, s22, 2560
    s_lshl_b32 s38, s33, 12
    s_add_u32 s51, s36, s38
    v_mov_b32 v12, 0x10000000
    v_cndmask_b32 v240, v12, v11, vcc
    s_mov_b32 s8, s4
    s_mov_b32 s9, s5
    s_mov_b32 s10, 0x271000
    s_mov_b32 s11, 0x20000
    s_add_u32 s12, s4, 0x280000
    s_addc_u32 s13, s5, 0
    s_mov_b32 s14, 0x271000
    s_mov_b32 s15, 0x20000
    s_add_u32 s16, s4, 0x1a00000
    s_addc_u32 s17, s5, 0
    s_mov_b32 s18, 0x2c000
    s_mov_b32 s19, 0x20000
    s_mov_b32 s76, s58
    s_mov_b32 s77, s59
    s_mov_b32 s78, 0x271000
    s_mov_b32 s79, 0x20000
    v_mov_b32 v252, 0
    v_mov_b32 v253, 0
    v_mov_b32 v254, 0
    v_mov_b32 v255, 0
    s_mov_b32 s38, 0
    v_and_b32 v244, 15, v0
    v_lshrrev_b32 v245, 4, v0
    v_lshrrev_b32 v250, 3, v244
    v_and_b32 v251, 7, v244
    v_lshlrev_b32 v251, 1, v251
    v_or_b32 v246, v251, v250
    v_lshlrev_b32 v250, 3, v250
    v_xor_b32 v246, v246, v250
    v_xor_b32 v246, v246, v245
    v_xor_b32 v247, 0, v246
    v_lshlrev_b32 v247, 4, v247
    v_lshl_add_u32 v220, v244, 8, v247
    v_add_u32 v220, s38, v220
    v_xor_b32 v247, 4, v246
    v_lshlrev_b32 v247, 4, v247
    v_lshl_add_u32 v221, v244, 8, v247
    v_add_u32 v221, s38, v221
    v_xor_b32 v247, 8, v246
    v_lshlrev_b32 v247, 4, v247
    v_lshl_add_u32 v222, v244, 8, v247
    v_add_u32 v222, s38, v222
    v_xor_b32 v247, 12, v246
    v_lshlrev_b32 v247, 4, v247
    v_lshl_add_u32 v223, v244, 8, v247
    v_add_u32 v223, s38, v223
    v_lshrrev_b32 v247, 2, v244
    v_lshl_add_u32 v247, v245, 2, v247
    v_lshrrev_b32 v250, 3, v247
    v_and_b32 v251, 7, v247
    v_lshlrev_b32 v251, 1, v251
    v_or_b32 v246, v251, v250
    v_lshlrev_b32 v250, 3, v250
    v_xor_b32 v246, v246, v250
    v_bfe_u32 v248, v0, 1, 1
    v_xor_b32 v246, v246, v248
    v_and_b32 v248, 1, v0
    v_lshlrev_b32 v248, 3, v248
    v_lshl_add_u32 v248, v247, 8, v248
    v_add_u32 v248, s38, v248
    v_xor_b32 v249, 0, v246
    v_lshl_add_u32 v224, v249, 4, v248
    v_xor_b32 v249, 2, v246
    v_lshl_add_u32 v225, v249, 4, v248
    v_xor_b32 v249, 4, v246
    v_lshl_add_u32 v226, v249, 4, v248
    v_xor_b32 v249, 6, v246
    v_lshl_add_u32 v227, v249, 4, v248
    v_xor_b32 v249, 8, v246
    v_lshl_add_u32 v228, v249, 4, v248
    v_xor_b32 v249, 10, v246
    v_lshl_add_u32 v229, v249, 4, v248
    v_xor_b32 v249, 12, v246
    v_lshl_add_u32 v230, v249, 4, v248
    v_xor_b32 v249, 14, v246
    v_lshl_add_u32 v231, v249, 4, v248
    v_mfma_f32_32x32x16_bf16 a[0:15], v[252:255], v[252:255], 0
    v_mfma_f32_32x32x16_bf16 a[16:31], v[252:255], v[252:255], 0
    v_mfma_f32_32x32x16_bf16 a[32:47], v[252:255], v[252:255], 0
    v_mfma_f32_32x32x16_bf16 a[48:63], v[252:255], v[252:255], 0
    v_mfma_f32_32x32x16_bf16 a[64:79], v[252:255], v[252:255], 0
    v_mfma_f32_32x32x16_bf16 a[80:95], v[252:255], v[252:255], 0
    v_mfma_f32_32x32x16_bf16 a[96:111], v[252:255], v[252:255], 0
    v_mfma_f32_32x32x16_bf16 a[112:127], v[252:255], v[252:255], 0
    v_mfma_f32_32x32x16_bf16 a[128:143], v[252:255], v[252:255], 0
    v_mfma_f32_32x32x16_bf16 a[144:159], v[252:255], v[252:255], 0
    v_mov_b32 v14, 0
    buffer_load_dword v15, v14, s[96:99], 0 offen sc1
    s_cmp_eq_u32 s48, 3
    s_cbranch_scc1 L_km_d3
    s_cmp_eq_u32 s48, 2
    s_cbranch_scc1 L_km_d2
    s_cmp_eq_u32 s48, 1
    s_cbranch_scc1 L_km_d1
    s_waitcnt vmcnt(1)
L_km_d1:
    s_waitcnt vmcnt(9)
L_km_d2:
    s_waitcnt vmcnt(17)
L_km_d3:
    s_waitcnt vmcnt(25)
    s_barrier
    s_mov_b32 s41, 0
L_km_tagp:
    s_waitcnt vmcnt(0)
    v_readfirstlane_b32 s34, v15
    s_cmp_lg_u32 s34, 0
    s_cbranch_scc1 L_km_tag
    s_sleep 4
    buffer_load_dword v15, v14, s[96:99], 0 offen sc1
    s_add_u32 s41, s41, 1
    s_cmp_lt_u32 s41, 262144
    s_cbranch_scc1 L_km_tagp
L_km_tag:
    s_and_b32 s34, s34, -8
    v_mov_b32 v12, s34
    v_mov_b32 v13, -1
    v_mov_b32 v14, -1
    v_mov_b32 v16, 89088
    ds_write_b96 v16, v[12:14]
    s_lshl_b32 s36, s6, 7
    v_lshl_add_u32 v15, v0, 24, s36
    v_lshl_add_u32 v16, v0, 3, s22
    v_cmp_gt_u32 vcc, s39, v16
    v_add_u32 v16, s23, v16
    v_mov_b32 v17, 65536
    v_lshl_add_u32 v16, v16, 7, v17
    v_mov_b32 v17, 0x10000000
    v_cndmask_b32 v16, v17, v16, vcc
    s_waitcnt lgkmcnt(0)
    s_barrier
    buffer_store_dword v12, v16, s[16:19], 0 offen sc1
    v_mov_b32 v13, s44
    buffer_store_dwordx2 v[12:13], v15, s[16:19], 0 offen sc1
    buffer_load_dword v241, v240, s[12:15], s51 offen
    s_branch L_km_attn
L_km_free1:
    s_mul_i32 s46, s20, 6144
    v_add_u32 v232, s46, v1
    s_mul_i32 s45, s22, 319488
    s_cmp_eq_u32 s35, 0
    s_cselect_b32 s36, 4, 0
    s_add_u32 s36, s36, s33
    s_lshl_b32 s52, s36, 12
    s_cmp_eq_u32 s35, 1
    s_cselect_b32 s36, 4, 1
    s_add_u32 s36, s36, s33
    s_lshl_b32 s53, s36, 12
    s_cmp_eq_u32 s35, 2
    s_cselect_b32 s36, 4, 2
    s_add_u32 s36, s36, s33
    s_lshl_b32 s54, s36, 12
    s_cmp_eq_u32 s35, 3
    s_cselect_b32 s36, 4, 3
    s_add_u32 s36, s36, s33
    s_lshl_b32 s55, s36, 12
    s_lshr_b32 s3, s22, 1
    s_lshl_b32 s32, s6, 2
    s_add_u32 s32, s32, s20
    s_getreg_b32 s44, hwreg(HW_REG_XCC_ID, 0, 16)
    v_lshlrev_b32 v11, 7, v0
    v_cmp_gt_u32 vcc, 20, v0
    s_mul_i32 s36, s22, 2560
    s_lshl_b32 s38, s33, 12
    s_add_u32 s51, s36, s38
    v_mov_b32 v12, 0x10000000
    v_cndmask_b32 v240, v12, v11, vcc
    s_mov_b32 s8, s4
    s_mov_b32 s9, s5
    s_mov_b32 s10, 0x271000
    s_mov_b32 s11, 0x20000
    s_add_u32 s12, s4, 0x280000
    s_addc_u32 s13, s5, 0
    s_mov_b32 s14, 0x271000
    s_mov_b32 s15, 0x20000
    s_add_u32 s16, s4, 0x1a00000
    s_addc_u32 s17, s5, 0
    s_mov_b32 s18, 0x2c000
    s_mov_b32 s19, 0x20000
    s_mov_b32 s76, s58
    s_mov_b32 s77, s59
    s_mov_b32 s78, 0x271000
    s_mov_b32 s79, 0x20000
    v_mov_b32 v252, 0
    v_mov_b32 v253, 0
    v_mov_b32 v254, 0
    v_mov_b32 v255, 0
    s_mov_b32 s38, 0
    v_and_b32 v244, 15, v0
    v_lshrrev_b32 v245, 4, v0
    v_lshrrev_b32 v250, 3, v244
    v_and_b32 v251, 7, v244
    v_lshlrev_b32 v251, 1, v251
    v_or_b32 v246, v251, v250
    v_lshlrev_b32 v250, 3, v250
    v_xor_b32 v246, v246, v250
    v_xor_b32 v246, v246, v245
    v_xor_b32 v247, 0, v246
    v_lshlrev_b32 v247, 4, v247
    v_lshl_add_u32 v220, v244, 8, v247
    v_add_u32 v220, s38, v220
    v_xor_b32 v247, 4, v246
    v_lshlrev_b32 v247, 4, v247
    v_lshl_add_u32 v221, v244, 8, v247
    v_add_u32 v221, s38, v221
    v_xor_b32 v247, 8, v246
    v_lshlrev_b32 v247, 4, v247
    v_lshl_add_u32 v222, v244, 8, v247
    v_add_u32 v222, s38, v222
    v_xor_b32 v247, 12, v246
    v_lshlrev_b32 v247, 4, v247
    v_lshl_add_u32 v223, v244, 8, v247
    v_add_u32 v223, s38, v223
    v_lshrrev_b32 v247, 2, v244
    v_lshl_add_u32 v247, v245, 2, v247
    v_lshrrev_b32 v250, 3, v247
    v_and_b32 v251, 7, v247
    v_lshlrev_b32 v251, 1, v251
    v_or_b32 v246, v251, v250
    v_lshlrev_b32 v250, 3, v250
    v_xor_b32 v246, v246, v250
    v_bfe_u32 v248, v0, 1, 1
    v_xor_b32 v246, v246, v248
    v_and_b32 v248, 1, v0
    v_lshlrev_b32 v248, 3, v248
    v_lshl_add_u32 v248, v247, 8, v248
    v_add_u32 v248, s38, v248
    v_xor_b32 v249, 0, v246
    v_lshl_add_u32 v224, v249, 4, v248
    v_xor_b32 v249, 2, v246
    v_lshl_add_u32 v225, v249, 4, v248
    v_xor_b32 v249, 4, v246
    v_lshl_add_u32 v226, v249, 4, v248
    v_xor_b32 v249, 6, v246
    v_lshl_add_u32 v227, v249, 4, v248
    v_xor_b32 v249, 8, v246
    v_lshl_add_u32 v228, v249, 4, v248
    v_xor_b32 v249, 10, v246
    v_lshl_add_u32 v229, v249, 4, v248
    v_xor_b32 v249, 12, v246
    v_lshl_add_u32 v230, v249, 4, v248
    v_xor_b32 v249, 14, v246
    v_lshl_add_u32 v231, v249, 4, v248
    v_mfma_f32_32x32x16_bf16 a[0:15], v[252:255], v[252:255], 0
    v_mfma_f32_32x32x16_bf16 a[16:31], v[252:255], v[252:255], 0
    v_mfma_f32_32x32x16_bf16 a[32:47], v[252:255], v[252:255], 0
    v_mfma_f32_32x32x16_bf16 a[48:63], v[252:255], v[252:255], 0
    v_mfma_f32_32x32x16_bf16 a[64:79], v[252:255], v[252:255], 0
    v_mfma_f32_32x32x16_bf16 a[80:95], v[252:255], v[252:255], 0
    v_mfma_f32_32x32x16_bf16 a[96:111], v[252:255], v[252:255], 0
    v_mfma_f32_32x32x16_bf16 a[112:127], v[252:255], v[252:255], 0
    v_mfma_f32_32x32x16_bf16 a[128:143], v[252:255], v[252:255], 0
    v_mfma_f32_32x32x16_bf16 a[144:159], v[252:255], v[252:255], 0
    s_cmp_eq_u32 s21, 31
    s_cbranch_scc0 L_km_free2
    s_cmp_lt_u32 s7, 3
    s_cbranch_scc1 L_km_w
L_km_free2:
    s_and_b32 s36, s21, 3
    s_lshl_b32 s36, s36, 2
    s_add_u32 s36, s36, s22
    s_sub_u32 s36, s36, 4
    s_lshr_b32 s38, s21, 3
    s_lshl_b32 s38, s38, 1
    s_bitcmp0_b32 s21, 2
    s_cbranch_scc1 L_km_sort
    s_barrier
    buffer_load_dword v241, v240, s[12:15], s51 offen
    s_barrier
    s_branch L_km_jobdone
L_km_w:
    s_lshl_b32 s40, s22, 1
    s_add_u32 s40, s40, s7
    s_sub_u32 s40, s40, 1
    s_load_dwordx2 s[60:61], s[0:1], 64
    s_cmp_ge_u32 s40, 8
    s_cselect_b32 s41, 32, 56
    s_load_dwordx2 s[64:65], s[0:1], s41
    s_cselect_b64 vcc, -1, 0
    s_cselect_b32 s42, 1, 4
    s_lshl_b32 s42, s42, 10
    s_and_b32 s48, s40, 7
    s_lshr_b32 s49, s48, 1
    s_lshl_b32 s49, s49, 5
    s_and_b32 s50, s48, 1
    s_lshl_b32 s50, s50, 2
    s_add_u32 s49, s49, s50
    v_lshrrev_b32 v5, 2, v3
    v_and_b32 v6, 3, v3
    v_lshl_add_u32 v7, v5, 3, v6
    v_add_u32 v7, s49, v7
    v_lshlrev_b32 v7, 1, v7
    v_lshl_add_u32 v7, v4, 11, v7
    v_lshl_add_u32 v8, v5, 5, v6
    v_cndmask_b32 v8, v3, v8, vcc
    v_lshlrev_b32 v8, 8, v8
    v_lshl_add_u32 v8, v4, 4, v8
    s_waitcnt lgkmcnt(0)
    s_mov_b32 s62, 32768
    s_mov_b32 s63, 0x20000
    s_mov_b32 s66, 32768
    s_mov_b32 s67, 0x20000
    s_load_dword s70, s[60:61], 0
    s_load_dword s71, s[64:65], 0
    s_mov_b32 s43, 0
    s_barrier
    buffer_load_dword v241, v240, s[12:15], s51 offen
    s_barrier
    buffer_load_ushort v192, v7, s[60:63], s43 offen offset:0
    buffer_load_ushort v193, v7, s[60:63], s43 offen offset:256
    buffer_load_ushort v194, v7, s[60:63], s43 offen offset:512
    buffer_load_ushort v195, v7, s[60:63], s43 offen offset:768
    buffer_load_ushort v196, v7, s[60:63], s43 offen offset:1024
    buffer_load_ushort v197, v7, s[60:63], s43 offen offset:1280
    buffer_load_ushort v198, v7, s[60:63], s43 offen offset:1536
    buffer_load_ushort v199, v7, s[60:63], s43 offen offset:1792
    s_add_u32 s43, s43, 8192
    buffer_load_ushort v200, v7, s[60:63], s43 offen offset:0
    buffer_load_ushort v201, v7, s[60:63], s43 offen offset:256
    buffer_load_ushort v202, v7, s[60:63], s43 offen offset:512
    buffer_load_ushort v203, v7, s[60:63], s43 offen offset:768
    buffer_load_ushort v204, v7, s[60:63], s43 offen offset:1024
    buffer_load_ushort v205, v7, s[60:63], s43 offen offset:1280
    buffer_load_ushort v206, v7, s[60:63], s43 offen offset:1536
    buffer_load_ushort v207, v7, s[60:63], s43 offen offset:1792
    s_add_u32 s43, s43, 8192
    buffer_load_ushort v208, v7, s[60:63], s43 offen offset:0
    buffer_load_ushort v209, v7, s[60:63], s43 offen offset:256
    buffer_load_ushort v210, v7, s[60:63], s43 offen offset:512
    buffer_load_ushort v211, v7, s[60:63], s43 offen offset:768
    buffer_load_ushort v212, v7, s[60:63], s43 offen offset:1024
    buffer_load_ushort v213, v7, s[60:63], s43 offen offset:1280
    buffer_load_ushort v214, v7, s[60:63], s43 offen offset:1536
    buffer_load_ushort v215, v7, s[60:63], s43 offen offset:1792
    s_add_u32 s43, s43, 8192
    buffer_load_ushort v216, v7, s[60:63], s43 offen offset:0
    buffer_load_ushort v217, v7, s[60:63], s43 offen offset:256
    buffer_load_ushort v218, v7, s[60:63], s43 offen offset:512
    buffer_load_ushort v219, v7, s[60:63], s43 offen offset:768
    buffer_load_ushort v244, v7, s[60:63], s43 offen offset:1024
    buffer_load_ushort v245, v7, s[60:63], s43 offen offset:1280
    buffer_load_ushort v246, v7, s[60:63], s43 offen offset:1536
    buffer_load_ushort v247, v7, s[60:63], s43 offen offset:1792
    s_mov_b32 s43, 0
    buffer_load_dwordx4 v[64:67], v8, s[64:67], s43 offen offset:0
    buffer_load_dwordx4 v[68:71], v8, s[64:67], s43 offen offset:64
    buffer_load_dwordx4 v[72:75], v8, s[64:67], s43 offen offset:128
    buffer_load_dwordx4 v[76:79], v8, s[64:67], s43 offen offset:192
    s_add_u32 s43, s43, s42
    buffer_load_dwordx4 v[80:83], v8, s[64:67], s43 offen offset:0
    buffer_load_dwordx4 v[84:87], v8, s[64:67], s43 offen offset:64
    buffer_load_dwordx4 v[88:91], v8, s[64:67], s43 offen offset:128
    buffer_load_dwordx4 v[92:95], v8, s[64:67], s43 offen offset:192
    s_add_u32 s43, s43, s42
    buffer_load_dwordx4 v[96:99], v8, s[64:67], s43 offen offset:0
    buffer_load_dwordx4 v[100:103], v8, s[64:67], s43 offen offset:64
    buffer_load_dwordx4 v[104:107], v8, s[64:67], s43 offen offset:128
    buffer_load_dwordx4 v[108:111], v8, s[64:67], s43 offen offset:192
    s_add_u32 s43, s43, s42
    buffer_load_dwordx4 v[112:115], v8, s[64:67], s43 offen offset:0
    buffer_load_dwordx4 v[116:119], v8, s[64:67], s43 offen offset:64
    buffer_load_dwordx4 v[120:123], v8, s[64:67], s43 offen offset:128
    buffer_load_dwordx4 v[124:127], v8, s[64:67], s43 offen offset:192
    s_add_u32 s43, s43, s42
    buffer_load_dwordx4 v[128:131], v8, s[64:67], s43 offen offset:0
    buffer_load_dwordx4 v[132:135], v8, s[64:67], s43 offen offset:64
    buffer_load_dwordx4 v[136:139], v8, s[64:67], s43 offen offset:128
    buffer_load_dwordx4 v[140:143], v8, s[64:67], s43 offen offset:192
    s_add_u32 s43, s43, s42
    buffer_load_dwordx4 v[144:147], v8, s[64:67], s43 offen offset:0
    buffer_load_dwordx4 v[148:151], v8, s[64:67], s43 offen offset:64
    buffer_load_dwordx4 v[152:155], v8, s[64:67], s43 offen offset:128
    buffer_load_dwordx4 v[156:159], v8, s[64:67], s43 offen offset:192
    s_add_u32 s43, s43, s42
    buffer_load_dwordx4 v[160:163], v8, s[64:67], s43 offen offset:0
    buffer_load_dwordx4 v[164:167], v8, s[64:67], s43 offen offset:64
    buffer_load_dwordx4 v[168:171], v8, s[64:67], s43 offen offset:128
    buffer_load_dwordx4 v[172:175], v8, s[64:67], s43 offen offset:192
    s_add_u32 s43, s43, s42
    s_waitcnt vmcnt(56)
    buffer_load_dwordx4 v[176:179], v8, s[64:67], s43 offen offset:0
    buffer_load_dwordx4 v[180:183], v8, s[64:67], s43 offen offset:64
    buffer_load_dwordx4 v[184:187], v8, s[64:67], s43 offen offset:128
    buffer_load_dwordx4 v[188:191], v8, s[64:67], s43 offen offset:192
    s_lshl_b32 s43, s40, 12
    s_mov_b32 s48, 0
    s_mov_b32 s49, 0xffff0000
    s_mov_b32 s50, 0x3db504f3
    s_mov_b32 s41, 0xbdc69217
    s_waitcnt vmcnt(28)
    v_lshl_or_b32 v16, v193, 16, v192
    v_lshl_or_b32 v17, v195, 16, v194
    v_lshl_or_b32 v18, v197, 16, v196
    v_lshl_or_b32 v19, v199, 16, v198
    v_lshl_or_b32 v20, v201, 16, v200
    v_lshl_or_b32 v21, v203, 16, v202
    v_lshl_or_b32 v22, v205, 16, v204
    v_lshl_or_b32 v23, v207, 16, v206
    v_lshl_or_b32 v24, v209, 16, v208
    v_lshl_or_b32 v25, v211, 16, v210
    v_lshl_or_b32 v26, v213, 16, v212
    v_lshl_or_b32 v27, v215, 16, v214
    v_lshl_or_b32 v28, v217, 16, v216
    v_lshl_or_b32 v29, v219, 16, v218
    v_lshl_or_b32 v30, v245, 16, v244
    v_lshl_or_b32 v31, v247, 16, v246
    v_mfma_f32_16x16x32_bf16 v[32:35], v[64:67], v[16:19], 0
    v_mfma_f32_16x16x32_bf16 v[32:35], v[68:71], v[20:23], v[32:35]
    v_mfma_f32_16x16x32_bf16 v[32:35], v[72:75], v[24:27], v[32:35]
    v_mfma_f32_16x16x32_bf16 v[32:35], v[76:79], v[28:31], v[32:35]
    s_waitcnt vmcnt(24)
    v_mfma_f32_16x16x32_bf16 v[36:39], v[80:83], v[16:19], 0
    v_mfma_f32_16x16x32_bf16 v[36:39], v[84:87], v[20:23], v[36:39]
    v_mfma_f32_16x16x32_bf16 v[36:39], v[88:91], v[24:27], v[36:39]
    v_mfma_f32_16x16x32_bf16 v[36:39], v[92:95], v[28:31], v[36:39]
    s_waitcnt vmcnt(20)
    v_mfma_f32_16x16x32_bf16 v[40:43], v[96:99], v[16:19], 0
    v_mfma_f32_16x16x32_bf16 v[40:43], v[100:103], v[20:23], v[40:43]
    v_mfma_f32_16x16x32_bf16 v[40:43], v[104:107], v[24:27], v[40:43]
    v_mfma_f32_16x16x32_bf16 v[40:43], v[108:111], v[28:31], v[40:43]
    s_waitcnt vmcnt(16)
    v_mfma_f32_16x16x32_bf16 v[44:47], v[112:115], v[16:19], 0
    v_mfma_f32_16x16x32_bf16 v[44:47], v[116:119], v[20:23], v[44:47]
    v_mfma_f32_16x16x32_bf16 v[44:47], v[120:123], v[24:27], v[44:47]
    v_mfma_f32_16x16x32_bf16 v[44:47], v[124:127], v[28:31], v[44:47]
    s_waitcnt vmcnt(12)
    v_mfma_f32_16x16x32_bf16 v[48:51], v[128:131], v[16:19], 0
    v_mfma_f32_16x16x32_bf16 v[48:51], v[132:135], v[20:23], v[48:51]
    v_mfma_f32_16x16x32_bf16 v[48:51], v[136:139], v[24:27], v[48:51]
    v_mfma_f32_16x16x32_bf16 v[48:51], v[140:143], v[28:31], v[48:51]
    s_waitcnt vmcnt(8)
    v_mfma_f32_16x16x32_bf16 v[52:55], v[144:147], v[16:19], 0
    v_mfma_f32_16x16x32_bf16 v[52:55], v[148:151], v[20:23], v[52:55]
    v_mfma_f32_16x16x32_bf16 v[52:55], v[152:155], v[24:27], v[52:55]
    v_mfma_f32_16x16x32_bf16 v[52:55], v[156:159], v[28:31], v[52:55]
    s_waitcnt vmcnt(4)
    v_mfma_f32_16x16x32_bf16 v[56:59], v[160:163], v[16:19], 0
    v_mfma_f32_16x16x32_bf16 v[56:59], v[164:167], v[20:23], v[56:59]
    v_mfma_f32_16x16x32_bf16 v[56:59], v[168:171], v[24:27], v[56:59]
    v_mfma_f32_16x16x32_bf16 v[56:59], v[172:175], v[28:31], v[56:59]
    s_waitcnt vmcnt(0)
    v_mfma_f32_16x16x32_bf16 v[60:63], v[176:179], v[16:19], 0
    v_mfma_f32_16x16x32_bf16 v[60:63], v[180:183], v[20:23], v[60:63]
    v_mfma_f32_16x16x32_bf16 v[60:63], v[184:187], v[24:27], v[60:63]
    v_mfma_f32_16x16x32_bf16 v[60:63], v[188:191], v[28:31], v[60:63]
    v_pk_add_f32 v[12:13], v[32:33], v[34:35]
    v_pk_add_f32 v[14:15], v[36:37], v[38:39]
    v_pk_add_f32 v[12:13], v[12:13], v[40:41]
    v_pk_add_f32 v[14:15], v[14:15], v[42:43]
    v_pk_add_f32 v[12:13], v[12:13], v[44:45]
    v_pk_add_f32 v[14:15], v[14:15], v[46:47]
    v_pk_add_f32 v[12:13], v[12:13], v[48:49]
    v_pk_add_f32 v[14:15], v[14:15], v[50:51]
    v_pk_add_f32 v[12:13], v[12:13], v[52:53]
    v_pk_add_f32 v[14:15], v[14:15], v[54:55]
    v_pk_add_f32 v[12:13], v[12:13], v[56:57]
    v_pk_add_f32 v[14:15], v[14:15], v[58:59]
    v_pk_add_f32 v[12:13], v[12:13], v[60:61]
    v_pk_add_f32 v[14:15], v[14:15], v[62:63]
    v_pk_add_f32 v[12:13], v[12:13], v[14:15]
    v_add_f32 v12, v12, v13
    v_mov_b32 v15, v63
    v_mov_b32 v14, v63
    s_nop 1
    v_permlane32_swap_b32 v15, v14
    v_mov_b32 v15, v14
    s_nop 1
    v_permlane16_swap_b32 v15, v14
    v_mov_b32 v13, v12
    s_nop 1
    v_permlane32_swap_b32 v12, v13
    v_add_f32 v12, v12, v13
    v_mov_b32 v13, v12
    s_nop 1
    v_permlane16_swap_b32 v12, v13
    v_add_f32 v12, v12, v13
    v_fma_f32 v12, v12, s50, -v14
    v_mul_f32 v12, s41, v12
    v_pk_add_f32 v[32:33], v[32:33], v[12:13] op_sel_hi:[1,0]
    v_pk_add_f32 v[34:35], v[34:35], v[12:13] op_sel_hi:[1,0]
    v_pk_add_f32 v[36:37], v[36:37], v[12:13] op_sel_hi:[1,0]
    v_pk_add_f32 v[38:39], v[38:39], v[12:13] op_sel_hi:[1,0]
    v_pk_add_f32 v[40:41], v[40:41], v[12:13] op_sel_hi:[1,0]
    v_pk_add_f32 v[42:43], v[42:43], v[12:13] op_sel_hi:[1,0]
    v_pk_add_f32 v[44:45], v[44:45], v[12:13] op_sel_hi:[1,0]
    v_pk_add_f32 v[46:47], v[46:47], v[12:13] op_sel_hi:[1,0]
    v_pk_add_f32 v[48:49], v[48:49], v[12:13] op_sel_hi:[1,0]
    v_pk_add_f32 v[50:51], v[50:51], v[12:13] op_sel_hi:[1,0]
    v_pk_add_f32 v[52:53], v[52:53], v[12:13] op_sel_hi:[1,0]
    v_pk_add_f32 v[54:55], v[54:55], v[12:13] op_sel_hi:[1,0]
    v_pk_add_f32 v[56:57], v[56:57], v[12:13] op_sel_hi:[1,0]
    v_pk_add_f32 v[58:59], v[58:59], v[12:13] op_sel_hi:[1,0]
    v_pk_add_f32 v[60:61], v[60:61], v[12:13] op_sel_hi:[1,0]
    v_pk_add_f32 v[62:63], v[62:63], v[12:13] op_sel_hi:[1,0]
    v_cndmask_b32 v63, v63, 0, s[48:49]
    v_cvt_pk_bf16_f32 v16, v32, v33
    v_cvt_pk_bf16_f32 v17, v34, v35
    v_cvt_pk_bf16_f32 v18, v36, v37
    v_cvt_pk_bf16_f32 v19, v38, v39
    v_cvt_pk_bf16_f32 v20, v40, v41
    v_cvt_pk_bf16_f32 v21, v42, v43
    v_cvt_pk_bf16_f32 v22, v44, v45
    v_cvt_pk_bf16_f32 v23, v46, v47
    v_cvt_pk_bf16_f32 v24, v48, v49
    v_cvt_pk_bf16_f32 v25, v50, v51
    v_cvt_pk_bf16_f32 v26, v52, v53
    v_cvt_pk_bf16_f32 v27, v54, v55
    v_cvt_pk_bf16_f32 v28, v56, v57
    v_cvt_pk_bf16_f32 v29, v58, v59
    v_cvt_pk_bf16_f32 v30, v60, v61
    v_cvt_pk_bf16_f32 v31, v62, v63
    s_waitcnt lgkmcnt(0)
    s_add_u32 s68, s4, 0x500000
    s_addc_u32 s69, s5, 0
    s_mov_b32 s70, 0x10000
    s_mov_b32 s71, 0x20000
    buffer_store_dwordx4 v[16:19], v1, s[68:71], s43 offen offset:0 sc1
    buffer_store_dwordx4 v[20:23], v1, s[68:71], s43 offen offset:1024 sc1
    buffer_store_dwordx4 v[24:27], v1, s[68:71], s43 offen offset:2048 sc1
    buffer_store_dwordx4 v[28:31], v1, s[68:71], s43 offen offset:3072 sc1
    s_branch L_km_jobdone
L_km_sort:
    s_lshl_b32 s38, s38, 3
    s_add_u32 s40, s36, s38
    s_load_dwordx4 s[68:71], s[0:1], 8
    s_mul_i32 s41, s40, 10000
    v_mov_b32 v12, 0
    v_mov_b32 v13, 0
    v_mov_b32 v14, 0
    v_mov_b32 v15, 0
    v_add_u32 v5, 73728, v1
    ds_write_b128 v5, v[12:15] offset:0
    ds_write_b128 v5, v[12:15] offset:1024
    ds_write_b128 v5, v[12:15] offset:2048
    ds_write_b128 v5, v[12:15] offset:3072
    s_waitcnt lgkmcnt(0)
    s_add_u32 s60, s70, s41
    s_addc_u32 s61, s71, 0
    s_mov_b32 s62, 10000
    s_mov_b32 s63, 0x20000
    s_add_u32 s64, s68, s41
    s_addc_u32 s65, s69, 0
    s_mov_b32 s66, 10000
    s_mov_b32 s67, 0x20000
    s_mov_b32 s48, 4096
    s_mov_b32 s49, 8192
    s_load_dword s70, s[60:61], 0
    s_load_dword s71, s[64:65], 0
    v_mov_b32 v6, 1
    v_cmp_gt_u32 vcc, 49, v0
    s_mov_b64 s[42:43], vcc
    s_add_u32 s36, s41, 0x560000
    s_lshl_b32 s38, s40, 12
    s_add_u32 s38, s38, 0x520000
    s_mov_b32 s40, 0xe0
    s_mov_b32 s41, 0x90
    v_lshlrev_b32 v5, 6, v0
    v_add_u32 v5, 73728, v5
    s_mov_b32 s50, 73728
    s_barrier
    buffer_load_dwordx4 v[16:19], v1, s[60:63], 0 offen offset:0
    buffer_load_dwordx4 v[20:23], v1, s[60:63], 0 offen offset:1024
    buffer_load_dwordx4 v[24:27], v1, s[60:63], 0 offen offset:2048
    buffer_load_dwordx4 v[28:31], v1, s[60:63], 0 offen offset:3072
    buffer_load_dwordx4 v[32:35], v1, s[60:63], s48 offen offset:0
    buffer_load_dwordx4 v[36:39], v1, s[60:63], s48 offen offset:1024
    buffer_load_dwordx4 v[40:43], v1, s[60:63], s48 offen offset:2048
    buffer_load_dwordx4 v[44:47], v1, s[60:63], s48 offen offset:3072
    buffer_load_dwordx4 v[48:51], v1, s[60:63], s49 offen offset:0
    buffer_load_dwordx4 v[52:55], v1, s[60:63], s49 offen offset:1024
    buffer_load_dwordx4 v[56:59], v1, s[64:67], 0 offen offset:0
    buffer_load_dwordx4 v[60:63], v1, s[64:67], 0 offen offset:1024
    buffer_load_dwordx4 v[64:67], v1, s[64:67], 0 offen offset:2048
    buffer_load_dwordx4 v[68:71], v1, s[64:67], 0 offen offset:3072
    buffer_load_dwordx4 v[72:75], v1, s[64:67], s48 offen offset:0
    buffer_load_dwordx4 v[76:79], v1, s[64:67], s48 offen offset:1024
    buffer_load_dwordx4 v[80:83], v1, s[64:67], s48 offen offset:2048
    buffer_load_dwordx4 v[84:87], v1, s[64:67], s48 offen offset:3072
    buffer_load_dwordx4 v[88:91], v1, s[64:67], s49 offen offset:0
    buffer_load_dwordx4 v[92:95], v1, s[64:67], s49 offen offset:1024
    buffer_load_dword v241, v240, s[12:15], s51 offen
    s_barrier
    s_waitcnt vmcnt(19)
    v_mul_u32_u24 v96, 6554, v16
    v_lshrrev_b32 v96, 16, v96
    v_mad_i32_i24 v16, v96, -10, v16
    v_lshl_add_u32 v96, v96, 2, s50
    v_mul_u32_u24 v97, 6554, v17
    v_lshrrev_b32 v97, 16, v97
    v_mad_i32_i24 v17, v97, -10, v17
    v_lshl_add_u32 v97, v97, 2, s50
    v_mul_u32_u24 v98, 6554, v18
    v_lshrrev_b32 v98, 16, v98
    v_mad_i32_i24 v18, v98, -10, v18
    v_lshl_add_u32 v98, v98, 2, s50
    v_mul_u32_u24 v99, 6554, v19
    v_lshrrev_b32 v99, 16, v99
    v_mad_i32_i24 v19, v99, -10, v19
    v_lshl_add_u32 v99, v99, 2, s50
    v_mul_u32_u24 v100, 6554, v20
    v_lshrrev_b32 v100, 16, v100
    v_mad_i32_i24 v20, v100, -10, v20
    v_lshl_add_u32 v100, v100, 2, s50
    v_mul_u32_u24 v101, 6554, v21
    v_lshrrev_b32 v101, 16, v101
    v_mad_i32_i24 v21, v101, -10, v21
    v_lshl_add_u32 v101, v101, 2, s50
    v_mul_u32_u24 v102, 6554, v22
    v_lshrrev_b32 v102, 16, v102
    v_mad_i32_i24 v22, v102, -10, v22
    v_lshl_add_u32 v102, v102, 2, s50
    v_mul_u32_u24 v103, 6554, v23
    v_lshrrev_b32 v103, 16, v103
    v_mad_i32_i24 v23, v103, -10, v23
    v_lshl_add_u32 v103, v103, 2, s50
    ds_add_rtn_u32 v136, v96, v6
    ds_add_rtn_u32 v137, v97, v6
    ds_add_rtn_u32 v138, v98, v6
    ds_add_rtn_u32 v139, v99, v6
    ds_add_rtn_u32 v140, v100, v6
    ds_add_rtn_u32 v141, v101, v6
    ds_add_rtn_u32 v142, v102, v6
    ds_add_rtn_u32 v143, v103, v6
    s_waitcnt vmcnt(17)
    v_mul_u32_u24 v104, 6554, v24
    v_lshrrev_b32 v104, 16, v104
    v_mad_i32_i24 v24, v104, -10, v24
    v_lshl_add_u32 v104, v104, 2, s50
    v_mul_u32_u24 v105, 6554, v25
    v_lshrrev_b32 v105, 16, v105
    v_mad_i32_i24 v25, v105, -10, v25
    v_lshl_add_u32 v105, v105, 2, s50
    v_mul_u32_u24 v106, 6554, v26
    v_lshrrev_b32 v106, 16, v106
    v_mad_i32_i24 v26, v106, -10, v26
    v_lshl_add_u32 v106, v106, 2, s50
    v_mul_u32_u24 v107, 6554, v27
    v_lshrrev_b32 v107, 16, v107
    v_mad_i32_i24 v27, v107, -10, v27
    v_lshl_add_u32 v107, v107, 2, s50
    v_mul_u32_u24 v108, 6554, v28
    v_lshrrev_b32 v108, 16, v108
    v_mad_i32_i24 v28, v108, -10, v28
    v_lshl_add_u32 v108, v108, 2, s50
    v_mul_u32_u24 v109, 6554, v29
    v_lshrrev_b32 v109, 16, v109
    v_mad_i32_i24 v29, v109, -10, v29
    v_lshl_add_u32 v109, v109, 2, s50
    v_mul_u32_u24 v110, 6554, v30
    v_lshrrev_b32 v110, 16, v110
    v_mad_i32_i24 v30, v110, -10, v30
    v_lshl_add_u32 v110, v110, 2, s50
    v_mul_u32_u24 v111, 6554, v31
    v_lshrrev_b32 v111, 16, v111
    v_mad_i32_i24 v31, v111, -10, v31
    v_lshl_add_u32 v111, v111, 2, s50
    ds_add_rtn_u32 v144, v104, v6
    ds_add_rtn_u32 v145, v105, v6
    ds_add_rtn_u32 v146, v106, v6
    ds_add_rtn_u32 v147, v107, v6
    ds_add_rtn_u32 v148, v108, v6
    ds_add_rtn_u32 v149, v109, v6
    ds_add_rtn_u32 v150, v110, v6
    ds_add_rtn_u32 v151, v111, v6
    s_waitcnt vmcnt(15)
    v_mul_u32_u24 v112, 6554, v32
    v_lshrrev_b32 v112, 16, v112
    v_mad_i32_i24 v32, v112, -10, v32
    v_lshl_add_u32 v112, v112, 2, s50
    v_mul_u32_u24 v113, 6554, v33
    v_lshrrev_b32 v113, 16, v113
    v_mad_i32_i24 v33, v113, -10, v33
    v_lshl_add_u32 v113, v113, 2, s50
    v_mul_u32_u24 v114, 6554, v34
    v_lshrrev_b32 v114, 16, v114
    v_mad_i32_i24 v34, v114, -10, v34
    v_lshl_add_u32 v114, v114, 2, s50
    v_mul_u32_u24 v115, 6554, v35
    v_lshrrev_b32 v115, 16, v115
    v_mad_i32_i24 v35, v115, -10, v35
    v_lshl_add_u32 v115, v115, 2, s50
    v_mul_u32_u24 v116, 6554, v36
    v_lshrrev_b32 v116, 16, v116
    v_mad_i32_i24 v36, v116, -10, v36
    v_lshl_add_u32 v116, v116, 2, s50
    v_mul_u32_u24 v117, 6554, v37
    v_lshrrev_b32 v117, 16, v117
    v_mad_i32_i24 v37, v117, -10, v37
    v_lshl_add_u32 v117, v117, 2, s50
    v_mul_u32_u24 v118, 6554, v38
    v_lshrrev_b32 v118, 16, v118
    v_mad_i32_i24 v38, v118, -10, v38
    v_lshl_add_u32 v118, v118, 2, s50
    v_mul_u32_u24 v119, 6554, v39
    v_lshrrev_b32 v119, 16, v119
    v_mad_i32_i24 v39, v119, -10, v39
    v_lshl_add_u32 v119, v119, 2, s50
    ds_add_rtn_u32 v152, v112, v6
    ds_add_rtn_u32 v153, v113, v6
    ds_add_rtn_u32 v154, v114, v6
    ds_add_rtn_u32 v155, v115, v6
    ds_add_rtn_u32 v156, v116, v6
    ds_add_rtn_u32 v157, v117, v6
    ds_add_rtn_u32 v158, v118, v6
    ds_add_rtn_u32 v159, v119, v6
    s_waitcnt vmcnt(13)
    v_mul_u32_u24 v120, 6554, v40
    v_lshrrev_b32 v120, 16, v120
    v_mad_i32_i24 v40, v120, -10, v40
    v_lshl_add_u32 v120, v120, 2, s50
    v_mul_u32_u24 v121, 6554, v41
    v_lshrrev_b32 v121, 16, v121
    v_mad_i32_i24 v41, v121, -10, v41
    v_lshl_add_u32 v121, v121, 2, s50
    v_mul_u32_u24 v122, 6554, v42
    v_lshrrev_b32 v122, 16, v122
    v_mad_i32_i24 v42, v122, -10, v42
    v_lshl_add_u32 v122, v122, 2, s50
    v_mul_u32_u24 v123, 6554, v43
    v_lshrrev_b32 v123, 16, v123
    v_mad_i32_i24 v43, v123, -10, v43
    v_lshl_add_u32 v123, v123, 2, s50
    v_mul_u32_u24 v124, 6554, v44
    v_lshrrev_b32 v124, 16, v124
    v_mad_i32_i24 v44, v124, -10, v44
    v_lshl_add_u32 v124, v124, 2, s50
    v_mul_u32_u24 v125, 6554, v45
    v_lshrrev_b32 v125, 16, v125
    v_mad_i32_i24 v45, v125, -10, v45
    v_lshl_add_u32 v125, v125, 2, s50
    v_mul_u32_u24 v126, 6554, v46
    v_lshrrev_b32 v126, 16, v126
    v_mad_i32_i24 v46, v126, -10, v46
    v_lshl_add_u32 v126, v126, 2, s50
    v_mul_u32_u24 v127, 6554, v47
    v_lshrrev_b32 v127, 16, v127
    v_mad_i32_i24 v47, v127, -10, v47
    v_lshl_add_u32 v127, v127, 2, s50
    ds_add_rtn_u32 v160, v120, v6
    ds_add_rtn_u32 v161, v121, v6
    ds_add_rtn_u32 v162, v122, v6
    ds_add_rtn_u32 v163, v123, v6
    ds_add_rtn_u32 v164, v124, v6
    ds_add_rtn_u32 v165, v125, v6
    ds_add_rtn_u32 v166, v126, v6
    ds_add_rtn_u32 v167, v127, v6
    s_waitcnt vmcnt(11)
    v_mul_u32_u24 v128, 6554, v48
    v_lshrrev_b32 v128, 16, v128
    v_mad_i32_i24 v48, v128, -10, v48
    v_lshl_add_u32 v128, v128, 2, s50
    v_mul_u32_u24 v129, 6554, v49
    v_lshrrev_b32 v129, 16, v129
    v_mad_i32_i24 v49, v129, -10, v49
    v_lshl_add_u32 v129, v129, 2, s50
    v_mul_u32_u24 v130, 6554, v50
    v_lshrrev_b32 v130, 16, v130
    v_mad_i32_i24 v50, v130, -10, v50
    v_lshl_add_u32 v130, v130, 2, s50
    v_mul_u32_u24 v131, 6554, v51
    v_lshrrev_b32 v131, 16, v131
    v_mad_i32_i24 v51, v131, -10, v51
    v_lshl_add_u32 v131, v131, 2, s50
    v_mul_u32_u24 v132, 6554, v52
    v_lshrrev_b32 v132, 16, v132
    v_mad_i32_i24 v52, v132, -10, v52
    v_lshl_add_u32 v132, v132, 2, s50
    v_mul_u32_u24 v133, 6554, v53
    v_lshrrev_b32 v133, 16, v133
    v_mad_i32_i24 v53, v133, -10, v53
    v_lshl_add_u32 v133, v133, 2, s50
    v_mul_u32_u24 v134, 6554, v54
    v_lshrrev_b32 v134, 16, v134
    v_mad_i32_i24 v54, v134, -10, v54
    v_lshl_add_u32 v134, v134, 2, s50
    v_mul_u32_u24 v135, 6554, v55
    v_lshrrev_b32 v135, 16, v135
    v_mad_i32_i24 v55, v135, -10, v55
    v_lshl_add_u32 v135, v135, 2, s50
    ds_add_rtn_u32 v168, v128, v6
    ds_add_rtn_u32 v169, v129, v6
    ds_add_rtn_u32 v170, v130, v6
    ds_add_rtn_u32 v171, v131, v6
    s_mov_b64 exec, s[42:43]
    ds_add_rtn_u32 v172, v132, v6
    ds_add_rtn_u32 v173, v133, v6
    ds_add_rtn_u32 v174, v134, v6
    ds_add_rtn_u32 v175, v135, v6
    s_mov_b64 exec, -1
    ds_read_b128 v[176:179], v5 offset:0
    ds_read_b128 v[180:183], v5 offset:16
    ds_read_b128 v[184:187], v5 offset:32
    ds_read_b128 v[188:191], v5 offset:48
    s_waitcnt vmcnt(1)
    v_lshlrev_b32 v7, 5, v56
    v_bfe_i32 v8, v56, 3, 1
    v_lshlrev_b32 v56, 8, v56
    v_lshl_or_b32 v16, v16, 28, v56
    v_and_or_b32 v16, v7, s40, v16
    v_bitop3_b32 v16, v8, s41, v16 bitop3:0x6a
    v_lshlrev_b32 v7, 5, v57
    v_bfe_i32 v8, v57, 3, 1
    v_lshlrev_b32 v57, 8, v57
    v_lshl_or_b32 v17, v17, 28, v57
    v_and_or_b32 v17, v7, s40, v17
    v_bitop3_b32 v17, v8, s41, v17 bitop3:0x6a
    v_lshlrev_b32 v7, 5, v58
    v_bfe_i32 v8, v58, 3, 1
    v_lshlrev_b32 v58, 8, v58
    v_lshl_or_b32 v18, v18, 28, v58
    v_and_or_b32 v18, v7, s40, v18
    v_bitop3_b32 v18, v8, s41, v18 bitop3:0x6a
    v_lshlrev_b32 v7, 5, v59
    v_bfe_i32 v8, v59, 3, 1
    v_lshlrev_b32 v59, 8, v59
    v_lshl_or_b32 v19, v19, 28, v59
    v_and_or_b32 v19, v7, s40, v19
    v_bitop3_b32 v19, v8, s41, v19 bitop3:0x6a
    v_lshlrev_b32 v7, 5, v60
    v_bfe_i32 v8, v60, 3, 1
    v_lshlrev_b32 v60, 8, v60
    v_lshl_or_b32 v20, v20, 28, v60
    v_and_or_b32 v20, v7, s40, v20
    v_bitop3_b32 v20, v8, s41, v20 bitop3:0x6a
    v_lshlrev_b32 v7, 5, v61
    v_bfe_i32 v8, v61, 3, 1
    v_lshlrev_b32 v61, 8, v61
    v_lshl_or_b32 v21, v21, 28, v61
    v_and_or_b32 v21, v7, s40, v21
    v_bitop3_b32 v21, v8, s41, v21 bitop3:0x6a
    v_lshlrev_b32 v7, 5, v62
    v_bfe_i32 v8, v62, 3, 1
    v_lshlrev_b32 v62, 8, v62
    v_lshl_or_b32 v22, v22, 28, v62
    v_and_or_b32 v22, v7, s40, v22
    v_bitop3_b32 v22, v8, s41, v22 bitop3:0x6a
    v_lshlrev_b32 v7, 5, v63
    v_bfe_i32 v8, v63, 3, 1
    v_lshlrev_b32 v63, 8, v63
    v_lshl_or_b32 v23, v23, 28, v63
    v_and_or_b32 v23, v7, s40, v23
    v_bitop3_b32 v23, v8, s41, v23 bitop3:0x6a
    v_lshlrev_b32 v7, 5, v64
    v_bfe_i32 v8, v64, 3, 1
    v_lshlrev_b32 v64, 8, v64
    v_lshl_or_b32 v24, v24, 28, v64
    v_and_or_b32 v24, v7, s40, v24
    v_bitop3_b32 v24, v8, s41, v24 bitop3:0x6a
    v_lshlrev_b32 v7, 5, v65
    v_bfe_i32 v8, v65, 3, 1
    v_lshlrev_b32 v65, 8, v65
    v_lshl_or_b32 v25, v25, 28, v65
    v_and_or_b32 v25, v7, s40, v25
    v_bitop3_b32 v25, v8, s41, v25 bitop3:0x6a
    v_lshlrev_b32 v7, 5, v66
    v_bfe_i32 v8, v66, 3, 1
    v_lshlrev_b32 v66, 8, v66
    v_lshl_or_b32 v26, v26, 28, v66
    v_and_or_b32 v26, v7, s40, v26
    v_bitop3_b32 v26, v8, s41, v26 bitop3:0x6a
    v_lshlrev_b32 v7, 5, v67
    v_bfe_i32 v8, v67, 3, 1
    v_lshlrev_b32 v67, 8, v67
    v_lshl_or_b32 v27, v27, 28, v67
    v_and_or_b32 v27, v7, s40, v27
    v_bitop3_b32 v27, v8, s41, v27 bitop3:0x6a
    v_lshlrev_b32 v7, 5, v68
    v_bfe_i32 v8, v68, 3, 1
    v_lshlrev_b32 v68, 8, v68
    v_lshl_or_b32 v28, v28, 28, v68
    v_and_or_b32 v28, v7, s40, v28
    v_bitop3_b32 v28, v8, s41, v28 bitop3:0x6a
    v_lshlrev_b32 v7, 5, v69
    v_bfe_i32 v8, v69, 3, 1
    v_lshlrev_b32 v69, 8, v69
    v_lshl_or_b32 v29, v29, 28, v69
    v_and_or_b32 v29, v7, s40, v29
    v_bitop3_b32 v29, v8, s41, v29 bitop3:0x6a
    v_lshlrev_b32 v7, 5, v70
    v_bfe_i32 v8, v70, 3, 1
    v_lshlrev_b32 v70, 8, v70
    v_lshl_or_b32 v30, v30, 28, v70
    v_and_or_b32 v30, v7, s40, v30
    v_bitop3_b32 v30, v8, s41, v30 bitop3:0x6a
    v_lshlrev_b32 v7, 5, v71
    v_bfe_i32 v8, v71, 3, 1
    v_lshlrev_b32 v71, 8, v71
    v_lshl_or_b32 v31, v31, 28, v71
    v_and_or_b32 v31, v7, s40, v31
    v_bitop3_b32 v31, v8, s41, v31 bitop3:0x6a
    s_add_u32 s64, s4, s36
    s_addc_u32 s65, s5, 0
    s_add_u32 s60, s4, s38
    s_addc_u32 s61, s5, 0
    s_mov_b32 s62, 4096
    s_waitcnt lgkmcnt(0)
    v_mov_b32 v192, 0
    v_add_u32 v193, v192, v176
    v_add_u32 v194, v193, v177
    v_add_u32 v195, v194, v178
    v_add_u32 v196, v195, v179
    v_add_u32 v197, v196, v180
    v_add_u32 v198, v197, v181
    v_add_u32 v199, v198, v182
    v_add_u32 v200, v199, v183
    v_add_u32 v201, v200, v184
    v_add_u32 v202, v201, v185
    v_add_u32 v203, v202, v186
    v_add_u32 v204, v203, v187
    v_add_u32 v205, v204, v188
    v_add_u32 v206, v205, v189
    v_add_u32 v207, v206, v190
    v_add_u32 v7, v207, v191
    v_mov_b32 v8, v7
    s_nop 1
    v_add_u32_dpp v8, v8, v8 row_shr:1 row_mask:0xf bank_mask:0xf
    s_nop 1
    v_add_u32_dpp v8, v8, v8 row_shr:2 row_mask:0xf bank_mask:0xf
    s_nop 1
    v_add_u32_dpp v8, v8, v8 row_shr:4 row_mask:0xf bank_mask:0xf
    s_nop 1
    v_add_u32_dpp v8, v8, v8 row_shr:8 row_mask:0xf bank_mask:0xf
    s_nop 1
    v_add_u32_dpp v8, v8, v8 row_bcast:15 row_mask:0xa bank_mask:0xf
    s_nop 1
    v_add_u32_dpp v8, v8, v8 row_bcast:31 row_mask:0xc bank_mask:0xf
    v_sub_u32 v8, v8, v7
    v_add_u32 v192, v192, v8
    v_lshl_or_b32 v176, v176, 16, v192
    v_add_u32 v193, v193, v8
    v_lshl_or_b32 v177, v177, 16, v193
    v_add_u32 v194, v194, v8
    v_lshl_or_b32 v178, v178, 16, v194
    v_add_u32 v195, v195, v8
    v_lshl_or_b32 v179, v179, 16, v195
    v_add_u32 v196, v196, v8
    v_lshl_or_b32 v180, v180, 16, v196
    v_add_u32 v197, v197, v8
    v_lshl_or_b32 v181, v181, 16, v197
    v_add_u32 v198, v198, v8
    v_lshl_or_b32 v182, v182, 16, v198
    v_add_u32 v199, v199, v8
    v_lshl_or_b32 v183, v183, 16, v199
    v_add_u32 v200, v200, v8
    v_lshl_or_b32 v184, v184, 16, v200
    v_add_u32 v201, v201, v8
    v_lshl_or_b32 v185, v185, 16, v201
    v_add_u32 v202, v202, v8
    v_lshl_or_b32 v186, v186, 16, v202
    v_add_u32 v203, v203, v8
    v_lshl_or_b32 v187, v187, 16, v203
    v_add_u32 v204, v204, v8
    v_lshl_or_b32 v188, v188, 16, v204
    v_add_u32 v205, v205, v8
    v_lshl_or_b32 v189, v189, 16, v205
    v_add_u32 v206, v206, v8
    v_lshl_or_b32 v190, v190, 16, v206
    v_add_u32 v207, v207, v8
    v_lshl_or_b32 v191, v191, 16, v207
    ds_write_b128 v5, v[176:179] offset:0
    ds_write_b128 v5, v[180:183] offset:16
    ds_write_b128 v5, v[184:187] offset:32
    ds_write_b128 v5, v[188:191] offset:48
    v_add_u32 v9, 73728, v1
    ds_read_b128 v[192:195], v9 offset:0
    ds_read_b128 v[196:199], v9 offset:1024
    ds_read_b128 v[200:203], v9 offset:2048
    ds_read_b128 v[204:207], v9 offset:3072
    ds_read_u16 v96, v96
    ds_read_u16 v97, v97
    ds_read_u16 v98, v98
    ds_read_u16 v99, v99
    ds_read_u16 v100, v100
    ds_read_u16 v101, v101
    ds_read_u16 v102, v102
    ds_read_u16 v103, v103
    ds_read_u16 v104, v104
    ds_read_u16 v105, v105
    ds_read_u16 v106, v106
    ds_read_u16 v107, v107
    ds_read_u16 v108, v108
    ds_read_u16 v109, v109
    ds_read_u16 v110, v110
    ds_read_u16 v111, v111
    ds_read_u16 v112, v112
    ds_read_u16 v113, v113
    ds_read_u16 v114, v114
    ds_read_u16 v115, v115
    ds_read_u16 v116, v116
    ds_read_u16 v117, v117
    ds_read_u16 v118, v118
    ds_read_u16 v119, v119
    ds_read_u16 v120, v120
    ds_read_u16 v121, v121
    ds_read_u16 v122, v122
    ds_read_u16 v123, v123
    ds_read_u16 v124, v124
    ds_read_u16 v125, v125
    ds_read_u16 v126, v126
    ds_read_u16 v127, v127
    ds_read_u16 v128, v128
    ds_read_u16 v129, v129
    ds_read_u16 v130, v130
    ds_read_u16 v131, v131
    ds_read_u16 v132, v132
    ds_read_u16 v133, v133
    ds_read_u16 v134, v134
    ds_read_u16 v135, v135
    v_lshlrev_b32 v7, 5, v72
    v_bfe_i32 v8, v72, 3, 1
    v_lshlrev_b32 v72, 8, v72
    v_lshl_or_b32 v32, v32, 28, v72
    v_and_or_b32 v32, v7, s40, v32
    v_bitop3_b32 v32, v8, s41, v32 bitop3:0x6a
    v_lshlrev_b32 v7, 5, v73
    v_bfe_i32 v8, v73, 3, 1
    v_lshlrev_b32 v73, 8, v73
    v_lshl_or_b32 v33, v33, 28, v73
    v_and_or_b32 v33, v7, s40, v33
    v_bitop3_b32 v33, v8, s41, v33 bitop3:0x6a
    v_lshlrev_b32 v7, 5, v74
    v_bfe_i32 v8, v74, 3, 1
    v_lshlrev_b32 v74, 8, v74
    v_lshl_or_b32 v34, v34, 28, v74
    v_and_or_b32 v34, v7, s40, v34
    v_bitop3_b32 v34, v8, s41, v34 bitop3:0x6a
    v_lshlrev_b32 v7, 5, v75
    v_bfe_i32 v8, v75, 3, 1
    v_lshlrev_b32 v75, 8, v75
    v_lshl_or_b32 v35, v35, 28, v75
    v_and_or_b32 v35, v7, s40, v35
    v_bitop3_b32 v35, v8, s41, v35 bitop3:0x6a
    v_lshlrev_b32 v7, 5, v76
    v_bfe_i32 v8, v76, 3, 1
    v_lshlrev_b32 v76, 8, v76
    v_lshl_or_b32 v36, v36, 28, v76
    v_and_or_b32 v36, v7, s40, v36
    v_bitop3_b32 v36, v8, s41, v36 bitop3:0x6a
    v_lshlrev_b32 v7, 5, v77
    v_bfe_i32 v8, v77, 3, 1
    v_lshlrev_b32 v77, 8, v77
    v_lshl_or_b32 v37, v37, 28, v77
    v_and_or_b32 v37, v7, s40, v37
    v_bitop3_b32 v37, v8, s41, v37 bitop3:0x6a
    v_lshlrev_b32 v7, 5, v78
    v_bfe_i32 v8, v78, 3, 1
    v_lshlrev_b32 v78, 8, v78
    v_lshl_or_b32 v38, v38, 28, v78
    v_and_or_b32 v38, v7, s40, v38
    v_bitop3_b32 v38, v8, s41, v38 bitop3:0x6a
    v_lshlrev_b32 v7, 5, v79
    v_bfe_i32 v8, v79, 3, 1
    v_lshlrev_b32 v79, 8, v79
    v_lshl_or_b32 v39, v39, 28, v79
    v_and_or_b32 v39, v7, s40, v39
    v_bitop3_b32 v39, v8, s41, v39 bitop3:0x6a
    v_lshlrev_b32 v7, 5, v80
    v_bfe_i32 v8, v80, 3, 1
    v_lshlrev_b32 v80, 8, v80
    v_lshl_or_b32 v40, v40, 28, v80
    v_and_or_b32 v40, v7, s40, v40
    v_bitop3_b32 v40, v8, s41, v40 bitop3:0x6a
    v_lshlrev_b32 v7, 5, v81
    v_bfe_i32 v8, v81, 3, 1
    v_lshlrev_b32 v81, 8, v81
    v_lshl_or_b32 v41, v41, 28, v81
    v_and_or_b32 v41, v7, s40, v41
    v_bitop3_b32 v41, v8, s41, v41 bitop3:0x6a
    v_lshlrev_b32 v7, 5, v82
    v_bfe_i32 v8, v82, 3, 1
    v_lshlrev_b32 v82, 8, v82
    v_lshl_or_b32 v42, v42, 28, v82
    v_and_or_b32 v42, v7, s40, v42
    v_bitop3_b32 v42, v8, s41, v42 bitop3:0x6a
    v_lshlrev_b32 v7, 5, v83
    v_bfe_i32 v8, v83, 3, 1
    v_lshlrev_b32 v83, 8, v83
    v_lshl_or_b32 v43, v43, 28, v83
    v_and_or_b32 v43, v7, s40, v43
    v_bitop3_b32 v43, v8, s41, v43 bitop3:0x6a
    v_lshlrev_b32 v7, 5, v84
    v_bfe_i32 v8, v84, 3, 1
    v_lshlrev_b32 v84, 8, v84
    v_lshl_or_b32 v44, v44, 28, v84
    v_and_or_b32 v44, v7, s40, v44
    v_bitop3_b32 v44, v8, s41, v44 bitop3:0x6a
    v_lshlrev_b32 v7, 5, v85
    v_bfe_i32 v8, v85, 3, 1
    v_lshlrev_b32 v85, 8, v85
    v_lshl_or_b32 v45, v45, 28, v85
    v_and_or_b32 v45, v7, s40, v45
    v_bitop3_b32 v45, v8, s41, v45 bitop3:0x6a
    v_lshlrev_b32 v7, 5, v86
    v_bfe_i32 v8, v86, 3, 1
    v_lshlrev_b32 v86, 8, v86
    v_lshl_or_b32 v46, v46, 28, v86
    v_and_or_b32 v46, v7, s40, v46
    v_bitop3_b32 v46, v8, s41, v46 bitop3:0x6a
    v_lshlrev_b32 v7, 5, v87
    v_bfe_i32 v8, v87, 3, 1
    v_lshlrev_b32 v87, 8, v87
    v_lshl_or_b32 v47, v47, 28, v87
    v_and_or_b32 v47, v7, s40, v47
    v_bitop3_b32 v47, v8, s41, v47 bitop3:0x6a
    v_lshlrev_b32 v7, 5, v88
    v_bfe_i32 v8, v88, 3, 1
    v_lshlrev_b32 v88, 8, v88
    v_lshl_or_b32 v48, v48, 28, v88
    v_and_or_b32 v48, v7, s40, v48
    v_bitop3_b32 v48, v8, s41, v48 bitop3:0x6a
    v_lshlrev_b32 v7, 5, v89
    v_bfe_i32 v8, v89, 3, 1
    v_lshlrev_b32 v89, 8, v89
    v_lshl_or_b32 v49, v49, 28, v89
    v_and_or_b32 v49, v7, s40, v49
    v_bitop3_b32 v49, v8, s41, v49 bitop3:0x6a
    v_lshlrev_b32 v7, 5, v90
    v_bfe_i32 v8, v90, 3, 1
    v_lshlrev_b32 v90, 8, v90
    v_lshl_or_b32 v50, v50, 28, v90
    v_and_or_b32 v50, v7, s40, v50
    v_bitop3_b32 v50, v8, s41, v50 bitop3:0x6a
    v_lshlrev_b32 v7, 5, v91
    v_bfe_i32 v8, v91, 3, 1
    v_lshlrev_b32 v91, 8, v91
    v_lshl_or_b32 v51, v51, 28, v91
    v_and_or_b32 v51, v7, s40, v51
    v_bitop3_b32 v51, v8, s41, v51 bitop3:0x6a
    v_lshlrev_b32 v7, 5, v92
    v_bfe_i32 v8, v92, 3, 1
    v_lshlrev_b32 v92, 8, v92
    v_lshl_or_b32 v52, v52, 28, v92
    v_and_or_b32 v52, v7, s40, v52
    v_bitop3_b32 v52, v8, s41, v52 bitop3:0x6a
    v_lshlrev_b32 v7, 5, v93
    v_bfe_i32 v8, v93, 3, 1
    v_lshlrev_b32 v93, 8, v93
    v_lshl_or_b32 v53, v53, 28, v93
    v_and_or_b32 v53, v7, s40, v53
    v_bitop3_b32 v53, v8, s41, v53 bitop3:0x6a
    v_lshlrev_b32 v7, 5, v94
    v_bfe_i32 v8, v94, 3, 1
    v_lshlrev_b32 v94, 8, v94
    v_lshl_or_b32 v54, v54, 28, v94
    v_and_or_b32 v54, v7, s40, v54
    v_bitop3_b32 v54, v8, s41, v54 bitop3:0x6a
    v_lshlrev_b32 v7, 5, v95
    v_bfe_i32 v8, v95, 3, 1
    v_lshlrev_b32 v95, 8, v95
    v_lshl_or_b32 v55, v55, 28, v95
    v_and_or_b32 v55, v7, s40, v55
    v_bitop3_b32 v55, v8, s41, v55 bitop3:0x6a
    s_waitcnt lgkmcnt(0)
    buffer_store_dwordx4 v[192:195], v1, s[60:63], 0 offen offset:0 sc1
    buffer_store_dwordx4 v[196:199], v1, s[60:63], 0 offen offset:1024 sc1
    buffer_store_dwordx4 v[200:203], v1, s[60:63], 0 offen offset:2048 sc1
    buffer_store_dwordx4 v[204:207], v1, s[60:63], 0 offen offset:3072 sc1
    s_mov_b32 s50, 77824
    v_add_u32 v96, v96, v136
    v_lshl_add_u32 v96, v96, 2, s50
    v_add_u32 v97, v97, v137
    v_lshl_add_u32 v97, v97, 2, s50
    v_add_u32 v98, v98, v138
    v_lshl_add_u32 v98, v98, 2, s50
    v_add_u32 v99, v99, v139
    v_lshl_add_u32 v99, v99, 2, s50
    v_add_u32 v100, v100, v140
    v_lshl_add_u32 v100, v100, 2, s50
    v_add_u32 v101, v101, v141
    v_lshl_add_u32 v101, v101, 2, s50
    v_add_u32 v102, v102, v142
    v_lshl_add_u32 v102, v102, 2, s50
    v_add_u32 v103, v103, v143
    v_lshl_add_u32 v103, v103, 2, s50
    v_add_u32 v104, v104, v144
    v_lshl_add_u32 v104, v104, 2, s50
    v_add_u32 v105, v105, v145
    v_lshl_add_u32 v105, v105, 2, s50
    v_add_u32 v106, v106, v146
    v_lshl_add_u32 v106, v106, 2, s50
    v_add_u32 v107, v107, v147
    v_lshl_add_u32 v107, v107, 2, s50
    v_add_u32 v108, v108, v148
    v_lshl_add_u32 v108, v108, 2, s50
    v_add_u32 v109, v109, v149
    v_lshl_add_u32 v109, v109, 2, s50
    v_add_u32 v110, v110, v150
    v_lshl_add_u32 v110, v110, 2, s50
    v_add_u32 v111, v111, v151
    v_lshl_add_u32 v111, v111, 2, s50
    v_add_u32 v112, v112, v152
    v_lshl_add_u32 v112, v112, 2, s50
    v_add_u32 v113, v113, v153
    v_lshl_add_u32 v113, v113, 2, s50
    v_add_u32 v114, v114, v154
    v_lshl_add_u32 v114, v114, 2, s50
    v_add_u32 v115, v115, v155
    v_lshl_add_u32 v115, v115, 2, s50
    v_add_u32 v116, v116, v156
    v_lshl_add_u32 v116, v116, 2, s50
    v_add_u32 v117, v117, v157
    v_lshl_add_u32 v117, v117, 2, s50
    v_add_u32 v118, v118, v158
    v_lshl_add_u32 v118, v118, 2, s50
    v_add_u32 v119, v119, v159
    v_lshl_add_u32 v119, v119, 2, s50
    v_add_u32 v120, v120, v160
    v_lshl_add_u32 v120, v120, 2, s50
    v_add_u32 v121, v121, v161
    v_lshl_add_u32 v121, v121, 2, s50
    v_add_u32 v122, v122, v162
    v_lshl_add_u32 v122, v122, 2, s50
    v_add_u32 v123, v123, v163
    v_lshl_add_u32 v123, v123, 2, s50
    v_add_u32 v124, v124, v164
    v_lshl_add_u32 v124, v124, 2, s50
    v_add_u32 v125, v125, v165
    v_lshl_add_u32 v125, v125, 2, s50
    v_add_u32 v126, v126, v166
    v_lshl_add_u32 v126, v126, 2, s50
    v_add_u32 v127, v127, v167
    v_lshl_add_u32 v127, v127, 2, s50
    v_add_u32 v128, v128, v168
    v_lshl_add_u32 v128, v128, 2, s50
    v_add_u32 v129, v129, v169
    v_lshl_add_u32 v129, v129, 2, s50
    v_add_u32 v130, v130, v170
    v_lshl_add_u32 v130, v130, 2, s50
    v_add_u32 v131, v131, v171
    v_lshl_add_u32 v131, v131, 2, s50
    v_add_u32 v132, v132, v172
    v_lshl_add_u32 v132, v132, 2, s50
    v_add_u32 v133, v133, v173
    v_lshl_add_u32 v133, v133, 2, s50
    v_add_u32 v134, v134, v174
    v_lshl_add_u32 v134, v134, 2, s50
    v_add_u32 v135, v135, v175
    v_lshl_add_u32 v135, v135, 2, s50
    ds_write_b32 v96, v16
    ds_write_b32 v97, v17
    ds_write_b32 v98, v18
    ds_write_b32 v99, v19
    ds_write_b32 v100, v20
    ds_write_b32 v101, v21
    ds_write_b32 v102, v22
    ds_write_b32 v103, v23
    ds_write_b32 v104, v24
    ds_write_b32 v105, v25
    ds_write_b32 v106, v26
    ds_write_b32 v107, v27
    ds_write_b32 v108, v28
    ds_write_b32 v109, v29
    ds_write_b32 v110, v30
    ds_write_b32 v111, v31
    ds_write_b32 v112, v32
    ds_write_b32 v113, v33
    ds_write_b32 v114, v34
    ds_write_b32 v115, v35
    ds_write_b32 v116, v36
    ds_write_b32 v117, v37
    ds_write_b32 v118, v38
    ds_write_b32 v119, v39
    ds_write_b32 v120, v40
    ds_write_b32 v121, v41
    ds_write_b32 v122, v42
    ds_write_b32 v123, v43
    ds_write_b32 v124, v44
    ds_write_b32 v125, v45
    ds_write_b32 v126, v46
    ds_write_b32 v127, v47
    ds_write_b32 v128, v48
    ds_write_b32 v129, v49
    ds_write_b32 v130, v50
    ds_write_b32 v131, v51
    s_mov_b64 exec, s[42:43]
    ds_write_b32 v132, v52
    ds_write_b32 v133, v53
    ds_write_b32 v134, v54
    ds_write_b32 v135, v55
    s_mov_b64 exec, -1
    v_add_u32 v9, 77824, v1
    s_waitcnt lgkmcnt(0)
    ds_read_b128 v[56:59], v9 offset:0
    ds_read_b128 v[60:63], v9 offset:1024
    ds_read_b128 v[64:67], v9 offset:2048
    ds_read_b128 v[68:71], v9 offset:3072
    ds_read_b128 v[72:75], v9 offset:4096
    ds_read_b128 v[76:79], v9 offset:5120
    ds_read_b128 v[80:83], v9 offset:6144
    ds_read_b128 v[84:87], v9 offset:7168
    ds_read_b128 v[88:91], v9 offset:8192
    ds_read_b128 v[92:95], v9 offset:9216
    s_waitcnt lgkmcnt(9)
    buffer_store_dwordx4 v[56:59], v1, s[64:67], 0 offen offset:0 sc1
    s_waitcnt lgkmcnt(8)
    buffer_store_dwordx4 v[60:63], v1, s[64:67], 0 offen offset:1024 sc1
    s_waitcnt lgkmcnt(7)
    buffer_store_dwordx4 v[64:67], v1, s[64:67], 0 offen offset:2048 sc1
    s_waitcnt lgkmcnt(6)
    buffer_store_dwordx4 v[68:71], v1, s[64:67], 0 offen offset:3072 sc1
    s_waitcnt lgkmcnt(5)
    buffer_store_dwordx4 v[72:75], v1, s[64:67], s48 offen offset:0 sc1
    s_waitcnt lgkmcnt(4)
    buffer_store_dwordx4 v[76:79], v1, s[64:67], s48 offen offset:1024 sc1
    s_waitcnt lgkmcnt(3)
    buffer_store_dwordx4 v[80:83], v1, s[64:67], s48 offen offset:2048 sc1
    s_waitcnt lgkmcnt(2)
    buffer_store_dwordx4 v[84:87], v1, s[64:67], s48 offen offset:3072 sc1
    s_waitcnt lgkmcnt(1)
    buffer_store_dwordx4 v[88:91], v1, s[64:67], s49 offen offset:0 sc1
    s_waitcnt lgkmcnt(0)
    buffer_store_dwordx4 v[92:95], v1, s[64:67], s49 offen offset:1024 sc1
L_km_jobdone:
    v_mov_b32 v254, 89088
    ds_read_b32 v255, v254
    s_waitcnt lgkmcnt(0)
    v_readfirstlane_b32 s34, v255
L_km_attn:
    s_cmp_eq_u32 s7, 0
    s_cbranch_scc0 L_km_q
    v_and_b32 v15, 7, v0
    v_lshlrev_b32 v15, 7, v15
    s_lshl_b32 s36, s21, 10
    s_mov_b32 s41, 0
L_km_xp:
    buffer_load_dwordx2 v[16:17], v15, s[16:19], s36 offen sc1
    s_waitcnt vmcnt(0)
    v_cmp_ne_u32 vcc, s34, v16
    s_cmp_eq_u32 vcc_lo, 0
    s_cbranch_scc1 L_km_x
    s_sleep 2
    s_add_u32 s41, s41, 1
    s_cmp_lt_u32 s41, 262144
    s_cbranch_scc1 L_km_xp
L_km_x:
    s_mov_b64 s[42:43], vcc
    v_cmp_ne_u32 vcc, s44, v17
    s_or_b32 s42, s42, vcc_lo
    s_cmp_eq_u32 s42, 0
    s_cselect_b32 s42, 1, 0
    v_mov_b32 v13, s42
    v_mov_b32 v14, 89088
    ds_write_b32 v14, v13 offset:4
    s_waitcnt lgkmcnt(0)
    s_mul_i32 s36, s22, 9984
    s_add_u32 s36, s36, 65536
    v_min_u32 v2, 11, v0
    v_lshlrev_b32 v2, 7, v2
    s_mov_b32 s38, 0
L_km_gpoll:
    buffer_load_dword v3, v2, s[16:19], s36 offen sc1
    s_waitcnt vmcnt(0)
    v_xor_b32 v3, s34, v3
    v_cmp_lt_u32 vcc, 7, v3
    s_and_b32 s40, vcc_lo, 0xfff
    s_cbranch_scc0 L_km_gready
    s_sleep 1
    s_add_u32 s38, s38, 1
    s_cmp_lt_u32 s38, 262144
    s_cbranch_scc1 L_km_gpoll
L_km_gready:
    s_mov_b32 s36, s45
    s_mov_b32 m0, 0
    s_nop 0
    buffer_load_dwordx4 v1, s[8:11], s36 offen offset:0 lds
    buffer_load_dwordx4 v1, s[8:11], s36 offen offset:1024 lds
    buffer_load_dwordx4 v1, s[8:11], s36 offen offset:2048 lds
    buffer_load_dwordx4 v1, s[8:11], s36 offen offset:3072 lds
    s_add_u32 s36, s36, 4096
    s_mov_b32 m0, 4096
    s_nop 0
    buffer_load_dwordx4 v1, s[8:11], s36 offen offset:0 lds
    buffer_load_dwordx4 v1, s[8:11], s36 offen offset:1024 lds
    buffer_load_dwordx4 v1, s[8:11], s36 offen offset:2048 lds
    buffer_load_dwordx4 v1, s[8:11], s36 offen offset:3072 lds
    s_add_u32 s36, s36, 4096
    s_mov_b32 m0, 8192
    s_nop 0
    buffer_load_dwordx4 v1, s[8:11], s36 offen offset:0 lds
    buffer_load_dwordx4 v1, s[8:11], s36 offen offset:1024 lds
    buffer_load_dwordx4 v1, s[8:11], s36 offen offset:2048 lds
    buffer_load_dwordx4 v1, s[8:11], s36 offen offset:3072 lds
    s_add_u32 s36, s36, 4096
    s_mov_b32 m0, 12288
    s_nop 0
    buffer_load_dwordx4 v1, s[8:11], s36 offen offset:0 lds
    buffer_load_dwordx4 v1, s[8:11], s36 offen offset:1024 lds
    buffer_load_dwordx4 v1, s[8:11], s36 offen offset:2048 lds
    buffer_load_dwordx4 v1, s[8:11], s36 offen offset:3072 lds
    s_add_u32 s36, s36, 4096
    s_mov_b32 m0, 16384
    s_nop 0
    buffer_load_dwordx4 v1, s[8:11], s36 offen offset:0 lds
    buffer_load_dwordx4 v1, s[8:11], s36 offen offset:1024 lds
    buffer_load_dwordx4 v1, s[8:11], s36 offen offset:2048 lds
    buffer_load_dwordx4 v1, s[8:11], s36 offen offset:3072 lds
    s_add_u32 s36, s36, 4096
    s_mov_b32 m0, 20480
    s_nop 0
    buffer_load_dwordx4 v1, s[8:11], s36 offen offset:0 lds
    buffer_load_dwordx4 v1, s[8:11], s36 offen offset:1024 lds
    buffer_load_dwordx4 v1, s[8:11], s36 offen offset:2048 lds
    buffer_load_dwordx4 v1, s[8:11], s36 offen offset:3072 lds
    s_mov_b32 s48, 1
    s_mov_b32 s38, 0
L_km_qlds:
    ds_read_b32 v3, v14 offset:8
    s_waitcnt lgkmcnt(0)
    v_readfirstlane_b32 s35, v3
    s_cmp_lg_u32 s35, -1
    s_cbranch_scc1 L_km_qload
    s_add_u32 s38, s38, 1
    s_cmp_lt_u32 s38, 4194304
    s_cbranch_scc1 L_km_qlds
    s_branch L_km_qload
L_km_q:
    s_lshl_b32 s36, s21, 10
    s_add_u32 s36, s36, 147968
    v_lshlrev_b32 v2, 3, v0
    v_lshlrev_b32 v5, 2, v0
    s_bfm_b32 s41, s39, 0
    s_xor_b32 s48, s57, 1
    s_mov_b32 s38, 0
L_km_qpoll:
    buffer_load_dwordx2 v[6:7], v2, s[16:19], s36 offen sc1
    s_waitcnt vmcnt(0)
    v_xor_b32 v3, s34, v6
    v_cmp_lt_u32 vcc, 7, v3
    s_mov_b32 s40, vcc_lo
    v_cmp_ne_u32 vcc, s44, v7
    s_or_b32 s40, s40, vcc_lo
    s_and_b32 s40, s40, s41
    s_cbranch_scc0 L_km_qnear
    s_add_u32 s38, s38, 1
    s_and_b32 s42, s38, 3
    s_cbranch_scc1 L_km_qpoll
    v_mov_b32 v9, 89088
    ds_read_b32 v9, v9 offset:4
    s_waitcnt lgkmcnt(0)
    v_readfirstlane_b32 s59, v9
    s_or_b32 s42, s59, s48
    s_cbranch_scc1 L_km_fdp
    buffer_wbl2 sc1
    s_lshr_b32 s42, s56, 12
    s_sub_u32 s42, s42, s23
    s_lshl_b32 s42, s42, 2
    s_add_u32 s42, s42, s36
    v_lshl_add_u32 v9, v0, 24, s42
    v_mov_b32 v10, s43
    s_waitcnt vmcnt(0)
    buffer_store_dword v10, v9, s[16:19], 0 offen offset:256 sc1
    s_mov_b32 s48, 1
L_km_fdp:
    buffer_load_dword v8, v5, s[16:19], s36 offen offset:256 sc1
    s_waitcnt vmcnt(0)
    v_xor_b32 v8, s34, v8
    v_cmp_lt_u32 vcc, 7, v8
    s_and_b32 s42, s40, vcc_lo
    s_cbranch_scc0 L_km_qfar
    s_cmp_lt_u32 s38, 262144
    s_cbranch_scc1 L_km_qpoll
L_km_qfar:
    v_cndmask_b32 v3, v8, v3, vcc
    buffer_inv sc1
    s_waitcnt vmcnt(0)
L_km_qnear:
    v_cmp_lt_u32 vcc, 3, v3
    s_and_b32 s35, vcc_lo, s41
    v_mov_b32 v2, 89088
    v_mov_b32 v3, s35
    ds_write_b32 v2, v3 offset:8
L_km_qload:
    buffer_load_dwordx4 a[160:163], v1, s[12:15], s52 offen offset:0 sc1
    buffer_load_dwordx4 a[164:167], v1, s[12:15], s52 offen offset:1024 sc1
    buffer_load_dwordx4 a[168:171], v1, s[12:15], s52 offen offset:2048 sc1
    buffer_load_dwordx4 a[172:175], v1, s[12:15], s52 offen offset:3072 sc1
    buffer_load_dwordx4 a[176:179], v1, s[12:15], s53 offen offset:0 sc1
    buffer_load_dwordx4 a[180:183], v1, s[12:15], s53 offen offset:1024 sc1
    buffer_load_dwordx4 a[184:187], v1, s[12:15], s53 offen offset:2048 sc1
    buffer_load_dwordx4 a[188:191], v1, s[12:15], s53 offen offset:3072 sc1
    s_waitcnt vmcnt(8)
    s_barrier
    v_mov_b32 v9, 89088
    ds_read_b32 v9, v9 offset:4
    s_waitcnt lgkmcnt(0)
    v_readfirstlane_b32 s59, v9
    s_or_b32 s42, s59, s48
    s_cbranch_scc1 L_km_fdb
    buffer_wbl2 sc1
    s_lshr_b32 s42, s56, 12
    s_sub_u32 s42, s42, s23
    s_lshl_b32 s42, s42, 2
    s_add_u32 s42, s42, s36
    v_lshl_add_u32 v9, v0, 24, s42
    v_mov_b32 v10, s43
    s_waitcnt vmcnt(0)
    buffer_store_dword v10, v9, s[16:19], 0 offen offset:256 sc1
    s_mov_b32 s48, 1
L_km_fdb:
    s_mov_b32 s42, 24576
    s_mov_b32 s40, 49152
    s_mov_b32 s41, 0
    s_cmp_lg_u32 s35, 0
    s_cbranch_scc1 L_k2_slow
    s_cmp_ge_u32 s33, 625
    s_cbranch_scc1 L_k2_idle
    ds_read_b128 v[164:167], v220 offset:0
    ds_read_b128 v[168:171], v221 offset:0
    ds_read_b128 v[172:175], v222 offset:0
    ds_read_b128 v[176:179], v223 offset:0
    ds_read_b128 v[180:183], v220 offset:4096
    ds_read_b128 v[184:187], v221 offset:4096
    ds_read_b128 v[188:191], v222 offset:4096
    ds_read_b128 v[192:195], v223 offset:4096
    ds_read_b128 v[104:107], v220 offset:8192
    ds_read_b128 v[108:111], v221 offset:8192
    ds_read_b128 v[112:115], v222 offset:8192
    ds_read_b128 v[116:119], v223 offset:8192
    s_waitcnt lgkmcnt(8)
    s_waitcnt vmcnt(4)
    v_mfma_f32_16x16x32_bf16 v[4:7], v[164:167], a[160:163], 0
    ds_read_b128 v[120:123], v220 offset:12288
    ds_read_b128 v[124:127], v221 offset:12288
    v_mfma_f32_16x16x32_bf16 v[4:7], v[168:171], a[164:167], v[4:7]
    ds_read_b128 v[128:131], v222 offset:12288
    ds_read_b128 v[132:135], v223 offset:12288
    v_mfma_f32_16x16x32_bf16 v[4:7], v[172:175], a[168:171], v[4:7]
    ds_read_b128 v[136:139], v220 offset:16384
    ds_read_b128 v[140:143], v221 offset:16384
    v_mfma_f32_16x16x32_bf16 v[4:7], v[176:179], a[172:175], v[4:7]
    ds_read_b128 v[144:147], v222 offset:16384
    ds_read_b128 v[148:151], v223 offset:16384
    s_waitcnt lgkmcnt(12)
    v_mfma_f32_16x16x32_bf16 v[8:11], v[192:195], a[172:175], 0
    ds_read_b128 v[196:199], v220 offset:20480
    ds_read_b128 v[200:203], v221 offset:20480
    v_mfma_f32_16x16x32_bf16 v[8:11], v[188:191], a[168:171], v[8:11]
    ds_read_b128 v[204:207], v222 offset:20480
    ds_read_b128 v[208:211], v223 offset:20480
    v_mfma_f32_16x16x32_bf16 v[8:11], v[184:187], a[164:167], v[8:11]
    s_sub_u32 s43, s42, s41
    v_add_u32 v220, s43, v220
    v_add_u32 v221, s43, v221
    buffer_load_dwordx4 a[192:195], v1, s[12:15], s54 offen offset:0 sc1
    v_mfma_f32_16x16x32_bf16 v[8:11], v[180:183], a[160:163], v[8:11]
    v_add_u32 v222, s43, v222
    v_add_u32 v223, s43, v223
    buffer_load_dwordx4 a[196:199], v1, s[12:15], s54 offen offset:1024 sc1
    s_waitcnt lgkmcnt(12)
    v_mfma_f32_16x16x32_bf16 v[12:15], v[104:107], a[160:163], 0
    buffer_load_dwordx4 a[200:203], v1, s[12:15], s54 offen offset:2048 sc1
    v_mfma_f32_16x16x32_bf16 v[12:15], v[108:111], a[164:167], v[12:15]
    buffer_load_dwordx4 a[204:207], v1, s[12:15], s54 offen offset:3072 sc1
    v_mfma_f32_16x16x32_bf16 v[12:15], v[112:115], a[168:171], v[12:15]
    buffer_load_dwordx4 a[208:211], v1, s[12:15], s55 offen offset:0 sc1
    v_mfma_f32_16x16x32_bf16 v[12:15], v[116:119], a[172:175], v[12:15]
    buffer_load_dwordx4 a[212:215], v1, s[12:15], s55 offen offset:1024 sc1
    v_exp_f32 v4, v4
    s_waitcnt lgkmcnt(8)
    v_mfma_f32_16x16x32_bf16 v[16:19], v[132:135], a[172:175], 0
    buffer_load_dwordx4 a[216:219], v1, s[12:15], s55 offen offset:2048 sc1
    v_exp_f32 v5, v5
    v_mfma_f32_16x16x32_bf16 v[16:19], v[128:131], a[168:171], v[16:19]
    buffer_load_dwordx4 a[220:223], v1, s[12:15], s55 offen offset:3072 sc1
    v_cvt_pk_bf16_f32 v44, v4, v5
    v_exp_f32 v6, v6
    v_mfma_f32_16x16x32_bf16 v[16:19], v[124:127], a[164:167], v[16:19]
    buffer_load_dwordx4 a[224:227], v1, s[12:15], s56 offen offset:0 sc1
    v_exp_f32 v7, v7
    v_mfma_f32_16x16x32_bf16 v[16:19], v[120:123], a[160:163], v[16:19]
    buffer_load_dwordx4 a[228:231], v1, s[12:15], s56 offen offset:1024 sc1
    v_cvt_pk_bf16_f32 v45, v6, v7
    v_exp_f32 v8, v8
    s_waitcnt lgkmcnt(4)
    v_mfma_f32_16x16x32_bf16 v[20:23], v[136:139], a[160:163], 0
    buffer_load_dwordx4 a[232:235], v1, s[12:15], s56 offen offset:2048 sc1
    v_exp_f32 v9, v9
    v_mfma_f32_16x16x32_bf16 v[20:23], v[140:143], a[164:167], v[20:23]
    buffer_load_dwordx4 a[236:239], v1, s[12:15], s56 offen offset:3072 sc1
    v_cvt_pk_bf16_f32 v46, v8, v9
    v_exp_f32 v10, v10
    v_mfma_f32_16x16x32_bf16 v[20:23], v[144:147], a[168:171], v[20:23]
    s_add_u32 s45, s45, 24576
    v_exp_f32 v11, v11
    v_mfma_f32_16x16x32_bf16 v[20:23], v[148:151], a[172:175], v[20:23]
    s_add_u32 s47, s46, s42
    v_cvt_pk_bf16_f32 v47, v10, v11
    v_exp_f32 v12, v12
    s_waitcnt lgkmcnt(0)
    v_mfma_f32_16x16x32_bf16 v[24:27], v[208:211], a[172:175], 0
    s_mov_b32 m0, s47
    v_exp_f32 v13, v13
    v_mfma_f32_16x16x32_bf16 v[24:27], v[204:207], a[168:171], v[24:27]
    buffer_load_dwordx4 v232, s[8:11], s45 offen offset:0 lds
    v_cvt_pk_bf16_f32 v48, v12, v13
    v_exp_f32 v14, v14
    v_mfma_f32_16x16x32_bf16 v[24:27], v[200:203], a[164:167], v[24:27]
    buffer_load_dwordx4 v232, s[8:11], s45 offen offset:1024 lds
    v_exp_f32 v15, v15
    v_mfma_f32_16x16x32_bf16 v[24:27], v[196:199], a[160:163], v[24:27]
    buffer_load_dwordx4 v232, s[8:11], s45 offen offset:2048 lds
    v_cvt_pk_bf16_f32 v49, v14, v15
    v_exp_f32 v16, v16
    s_waitcnt vmcnt(15)
    v_mfma_f32_16x16x32_bf16 v[28:31], v[164:167], a[176:179], 0
    buffer_load_dwordx4 v232, s[8:11], s45 offen offset:3072 lds
    v_exp_f32 v17, v17
    v_mfma_f32_16x16x32_bf16 v[28:31], v[168:171], a[180:183], v[28:31]
    s_add_u32 s45, s45, 4096
    s_add_u32 m0, m0, 4096
    v_cvt_pk_bf16_f32 v50, v16, v17
    v_exp_f32 v18, v18
    v_mfma_f32_16x16x32_bf16 v[28:31], v[172:175], a[184:187], v[28:31]
    buffer_load_dwordx4 v232, s[8:11], s45 offen offset:0 lds
    v_exp_f32 v19, v19
    v_mfma_f32_16x16x32_bf16 v[28:31], v[176:179], a[188:191], v[28:31]
    buffer_load_dwordx4 v232, s[8:11], s45 offen offset:1024 lds
    v_cvt_pk_bf16_f32 v51, v18, v19
    v_exp_f32 v20, v20
    v_mfma_f32_16x16x32_bf16 v[4:7], v[192:195], a[188:191], 0
    s_add_u32 s45, s45, 20480
    s_lshl_b32 s36, s20, 20
    v_exp_f32 v21, v21
    v_mfma_f32_16x16x32_bf16 v[4:7], v[188:191], a[184:187], v[4:7]
    s_lshr_b32 s38, s6, 2
    v_cvt_pk_bf16_f32 v52, v20, v21
    v_exp_f32 v22, v22
    v_mfma_f32_16x16x32_bf16 v[4:7], v[184:187], a[180:183], v[4:7]
    s_lshl_b32 s38, s38, 7
    v_exp_f32 v23, v23
    v_mfma_f32_16x16x32_bf16 v[4:7], v[180:183], a[176:179], v[4:7]
    s_add_u32 s36, s36, s38
    s_and_b32 s38, s6, 3
    v_cvt_pk_bf16_f32 v53, v22, v23
    v_exp_f32 v24, v24
    v_mfma_f32_16x16x32_bf16 v[8:11], v[104:107], a[176:179], 0
    s_lshl_b32 s38, s38, 2
    v_exp_f32 v25, v25
    v_mfma_f32_16x16x32_bf16 v[8:11], v[108:111], a[180:183], v[8:11]
    s_add_u32 s36, s36, s38
    v_cvt_pk_bf16_f32 v54, v24, v25
    v_exp_f32 v26, v26
    v_mfma_f32_16x16x32_bf16 v[8:11], v[112:115], a[184:187], v[8:11]
    s_add_u32 s36, s36, 32768
    v_mov_b32 v250, s34
    v_lshl_add_u32 v251, v0, 24, s36
    s_add_u32 s96, s4, 0x1a00000
    v_exp_f32 v27, v27
    v_mfma_f32_16x16x32_bf16 v[8:11], v[116:119], a[188:191], v[8:11]
    s_addc_u32 s97, s5, 0
    s_mov_b32 s98, 0x2c000
    v_cvt_pk_bf16_f32 v55, v26, v27
    v_exp_f32 v28, v28
    v_mfma_f32_16x16x32_bf16 v[12:15], v[132:135], a[188:191], 0
    s_mov_b32 s99, 0x20000
    v_exp_f32 v29, v29
    v_mfma_f32_16x16x32_bf16 v[12:15], v[128:131], a[184:187], v[12:15]
    buffer_store_dword v250, v251, s[96:99], 0 offen sc1
    v_cvt_pk_bf16_f32 v56, v28, v29
    v_exp_f32 v30, v30
    v_mfma_f32_16x16x32_bf16 v[12:15], v[124:127], a[180:183], v[12:15]
    s_mul_i32 s36, s20, 17
    v_min_u32 v2, 16, v0
    v_add_u32 v2, s36, v2
    s_mul_i32 s36, s22, 78
    v_exp_f32 v31, v31
    v_mfma_f32_16x16x32_bf16 v[12:15], v[120:123], a[176:179], v[12:15]
    s_add_u32 s36, s36, 12
    v_cmp_gt_u32 vcc, 66, v2
    v_add_u32 v2, s36, v2
    v_mov_b32 v3, 624
    v_cndmask_b32 v2, v3, v2, vcc
    v_mov_b32 v3, 65536
    v_lshl_add_u32 v249, v2, 7, v3
    v_mov_b32 v3, 32768
    v_lshl_add_u32 v233, v0, 7, v3
    v_lshlrev_b32 v235, 7, v0
    s_mov_b32 s49, 2555904
    v_cvt_pk_bf16_f32 v57, v30, v31
    v_exp_f32 v4, v4
    v_mfma_f32_16x16x32_bf16 v[16:19], v[136:139], a[176:179], 0
    s_lshl_b32 s37, s20, 12
    v_exp_f32 v5, v5
    v_mfma_f32_16x16x32_bf16 v[16:19], v[140:143], a[180:183], v[16:19]
    s_add_u32 s37, s37, 73728
    s_lshl_b32 s51, s20, 14
    v_cvt_pk_bf16_f32 v58, v4, v5
    v_exp_f32 v6, v6
    v_mfma_f32_16x16x32_bf16 v[16:19], v[144:147], a[184:187], v[16:19]
    s_add_u32 s64, s4, 0x560000
    v_exp_f32 v7, v7
    v_mfma_f32_16x16x32_bf16 v[16:19], v[148:151], a[188:191], v[16:19]
    s_addc_u32 s65, s5, 0
    v_cvt_pk_bf16_f32 v59, v6, v7
    v_exp_f32 v8, v8
    v_mfma_f32_16x16x32_bf16 v[20:23], v[208:211], a[188:191], 0
    s_mov_b32 s66, 0x9c400
    s_mov_b32 s67, 0x20000
    v_exp_f32 v9, v9
    v_mfma_f32_16x16x32_bf16 v[20:23], v[204:207], a[184:187], v[20:23]
    s_add_u32 s60, s4, 0x1a08000
    v_cvt_pk_bf16_f32 v60, v8, v9
    v_exp_f32 v10, v10
    v_mfma_f32_16x16x32_bf16 v[20:23], v[200:203], a[180:183], v[20:23]
    s_addc_u32 s61, s5, 0
    v_exp_f32 v11, v11
    v_mfma_f32_16x16x32_bf16 v[20:23], v[196:199], a[176:179], v[20:23]
    s_mov_b32 s62, 0x2000
    s_mov_b32 s63, 0x20000
    v_cvt_pk_bf16_f32 v61, v10, v11
    v_exp_f32 v12, v12
    s_waitcnt vmcnt(15)
    v_mfma_f32_16x16x32_bf16 v[24:27], v[164:167], a[192:195], 0
    s_mov_b32 s12, -8192
    v_exp_f32 v13, v13
    v_mfma_f32_16x16x32_bf16 v[24:27], v[168:171], a[196:199], v[24:27]
    s_bfe_u32 s36, s2, 0x10003
    v_cvt_pk_bf16_f32 v62, v12, v13
    v_exp_f32 v14, v14
    v_mfma_f32_16x16x32_bf16 v[24:27], v[172:175], a[200:203], v[24:27]
    s_add_u32 s36, s36, 1
    s_mov_b32 s48, -1
    v_exp_f32 v15, v15
    v_mfma_f32_16x16x32_bf16 v[24:27], v[176:179], a[204:207], v[24:27]
    s_sub_u32 s14, s36, 4
    v_cvt_pk_bf16_f32 v63, v14, v15
    v_exp_f32 v16, v16
    v_mfma_f32_16x16x32_bf16 v[28:31], v[192:195], a[204:207], 0
    s_mov_b32 s13, 0
    v_exp_f32 v17, v17
    v_mfma_f32_16x16x32_bf16 v[28:31], v[188:191], a[200:203], v[28:31]
    s_add_u32 s50, s51, 14336
    s_lshl_b32 s36, s21, 3
    v_cvt_pk_bf16_f32 v64, v16, v17
    v_exp_f32 v18, v18
    v_mfma_f32_16x16x32_bf16 v[28:31], v[184:187], a[196:199], v[28:31]
    s_add_u32 s36, s36, s22
    v_exp_f32 v19, v19
    v_mfma_f32_16x16x32_bf16 v[28:31], v[180:183], a[192:195], v[28:31]
    s_mul_i32 s36, s36, 81920
    v_cvt_pk_bf16_f32 v65, v18, v19
    v_exp_f32 v20, v20
    v_mfma_f32_16x16x32_bf16 v[4:7], v[104:107], a[192:195], 0
    s_add_u32 s36, s36, 0x600000
    s_add_u32 s24, s4, s36
    v_exp_f32 v21, v21
    v_mfma_f32_16x16x32_bf16 v[4:7], v[108:111], a[196:199], v[4:7]
    s_addc_u32 s25, s5, 0
    v_cvt_pk_bf16_f32 v66, v20, v21
    v_exp_f32 v22, v22
    v_mfma_f32_16x16x32_bf16 v[4:7], v[112:115], a[200:203], v[4:7]
    s_mov_b32 s26, 81920
    v_exp_f32 v23, v23
    v_mfma_f32_16x16x32_bf16 v[4:7], v[116:119], a[204:207], v[4:7]
    s_lshl_b32 s58, s23, 10
    s_lshr_b32 s52, s52, 2
    v_cvt_pk_bf16_f32 v67, v22, v23
    v_exp_f32 v24, v24
    v_mfma_f32_16x16x32_bf16 v[8:11], v[132:135], a[204:207], 0
    s_sub_u32 s52, s52, s58
    v_exp_f32 v25, v25
    v_mfma_f32_16x16x32_bf16 v[8:11], v[128:131], a[200:203], v[8:11]
    s_lshr_b32 s53, s53, 2
    v_cvt_pk_bf16_f32 v68, v24, v25
    v_exp_f32 v26, v26
    v_mfma_f32_16x16x32_bf16 v[8:11], v[124:127], a[196:199], v[8:11]
    s_sub_u32 s53, s53, s58
    s_lshr_b32 s54, s54, 2
    v_exp_f32 v27, v27
    v_mfma_f32_16x16x32_bf16 v[8:11], v[120:123], a[192:195], v[8:11]
    s_sub_u32 s54, s54, s58
    v_cvt_pk_bf16_f32 v69, v26, v27
    v_exp_f32 v28, v28
    v_mfma_f32_16x16x32_bf16 v[12:15], v[136:139], a[192:195], 0
    s_lshr_b32 s55, s55, 2
    v_exp_f32 v29, v29
    v_mfma_f32_16x16x32_bf16 v[12:15], v[140:143], a[196:199], v[12:15]
    s_sub_u32 s55, s55, s58
    s_lshr_b32 s56, s56, 2
    v_cvt_pk_bf16_f32 v70, v28, v29
    v_exp_f32 v30, v30
    v_mfma_f32_16x16x32_bf16 v[12:15], v[144:147], a[200:203], v[12:15]
    s_sub_u32 s56, s56, s58
    v_exp_f32 v31, v31
    v_mfma_f32_16x16x32_bf16 v[12:15], v[148:151], a[204:207], v[12:15]
    s_mov_b32 s27, 0x20000
    v_cvt_pk_bf16_f32 v71, v30, v31
    v_exp_f32 v4, v4
    s_waitcnt vmcnt(11)
    v_mfma_f32_16x16x32_bf16 v[16:19], v[176:179], a[220:223], 0
    s_add_u32 s28, s4, 0x500000
    s_addc_u32 s29, s5, 0
    v_exp_f32 v5, v5
    v_mfma_f32_16x16x32_bf16 v[16:19], v[172:175], a[216:219], v[16:19]
    s_mov_b32 s30, 0x10000
    v_cvt_pk_bf16_f32 v72, v4, v5
    v_exp_f32 v6, v6
    v_mfma_f32_16x16x32_bf16 v[16:19], v[168:171], a[212:215], v[16:19]
    buffer_load_dword v248, v249, s[96:99], 0 offen sc1
    s_mov_b32 s31, 0x20000
    v_exp_f32 v7, v7
    v_mfma_f32_16x16x32_bf16 v[16:19], v[164:167], a[208:211], v[16:19]
    s_lshl_b32 s36, s21, 10
    s_add_u32 s36, s36, 0x1a24000
    v_cvt_pk_bf16_f32 v73, v6, v7
    v_exp_f32 v8, v8
    v_mfma_f32_16x16x32_bf16 v[20:23], v[180:183], a[208:211], 0
    s_add_u32 s68, s4, s36
    v_exp_f32 v9, v9
    v_mfma_f32_16x16x32_bf16 v[20:23], v[184:187], a[212:215], v[20:23]
    s_addc_u32 s69, s5, 0
    v_cvt_pk_bf16_f32 v74, v8, v9
    v_exp_f32 v10, v10
    v_mfma_f32_16x16x32_bf16 v[20:23], v[188:191], a[216:219], v[20:23]
    s_mov_b32 s70, 512
    s_mov_b32 s71, 0x20000
    v_exp_f32 v11, v11
    v_mfma_f32_16x16x32_bf16 v[20:23], v[192:195], a[220:223], v[20:23]
    s_add_u32 s36, s22, 1
    v_cvt_pk_bf16_f32 v75, v10, v11
    v_exp_f32 v12, v12
    v_mfma_f32_16x16x32_bf16 v[24:27], v[116:119], a[220:223], 0
    s_mul_i32 s7, s36, 319488
    v_exp_f32 v13, v13
    v_mfma_f32_16x16x32_bf16 v[24:27], v[112:115], a[216:219], v[24:27]
    s_mov_b32 s6, 8192
    v_and_b32 v238, 15, v0
    v_lshrrev_b32 v239, 4, v0
    s_sub_u32 s36, s32, s20
    v_cvt_pk_bf16_f32 v76, v12, v13
    v_exp_f32 v14, v14
    v_mfma_f32_16x16x32_bf16 v[24:27], v[108:111], a[212:215], v[24:27]
    s_mul_i32 s36, s36, 10
    s_lshl_b32 s38, s20, 4
    v_exp_f32 v15, v15
    v_mfma_f32_16x16x32_bf16 v[24:27], v[104:107], a[208:211], v[24:27]
    v_add_u32 v3, s38, v238
    v_add_u32 v2, s36, v3
    v_lshlrev_b32 v2, 8, v2
    v_lshl_add_u32 v2, v239, 4, v2
    v_cmp_gt_u32 vcc, 40, v3
    v_mov_b32 v240, 0x10000000
    s_nop 0
    v_cndmask_b32 v240, v240, v2, vcc
    v_mov_b32 v242, 0
    v_mov_b32 v243, 0
    v_mov_b32 v244, 0
    v_mov_b32 v245, 0
    v_mov_b32 v246, 0
    s_mov_b32 s16, 0x00ffffff
    v_cvt_pk_bf16_f32 v77, v14, v15
    v_exp_f32 v16, v16
    v_mfma_f32_16x16x32_bf16 v[28:31], v[120:123], a[208:211], 0
    s_mov_b32 s17, 0x070c030c
    v_exp_f32 v17, v17
    v_mfma_f32_16x16x32_bf16 v[28:31], v[124:127], a[212:215], v[28:31]
    s_mov_b32 s18, 0x10001000
    s_mov_b32 s19, 0x05040100
    v_cvt_pk_bf16_f32 v80, v16, v17
    v_exp_f32 v18, v18
    v_mfma_f32_16x16x32_bf16 v[28:31], v[128:131], a[216:219], v[28:31]
    s_mov_b32 s23, 0x07060302
    v_exp_f32 v19, v19
    v_mfma_f32_16x16x32_bf16 v[28:31], v[132:135], a[220:223], v[28:31]
    s_mov_b32 s47, s40
    v_cvt_pk_bf16_f32 v81, v18, v19
    v_exp_f32 v20, v20
    v_mfma_f32_16x16x32_bf16 v[4:7], v[148:151], a[220:223], 0
    s_mov_b32 s40, s41
    s_mov_b32 s41, s42
    v_exp_f32 v21, v21
    v_mfma_f32_16x16x32_bf16 v[4:7], v[144:147], a[216:219], v[4:7]
    s_mov_b32 s42, s47
    v_cvt_pk_bf16_f32 v82, v20, v21
    v_exp_f32 v22, v22
    v_mfma_f32_16x16x32_bf16 v[4:7], v[140:143], a[212:215], v[4:7]
    v_exp_f32 v23, v23
    v_mfma_f32_16x16x32_bf16 v[4:7], v[136:139], a[208:211], v[4:7]
    v_cvt_pk_bf16_f32 v83, v22, v23
    v_exp_f32 v24, v24
    s_waitcnt vmcnt(8)
    v_mfma_f32_16x16x32_bf16 v[8:11], v[164:167], a[224:227], 0
    v_exp_f32 v25, v25
    v_mfma_f32_16x16x32_bf16 v[8:11], v[168:171], a[228:231], v[8:11]
    v_cvt_pk_bf16_f32 v84, v24, v25
    v_exp_f32 v26, v26
    v_mfma_f32_16x16x32_bf16 v[8:11], v[172:175], a[232:235], v[8:11]
    v_exp_f32 v27, v27
    v_mfma_f32_16x16x32_bf16 v[8:11], v[176:179], a[236:239], v[8:11]
    v_cvt_pk_bf16_f32 v85, v26, v27
    v_exp_f32 v28, v28
    v_mfma_f32_16x16x32_bf16 v[12:15], v[192:195], a[236:239], 0
    v_exp_f32 v29, v29
    v_mfma_f32_16x16x32_bf16 v[12:15], v[188:191], a[232:235], v[12:15]
    v_cvt_pk_bf16_f32 v86, v28, v29
    v_exp_f32 v30, v30
    v_mfma_f32_16x16x32_bf16 v[12:15], v[184:187], a[228:231], v[12:15]
    v_exp_f32 v31, v31
    v_mfma_f32_16x16x32_bf16 v[12:15], v[180:183], a[224:227], v[12:15]
    v_cvt_pk_bf16_f32 v87, v30, v31
    v_exp_f32 v4, v4
    v_mfma_f32_16x16x32_bf16 v[16:19], v[104:107], a[224:227], 0
    v_exp_f32 v5, v5
    v_mfma_f32_16x16x32_bf16 v[16:19], v[108:111], a[228:231], v[16:19]
    v_cvt_pk_bf16_f32 v88, v4, v5
    v_exp_f32 v6, v6
    v_mfma_f32_16x16x32_bf16 v[16:19], v[112:115], a[232:235], v[16:19]
    v_exp_f32 v7, v7
    v_mfma_f32_16x16x32_bf16 v[16:19], v[116:119], a[236:239], v[16:19]
    v_cvt_pk_bf16_f32 v89, v6, v7
    v_exp_f32 v8, v8
    v_mfma_f32_16x16x32_bf16 v[20:23], v[132:135], a[236:239], 0
    v_exp_f32 v9, v9
    v_mfma_f32_16x16x32_bf16 v[20:23], v[128:131], a[232:235], v[20:23]
    v_cvt_pk_bf16_f32 v92, v8, v9
    v_exp_f32 v10, v10
    v_mfma_f32_16x16x32_bf16 v[20:23], v[124:127], a[228:231], v[20:23]
    v_exp_f32 v11, v11
    v_mfma_f32_16x16x32_bf16 v[20:23], v[120:123], a[224:227], v[20:23]
    v_cvt_pk_bf16_f32 v93, v10, v11
    v_exp_f32 v12, v12
    v_mfma_f32_16x16x32_bf16 v[24:27], v[136:139], a[224:227], 0
    v_exp_f32 v13, v13
    v_mfma_f32_16x16x32_bf16 v[24:27], v[140:143], a[228:231], v[24:27]
    v_cvt_pk_bf16_f32 v94, v12, v13
    v_exp_f32 v14, v14
    v_mfma_f32_16x16x32_bf16 v[24:27], v[144:147], a[232:235], v[24:27]
    v_exp_f32 v15, v15
    v_mfma_f32_16x16x32_bf16 v[24:27], v[148:151], a[236:239], v[24:27]
    v_cvt_pk_bf16_f32 v95, v14, v15
    v_exp_f32 v16, v16
    v_mfma_f32_16x16x32_bf16 v[32:35], v[208:211], a[204:207], 0
    v_exp_f32 v17, v17
    s_waitcnt vmcnt(0)
    v_xor_b32 v248, s34, v248
    v_cmp_lt_u32 vcc, 7, v248
    s_cmp_lg_u64 vcc, 0
    s_cbranch_scc1 L_km_rdyf
L_km_rdyef:
    v_mfma_f32_16x16x32_bf16 v[32:35], v[204:207], a[200:203], v[32:35]
    s_waitcnt lgkmcnt(0)
    s_barrier
    v_cvt_pk_bf16_f32 v96, v16, v17
    v_exp_f32 v18, v18
    v_mfma_f32_16x16x32_bf16 v[32:35], v[200:203], a[196:199], v[32:35]
    ds_read_b128 v[164:167], v220 offset:0
    v_exp_f32 v19, v19
    v_mfma_f32_16x16x32_bf16 v[32:35], v[196:199], a[192:195], v[32:35]
    ds_read_b128 v[168:171], v221 offset:0
    v_cvt_pk_bf16_f32 v97, v18, v19
    v_exp_f32 v20, v20
    v_mfma_f32_16x16x32_bf16 v[36:39], v[196:199], a[208:211], 0
    ds_read_b128 v[172:175], v222 offset:0
    v_exp_f32 v21, v21
    v_mfma_f32_16x16x32_bf16 v[36:39], v[200:203], a[212:215], v[36:39]
    ds_read_b128 v[176:179], v223 offset:0
    v_cvt_pk_bf16_f32 v98, v20, v21
    v_exp_f32 v22, v22
    v_mfma_f32_16x16x32_bf16 v[36:39], v[204:207], a[216:219], v[36:39]
    v_exp_f32 v23, v23
    v_mfma_f32_16x16x32_bf16 v[36:39], v[208:211], a[220:223], v[36:39]
    v_cvt_pk_bf16_f32 v99, v22, v23
    v_exp_f32 v24, v24
    v_mfma_f32_16x16x32_bf16 v[40:43], v[208:211], a[236:239], 0
    v_exp_f32 v25, v25
    v_mfma_f32_16x16x32_bf16 v[40:43], v[204:207], a[232:235], v[40:43]
    v_cvt_pk_bf16_f32 v100, v24, v25
    v_exp_f32 v26, v26
    v_mfma_f32_16x16x32_bf16 v[40:43], v[200:203], a[228:231], v[40:43]
    v_exp_f32 v27, v27
    v_exp_f32 v32, v32
    v_exp_f32 v33, v33
    v_exp_f32 v34, v34
    v_mfma_f32_16x16x32_bf16 v[40:43], v[196:199], a[224:227], v[40:43]
    s_waitcnt lgkmcnt(0)
    v_cvt_pk_bf16_f32 v101, v26, v27
    v_cvt_pk_bf16_f32 v78, v32, v33
    .p2align 6
L_k2_loop:
    v_mfma_f32_16x16x32_bf16 v[4:7], v[164:167], a[160:163], 0
    s_sub_u32 s43, s42, s41
    v_exp_f32 v35, v35
    v_mfma_f32_16x16x32_bf16 v[4:7], v[168:171], a[164:167], v[4:7]
    s_sub_u32 s44, s41, s40
    ds_read_b64_tr_b16 v[196:197], v224 offset:0
    v_cvt_pk_bf16_f32 v79, v34, v35
    v_mfma_f32_16x16x32_bf16 v[4:7], v[172:175], a[168:171], v[4:7]
    v_exp_f32 v36, v36
    v_mfma_f32_16x16x32_bf16 v[4:7], v[176:179], a[172:175], v[4:7]
    ds_read_b64_tr_b16 v[198:199], v224 offset:4096
    ds_read_b64_tr_b16 v[200:201], v224 offset:8192
    v_mfma_f32_16x16x32_bf16 v[8:11], v[176:179], a[188:191], 0
    v_exp_f32 v37, v37
    v_mfma_f32_16x16x32_bf16 v[8:11], v[172:175], a[184:187], v[8:11]
    ds_read_b64_tr_b16 v[202:203], v224 offset:12288
    v_cvt_pk_bf16_f32 v90, v36, v37
    v_mfma_f32_16x16x32_bf16 v[8:11], v[168:171], a[180:183], v[8:11]
    v_exp_f32 v38, v38
    v_mfma_f32_16x16x32_bf16 v[8:11], v[164:167], a[176:179], v[8:11]
    ds_read_b64_tr_b16 v[204:205], v224 offset:16384
    ds_read_b64_tr_b16 v[206:207], v224 offset:20480
    v_mfma_f32_16x16x32_bf16 v[12:15], v[164:167], a[192:195], 0
    v_exp_f32 v39, v39
    v_mfma_f32_16x16x32_bf16 v[12:15], v[168:171], a[196:199], v[12:15]
    ds_read_b128 v[180:183], v220 offset:4096
    v_cvt_pk_bf16_f32 v91, v38, v39
    v_mfma_f32_16x16x32_bf16 v[12:15], v[172:175], a[200:203], v[12:15]
    v_exp_f32 v40, v40
    v_mfma_f32_16x16x32_bf16 v[12:15], v[176:179], a[204:207], v[12:15]
    ds_read_b128 v[184:187], v221 offset:4096
    ds_read_b128 v[188:191], v222 offset:4096
    v_mfma_f32_16x16x32_bf16 v[16:19], v[176:179], a[220:223], 0
    v_exp_f32 v41, v41
    v_mfma_f32_16x16x32_bf16 v[16:19], v[172:175], a[216:219], v[16:19]
    ds_read_b128 v[192:195], v223 offset:4096
    v_cvt_pk_bf16_f32 v102, v40, v41
    v_mfma_f32_16x16x32_bf16 v[16:19], v[168:171], a[212:215], v[16:19]
    v_exp_f32 v42, v42
    v_mfma_f32_16x16x32_bf16 v[16:19], v[164:167], a[208:211], v[16:19]
    v_add_u32 v224, s44, v224
    v_mfma_f32_16x16x32_bf16 v[20:23], v[164:167], a[224:227], 0
    v_exp_f32 v43, v43
    v_mfma_f32_16x16x32_bf16 v[20:23], v[168:171], a[228:231], v[20:23]
    v_cvt_pk_bf16_f32 v103, v42, v43
    v_mfma_f32_16x16x32_bf16 v[20:23], v[172:175], a[232:235], v[20:23]
    v_exp_f32 v4, v4
    v_mfma_f32_16x16x32_bf16 v[20:23], v[176:179], a[236:239], v[20:23]
    s_waitcnt lgkmcnt(4)
    v_mfma_f32_16x16x32_bf16 a[0:3], v[196:199], v[44:47], a[0:3]
    v_exp_f32 v5, v5
    v_mfma_f32_16x16x32_bf16 a[0:3], v[200:203], v[48:51], a[0:3]
    ds_read_b64_tr_b16 v[208:209], v225 offset:0
    v_cvt_pk_bf16_f32 v104, v4, v5
    v_mfma_f32_16x16x32_bf16 a[0:3], v[204:207], v[52:55], a[0:3]
    v_exp_f32 v6, v6
    v_mfma_f32_16x16x32_bf16 a[32:35], v[204:207], v[64:67], a[32:35]
    ds_read_b64_tr_b16 v[210:211], v225 offset:4096
    ds_read_b64_tr_b16 v[212:213], v225 offset:8192
    v_mfma_f32_16x16x32_bf16 a[32:35], v[200:203], v[60:63], a[32:35]
    v_exp_f32 v7, v7
    v_mfma_f32_16x16x32_bf16 a[32:35], v[196:199], v[56:59], a[32:35]
    ds_read_b64_tr_b16 v[214:215], v225 offset:12288
    v_cvt_pk_bf16_f32 v105, v6, v7
    v_mfma_f32_16x16x32_bf16 a[64:67], v[196:199], v[68:71], a[64:67]
    v_exp_f32 v8, v8
    v_mfma_f32_16x16x32_bf16 a[64:67], v[200:203], v[72:75], a[64:67]
    ds_read_b64_tr_b16 v[216:217], v225 offset:16384
    ds_read_b64_tr_b16 v[218:219], v225 offset:20480
    v_mfma_f32_16x16x32_bf16 a[64:67], v[204:207], v[76:79], a[64:67]
    v_exp_f32 v9, v9
    v_mfma_f32_16x16x32_bf16 a[96:99], v[204:207], v[88:91], a[96:99]
    v_cvt_pk_bf16_f32 v116, v8, v9
    v_add_u32 v225, s44, v225
    v_mfma_f32_16x16x32_bf16 a[96:99], v[200:203], v[84:87], a[96:99]
    v_exp_f32 v10, v10
    v_mfma_f32_16x16x32_bf16 a[96:99], v[196:199], v[80:83], a[96:99]
    v_mfma_f32_16x16x32_bf16 a[128:131], v[196:199], v[92:95], a[128:131]
    v_exp_f32 v11, v11
    v_mfma_f32_16x16x32_bf16 a[128:131], v[200:203], v[96:99], a[128:131]
    v_cvt_pk_bf16_f32 v117, v10, v11
    v_mfma_f32_16x16x32_bf16 a[128:131], v[204:207], v[100:103], a[128:131]
    s_waitcnt lgkmcnt(6)
    v_exp_f32 v12, v12
    v_mfma_f32_16x16x32_bf16 v[24:27], v[180:183], a[160:163], 0
    v_mfma_f32_16x16x32_bf16 v[24:27], v[184:187], a[164:167], v[24:27]
    s_add_u32 s47, s46, s42
    v_exp_f32 v13, v13
    v_mfma_f32_16x16x32_bf16 v[24:27], v[188:191], a[168:171], v[24:27]
    s_mov_b32 m0, s47
    ds_read_b64_tr_b16 v[196:197], v226 offset:0
    v_cvt_pk_bf16_f32 v128, v12, v13
    v_mfma_f32_16x16x32_bf16 v[24:27], v[192:195], a[172:175], v[24:27]
    v_exp_f32 v14, v14
    v_mfma_f32_16x16x32_bf16 v[28:31], v[192:195], a[188:191], 0
    buffer_load_dwordx4 v232, s[8:11], s45 offen offset:0 lds
    v_mfma_f32_16x16x32_bf16 v[28:31], v[188:191], a[184:187], v[28:31]
    v_exp_f32 v15, v15
    v_mfma_f32_16x16x32_bf16 v[28:31], v[184:187], a[180:183], v[28:31]
    ds_read_b64_tr_b16 v[198:199], v226 offset:4096
    v_cvt_pk_bf16_f32 v129, v14, v15
    v_mfma_f32_16x16x32_bf16 v[28:31], v[180:183], a[176:179], v[28:31]
    v_exp_f32 v16, v16
    v_mfma_f32_16x16x32_bf16 v[32:35], v[180:183], a[192:195], 0
    ds_read_b64_tr_b16 v[200:201], v226 offset:8192
    ds_read_b64_tr_b16 v[202:203], v226 offset:12288
    v_mfma_f32_16x16x32_bf16 v[32:35], v[184:187], a[196:199], v[32:35]
    v_exp_f32 v17, v17
    v_mfma_f32_16x16x32_bf16 v[32:35], v[188:191], a[200:203], v[32:35]
    ds_read_b64_tr_b16 v[204:205], v226 offset:16384
    v_cvt_pk_bf16_f32 v140, v16, v17
    v_mfma_f32_16x16x32_bf16 v[32:35], v[192:195], a[204:207], v[32:35]
    v_exp_f32 v18, v18
    v_mfma_f32_16x16x32_bf16 v[36:39], v[192:195], a[220:223], 0
    buffer_load_dwordx4 v232, s[8:11], s45 offen offset:1024 lds
    v_mfma_f32_16x16x32_bf16 v[36:39], v[188:191], a[216:219], v[36:39]
    v_exp_f32 v19, v19
    v_mfma_f32_16x16x32_bf16 v[36:39], v[184:187], a[212:215], v[36:39]
    ds_read_b64_tr_b16 v[206:207], v226 offset:20480
    v_cvt_pk_bf16_f32 v141, v18, v19
    v_mfma_f32_16x16x32_bf16 v[36:39], v[180:183], a[208:211], v[36:39]
    v_exp_f32 v20, v20
    v_mfma_f32_16x16x32_bf16 v[40:43], v[180:183], a[224:227], 0
    v_add_u32 v226, s44, v226
    v_mfma_f32_16x16x32_bf16 v[40:43], v[184:187], a[228:231], v[40:43]
    v_exp_f32 v21, v21
    v_mfma_f32_16x16x32_bf16 v[40:43], v[188:191], a[232:235], v[40:43]
    v_cvt_pk_bf16_f32 v152, v20, v21
    v_mfma_f32_16x16x32_bf16 v[40:43], v[192:195], a[236:239], v[40:43]
    s_waitcnt lgkmcnt(6)
    v_exp_f32 v22, v22
    v_mfma_f32_16x16x32_bf16 a[4:7], v[208:211], v[44:47], a[4:7]
    buffer_load_dwordx4 v232, s[8:11], s45 offen offset:2048 lds
    v_mfma_f32_16x16x32_bf16 a[4:7], v[212:215], v[48:51], a[4:7]
    v_exp_f32 v23, v23
    v_mfma_f32_16x16x32_bf16 a[4:7], v[216:219], v[52:55], a[4:7]
    ds_read_b128 v[164:167], v220 offset:8192
    v_cvt_pk_bf16_f32 v153, v22, v23
    v_mfma_f32_16x16x32_bf16 a[36:39], v[216:219], v[64:67], a[36:39]
    v_exp_f32 v24, v24
    v_mfma_f32_16x16x32_bf16 a[36:39], v[212:215], v[60:63], a[36:39]
    ds_read_b128 v[168:171], v221 offset:8192
    ds_read_b128 v[172:175], v222 offset:8192
    v_mfma_f32_16x16x32_bf16 a[36:39], v[208:211], v[56:59], a[36:39]
    v_exp_f32 v25, v25
    v_mfma_f32_16x16x32_bf16 a[68:71], v[208:211], v[68:71], a[68:71]
    ds_read_b128 v[176:179], v223 offset:8192
    v_cvt_pk_bf16_f32 v106, v24, v25
    v_mfma_f32_16x16x32_bf16 a[68:71], v[212:215], v[72:75], a[68:71]
    v_exp_f32 v26, v26
    v_mfma_f32_16x16x32_bf16 a[68:71], v[216:219], v[76:79], a[68:71]
    buffer_load_dwordx4 v232, s[8:11], s45 offen offset:3072 lds
    v_mfma_f32_16x16x32_bf16 a[100:103], v[216:219], v[88:91], a[100:103]
    v_exp_f32 v27, v27
    v_mfma_f32_16x16x32_bf16 a[100:103], v[212:215], v[84:87], a[100:103]
    v_cvt_pk_bf16_f32 v107, v26, v27
    v_mfma_f32_16x16x32_bf16 a[100:103], v[208:211], v[80:83], a[100:103]
    v_exp_f32 v28, v28
    v_mfma_f32_16x16x32_bf16 a[132:135], v[208:211], v[92:95], a[132:135]
    v_mfma_f32_16x16x32_bf16 a[132:135], v[212:215], v[96:99], a[132:135]
    v_exp_f32 v29, v29
    v_mfma_f32_16x16x32_bf16 a[132:135], v[216:219], v[100:103], a[132:135]
    s_waitcnt lgkmcnt(4)
    v_cvt_pk_bf16_f32 v118, v28, v29
    v_mfma_f32_16x16x32_bf16 a[8:11], v[196:199], v[44:47], a[8:11]
    s_add_u32 s45, s45, 4096
    v_exp_f32 v30, v30
    v_mfma_f32_16x16x32_bf16 a[8:11], v[200:203], v[48:51], a[8:11]
    s_add_u32 m0, m0, 4096
    ds_read_b64_tr_b16 v[208:209], v227 offset:0
    ds_read_b64_tr_b16 v[210:211], v227 offset:4096
    v_mfma_f32_16x16x32_bf16 a[8:11], v[204:207], v[52:55], a[8:11]
    v_exp_f32 v31, v31
    v_mfma_f32_16x16x32_bf16 a[40:43], v[204:207], v[64:67], a[40:43]
    ds_read_b64_tr_b16 v[212:213], v227 offset:8192
    v_cvt_pk_bf16_f32 v119, v30, v31
    v_mfma_f32_16x16x32_bf16 a[40:43], v[200:203], v[60:63], a[40:43]
    v_exp_f32 v32, v32
    v_mfma_f32_16x16x32_bf16 a[40:43], v[196:199], v[56:59], a[40:43]
    buffer_load_dwordx4 v232, s[8:11], s45 offen offset:0 lds
    v_mfma_f32_16x16x32_bf16 a[72:75], v[196:199], v[68:71], a[72:75]
    v_exp_f32 v33, v33
    v_mfma_f32_16x16x32_bf16 a[72:75], v[200:203], v[72:75], a[72:75]
    ds_read_b64_tr_b16 v[214:215], v227 offset:12288
    v_cvt_pk_bf16_f32 v130, v32, v33
    v_mfma_f32_16x16x32_bf16 a[72:75], v[204:207], v[76:79], a[72:75]
    v_exp_f32 v34, v34
    v_mfma_f32_16x16x32_bf16 a[104:107], v[204:207], v[88:91], a[104:107]
    ds_read_b64_tr_b16 v[216:217], v227 offset:16384
    ds_read_b64_tr_b16 v[218:219], v227 offset:20480
    v_mfma_f32_16x16x32_bf16 a[104:107], v[200:203], v[84:87], a[104:107]
    v_exp_f32 v35, v35
    v_mfma_f32_16x16x32_bf16 a[104:107], v[196:199], v[80:83], a[104:107]
    v_cvt_pk_bf16_f32 v131, v34, v35
    v_add_u32 v227, s44, v227
    v_mfma_f32_16x16x32_bf16 a[136:139], v[196:199], v[92:95], a[136:139]
    v_exp_f32 v36, v36
    v_mfma_f32_16x16x32_bf16 a[136:139], v[200:203], v[96:99], a[136:139]
    buffer_load_dwordx4 v232, s[8:11], s45 offen offset:1024 lds
    v_mfma_f32_16x16x32_bf16 a[136:139], v[204:207], v[100:103], a[136:139]
    s_waitcnt lgkmcnt(6)
    v_exp_f32 v37, v37
    v_mfma_f32_16x16x32_bf16 v[4:7], v[164:167], a[160:163], 0
    v_cvt_pk_bf16_f32 v142, v36, v37
    v_mfma_f32_16x16x32_bf16 v[4:7], v[168:171], a[164:167], v[4:7]
    v_exp_f32 v38, v38
    v_mfma_f32_16x16x32_bf16 v[4:7], v[172:175], a[168:171], v[4:7]
    v_mfma_f32_16x16x32_bf16 v[4:7], v[176:179], a[172:175], v[4:7]
    v_exp_f32 v39, v39
    v_mfma_f32_16x16x32_bf16 v[8:11], v[176:179], a[188:191], 0
    s_add_u32 s45, s45, 20480
    v_cvt_pk_bf16_f32 v143, v38, v39
    v_mfma_f32_16x16x32_bf16 v[8:11], v[172:175], a[184:187], v[8:11]
    s_cmp_eq_u32 s45, s7
    v_exp_f32 v40, v40
    v_mfma_f32_16x16x32_bf16 v[8:11], v[168:171], a[180:183], v[8:11]
    s_cselect_b32 s45, s49, s45
    v_mfma_f32_16x16x32_bf16 v[8:11], v[164:167], a[176:179], v[8:11]
    v_exp_f32 v41, v41
    v_mfma_f32_16x16x32_bf16 v[12:15], v[164:167], a[192:195], 0
    ds_read_b128 v[180:183], v220 offset:12288
    v_cvt_pk_bf16_f32 v154, v40, v41
    v_mfma_f32_16x16x32_bf16 v[12:15], v[168:171], a[196:199], v[12:15]
    v_exp_f32 v42, v42
    v_mfma_f32_16x16x32_bf16 v[12:15], v[172:175], a[200:203], v[12:15]
    ds_read_b128 v[184:187], v221 offset:12288
    ds_read_b128 v[188:191], v222 offset:12288
    v_mfma_f32_16x16x32_bf16 v[12:15], v[176:179], a[204:207], v[12:15]
    v_exp_f32 v43, v43
    v_mfma_f32_16x16x32_bf16 v[16:19], v[176:179], a[220:223], 0
    ds_read_b128 v[192:195], v223 offset:12288
    v_cvt_pk_bf16_f32 v155, v42, v43
    v_mfma_f32_16x16x32_bf16 v[16:19], v[172:175], a[216:219], v[16:19]
    v_exp_f32 v4, v4
    v_mfma_f32_16x16x32_bf16 v[16:19], v[168:171], a[212:215], v[16:19]
    v_mfma_f32_16x16x32_bf16 v[16:19], v[164:167], a[208:211], v[16:19]
    v_exp_f32 v5, v5
    v_mfma_f32_16x16x32_bf16 v[20:23], v[164:167], a[224:227], 0
    v_cvt_pk_bf16_f32 v108, v4, v5
    v_mfma_f32_16x16x32_bf16 v[20:23], v[168:171], a[228:231], v[20:23]
    v_exp_f32 v6, v6
    v_mfma_f32_16x16x32_bf16 v[20:23], v[172:175], a[232:235], v[20:23]
    buffer_load_dwordx4 v[248:251], v235, s[60:63], s12 offen sc1
    v_mfma_f32_16x16x32_bf16 v[20:23], v[176:179], a[236:239], v[20:23]
    s_waitcnt lgkmcnt(4)
    v_exp_f32 v7, v7
    v_mfma_f32_16x16x32_bf16 a[12:15], v[208:211], v[44:47], a[12:15]
    v_cvt_pk_bf16_f32 v109, v6, v7
    v_mfma_f32_16x16x32_bf16 a[12:15], v[212:215], v[48:51], a[12:15]
    v_exp_f32 v8, v8
    v_mfma_f32_16x16x32_bf16 a[12:15], v[216:219], v[52:55], a[12:15]
    ds_read_b64_tr_b16 v[196:197], v228 offset:0
    ds_read_b64_tr_b16 v[198:199], v228 offset:4096
    v_mfma_f32_16x16x32_bf16 a[44:47], v[216:219], v[64:67], a[44:47]
    s_add_u32 s12, s12, s6
    v_exp_f32 v9, v9
    v_mfma_f32_16x16x32_bf16 a[44:47], v[212:215], v[60:63], a[44:47]
    s_add_u32 m0, s51, 90112
    ds_read_b64_tr_b16 v[200:201], v228 offset:8192
    v_cvt_pk_bf16_f32 v120, v8, v9
    v_mfma_f32_16x16x32_bf16 a[44:47], v[208:211], v[56:59], a[44:47]
    v_exp_f32 v10, v10
    v_mfma_f32_16x16x32_bf16 a[76:79], v[208:211], v[68:71], a[76:79]
    buffer_load_dwordx4 v1, s[28:31], s51 offen lds
    v_mfma_f32_16x16x32_bf16 a[76:79], v[212:215], v[72:75], a[76:79]
    v_exp_f32 v11, v11
    v_mfma_f32_16x16x32_bf16 a[76:79], v[216:219], v[76:79], a[76:79]
    ds_read_b64_tr_b16 v[202:203], v228 offset:12288
    v_cvt_pk_bf16_f32 v121, v10, v11
    v_mfma_f32_16x16x32_bf16 a[108:111], v[216:219], v[88:91], a[108:111]
    v_exp_f32 v12, v12
    v_mfma_f32_16x16x32_bf16 a[108:111], v[212:215], v[84:87], a[108:111]
    ds_read_b64_tr_b16 v[204:205], v228 offset:16384
    ds_read_b64_tr_b16 v[206:207], v228 offset:20480
    v_mfma_f32_16x16x32_bf16 a[108:111], v[208:211], v[80:83], a[108:111]
    v_exp_f32 v13, v13
    v_mfma_f32_16x16x32_bf16 a[140:143], v[208:211], v[92:95], a[140:143]
    v_cvt_pk_bf16_f32 v132, v12, v13
    v_add_u32 v228, s44, v228
    v_mfma_f32_16x16x32_bf16 a[140:143], v[212:215], v[96:99], a[140:143]
    v_exp_f32 v14, v14
    v_mfma_f32_16x16x32_bf16 a[140:143], v[216:219], v[100:103], a[140:143]
    s_waitcnt lgkmcnt(6)
    v_mfma_f32_16x16x32_bf16 v[24:27], v[180:183], a[160:163], 0
    v_exp_f32 v15, v15
    v_mfma_f32_16x16x32_bf16 v[24:27], v[184:187], a[164:167], v[24:27]
    ds_read_b64_tr_b16 v[208:209], v229 offset:0
    v_cvt_pk_bf16_f32 v133, v14, v15
    v_mfma_f32_16x16x32_bf16 v[24:27], v[188:191], a[168:171], v[24:27]
    v_exp_f32 v16, v16
    v_mfma_f32_16x16x32_bf16 v[24:27], v[192:195], a[172:175], v[24:27]
    buffer_load_dwordx4 v1, s[28:31], s51 offen offset:1024 lds
    v_mfma_f32_16x16x32_bf16 v[28:31], v[192:195], a[188:191], 0
    v_exp_f32 v17, v17
    v_mfma_f32_16x16x32_bf16 v[28:31], v[188:191], a[184:187], v[28:31]
    ds_read_b64_tr_b16 v[210:211], v229 offset:4096
    v_cvt_pk_bf16_f32 v144, v16, v17
    v_mfma_f32_16x16x32_bf16 v[28:31], v[184:187], a[180:183], v[28:31]
    v_exp_f32 v18, v18
    v_mfma_f32_16x16x32_bf16 v[28:31], v[180:183], a[176:179], v[28:31]
    ds_read_b64_tr_b16 v[212:213], v229 offset:8192
    ds_read_b64_tr_b16 v[214:215], v229 offset:12288
    v_mfma_f32_16x16x32_bf16 v[32:35], v[180:183], a[192:195], 0
    s_add_u32 s51, s51, 2048
    v_exp_f32 v19, v19
    v_mfma_f32_16x16x32_bf16 v[32:35], v[184:187], a[196:199], v[32:35]
    s_min_u32 s51, s51, s50
    ds_read_b64_tr_b16 v[216:217], v229 offset:16384
    v_cvt_pk_bf16_f32 v145, v18, v19
    v_mfma_f32_16x16x32_bf16 v[32:35], v[188:191], a[200:203], v[32:35]
    v_exp_f32 v20, v20
    v_mfma_f32_16x16x32_bf16 v[32:35], v[192:195], a[204:207], v[32:35]
    ds_read_b64_tr_b16 v[218:219], v229 offset:20480
    v_add_u32 v229, s44, v229
    v_mfma_f32_16x16x32_bf16 v[36:39], v[192:195], a[220:223], 0
    v_exp_f32 v21, v21
    v_mfma_f32_16x16x32_bf16 v[36:39], v[188:191], a[216:219], v[36:39]
    v_cvt_pk_bf16_f32 v156, v20, v21
    v_mfma_f32_16x16x32_bf16 v[36:39], v[184:187], a[212:215], v[36:39]
    v_exp_f32 v22, v22
    v_mfma_f32_16x16x32_bf16 v[36:39], v[180:183], a[208:211], v[36:39]
    v_mfma_f32_16x16x32_bf16 v[40:43], v[180:183], a[224:227], 0
    v_exp_f32 v23, v23
    v_mfma_f32_16x16x32_bf16 v[40:43], v[184:187], a[228:231], v[40:43]
    v_cvt_pk_bf16_f32 v157, v22, v23
    v_mfma_f32_16x16x32_bf16 v[40:43], v[188:191], a[232:235], v[40:43]
    v_exp_f32 v24, v24
    v_mfma_f32_16x16x32_bf16 v[40:43], v[192:195], a[236:239], v[40:43]
    s_waitcnt lgkmcnt(6)
    v_mfma_f32_16x16x32_bf16 a[16:19], v[196:199], v[44:47], a[16:19]
    v_exp_f32 v25, v25
    v_mfma_f32_16x16x32_bf16 a[16:19], v[200:203], v[48:51], a[16:19]
    v_cvt_pk_bf16_f32 v110, v24, v25
    v_mfma_f32_16x16x32_bf16 a[16:19], v[204:207], v[52:55], a[16:19]
    v_exp_f32 v26, v26
    v_mfma_f32_16x16x32_bf16 a[48:51], v[204:207], v[64:67], a[48:51]
    ds_read_b128 v[164:167], v220 offset:16384
    ds_read_b128 v[168:171], v221 offset:16384
    v_mfma_f32_16x16x32_bf16 a[48:51], v[200:203], v[60:63], a[48:51]
    v_exp_f32 v27, v27
    v_mfma_f32_16x16x32_bf16 a[48:51], v[196:199], v[56:59], a[48:51]
    ds_read_b128 v[172:175], v222 offset:16384
    v_cvt_pk_bf16_f32 v111, v26, v27
    v_mfma_f32_16x16x32_bf16 a[80:83], v[196:199], v[68:71], a[80:83]
    v_exp_f32 v28, v28
    v_mfma_f32_16x16x32_bf16 a[80:83], v[200:203], v[72:75], a[80:83]
    ds_read_b128 v[176:179], v223 offset:16384
    v_mfma_f32_16x16x32_bf16 a[80:83], v[204:207], v[76:79], a[80:83]
    v_exp_f32 v29, v29
    v_mfma_f32_16x16x32_bf16 a[112:115], v[204:207], v[88:91], a[112:115]
    v_cvt_pk_bf16_f32 v122, v28, v29
    v_mfma_f32_16x16x32_bf16 a[112:115], v[200:203], v[84:87], a[112:115]
    v_exp_f32 v30, v30
    v_mfma_f32_16x16x32_bf16 a[112:115], v[196:199], v[80:83], a[112:115]
    v_mfma_f32_16x16x32_bf16 a[144:147], v[196:199], v[92:95], a[144:147]
    v_exp_f32 v31, v31
    v_mfma_f32_16x16x32_bf16 a[144:147], v[200:203], v[96:99], a[144:147]
    v_cvt_pk_bf16_f32 v123, v30, v31
    v_mfma_f32_16x16x32_bf16 a[144:147], v[204:207], v[100:103], a[144:147]
    s_waitcnt lgkmcnt(4)
    v_exp_f32 v32, v32
    v_mfma_f32_16x16x32_bf16 a[20:23], v[208:211], v[44:47], a[20:23]
    v_mfma_f32_16x16x32_bf16 a[20:23], v[212:215], v[48:51], a[20:23]
    v_exp_f32 v33, v33
    v_mfma_f32_16x16x32_bf16 a[20:23], v[216:219], v[52:55], a[20:23]
    ds_read_b64_tr_b16 v[196:197], v230 offset:0
    v_cvt_pk_bf16_f32 v134, v32, v33
    v_mfma_f32_16x16x32_bf16 a[52:55], v[216:219], v[64:67], a[52:55]
    v_exp_f32 v34, v34
    v_mfma_f32_16x16x32_bf16 a[52:55], v[212:215], v[60:63], a[52:55]
    ds_read_b64_tr_b16 v[198:199], v230 offset:4096
    ds_read_b64_tr_b16 v[200:201], v230 offset:8192
    v_mfma_f32_16x16x32_bf16 a[52:55], v[208:211], v[56:59], a[52:55]
    v_exp_f32 v35, v35
    v_mfma_f32_16x16x32_bf16 a[84:87], v[208:211], v[68:71], a[84:87]
    ds_read_b64_tr_b16 v[202:203], v230 offset:12288
    v_cvt_pk_bf16_f32 v135, v34, v35
    v_mfma_f32_16x16x32_bf16 a[84:87], v[212:215], v[72:75], a[84:87]
    v_exp_f32 v36, v36
    v_mfma_f32_16x16x32_bf16 a[84:87], v[216:219], v[76:79], a[84:87]
    ds_read_b64_tr_b16 v[204:205], v230 offset:16384
    ds_read_b64_tr_b16 v[206:207], v230 offset:20480
    v_mfma_f32_16x16x32_bf16 a[116:119], v[216:219], v[88:91], a[116:119]
    v_exp_f32 v37, v37
    v_mfma_f32_16x16x32_bf16 a[116:119], v[212:215], v[84:87], a[116:119]
    v_cvt_pk_bf16_f32 v146, v36, v37
    v_add_u32 v230, s44, v230
    v_mfma_f32_16x16x32_bf16 a[116:119], v[208:211], v[80:83], a[116:119]
    v_exp_f32 v38, v38
    v_mfma_f32_16x16x32_bf16 a[148:151], v[208:211], v[92:95], a[148:151]
    v_mfma_f32_16x16x32_bf16 a[148:151], v[212:215], v[96:99], a[148:151]
    v_exp_f32 v39, v39
    v_mfma_f32_16x16x32_bf16 a[148:151], v[216:219], v[100:103], a[148:151]
    s_waitcnt lgkmcnt(6)
    v_cvt_pk_bf16_f32 v147, v38, v39
    v_mfma_f32_16x16x32_bf16 v[4:7], v[164:167], a[160:163], 0
    v_exp_f32 v40, v40
    v_mfma_f32_16x16x32_bf16 v[4:7], v[168:171], a[164:167], v[4:7]
    v_mfma_f32_16x16x32_bf16 v[4:7], v[172:175], a[168:171], v[4:7]
    v_exp_f32 v41, v41
    v_mfma_f32_16x16x32_bf16 v[4:7], v[176:179], a[172:175], v[4:7]
    v_cvt_pk_bf16_f32 v158, v40, v41
    v_mfma_f32_16x16x32_bf16 v[8:11], v[176:179], a[188:191], 0
    v_exp_f32 v42, v42
    v_mfma_f32_16x16x32_bf16 v[8:11], v[172:175], a[184:187], v[8:11]
    v_mfma_f32_16x16x32_bf16 v[8:11], v[168:171], a[180:183], v[8:11]
    v_exp_f32 v43, v43
    v_mfma_f32_16x16x32_bf16 v[8:11], v[164:167], a[176:179], v[8:11]
    ds_read_b128 v[180:183], v220 offset:20480
    v_cvt_pk_bf16_f32 v159, v42, v43
    v_mfma_f32_16x16x32_bf16 v[12:15], v[164:167], a[192:195], 0
    v_exp_f32 v4, v4
    v_mfma_f32_16x16x32_bf16 v[12:15], v[168:171], a[196:199], v[12:15]
    ds_read_b128 v[184:187], v221 offset:20480
    ds_read_b128 v[188:191], v222 offset:20480
    v_mfma_f32_16x16x32_bf16 v[12:15], v[172:175], a[200:203], v[12:15]
    v_exp_f32 v5, v5
    v_mfma_f32_16x16x32_bf16 v[12:15], v[176:179], a[204:207], v[12:15]
    ds_read_b128 v[192:195], v223 offset:20480
    v_cvt_pk_bf16_f32 v112, v4, v5
    v_mfma_f32_16x16x32_bf16 v[16:19], v[176:179], a[220:223], 0
    v_exp_f32 v6, v6
    v_mfma_f32_16x16x32_bf16 v[16:19], v[172:175], a[216:219], v[16:19]
    v_add_u32 v220, s43, v220
    v_add_u32 v221, s43, v221
    v_mfma_f32_16x16x32_bf16 v[16:19], v[168:171], a[212:215], v[16:19]
    v_exp_f32 v7, v7
    v_mfma_f32_16x16x32_bf16 v[16:19], v[164:167], a[208:211], v[16:19]
    v_cvt_pk_bf16_f32 v113, v6, v7
    v_add_u32 v222, s43, v222
    v_mfma_f32_16x16x32_bf16 v[20:23], v[164:167], a[224:227], 0
    v_exp_f32 v8, v8
    v_mfma_f32_16x16x32_bf16 v[20:23], v[168:171], a[228:231], v[20:23]
    v_add_u32 v223, s43, v223
    v_mfma_f32_16x16x32_bf16 v[20:23], v[172:175], a[232:235], v[20:23]
    v_exp_f32 v9, v9
    v_mfma_f32_16x16x32_bf16 v[20:23], v[176:179], a[236:239], v[20:23]
    s_waitcnt lgkmcnt(4)
    v_cvt_pk_bf16_f32 v124, v8, v9
    v_mfma_f32_16x16x32_bf16 a[24:27], v[196:199], v[44:47], a[24:27]
    v_exp_f32 v10, v10
    v_mfma_f32_16x16x32_bf16 a[24:27], v[200:203], v[48:51], a[24:27]
    ds_read_b64_tr_b16 v[208:209], v231 offset:0
    ds_read_b64_tr_b16 v[210:211], v231 offset:4096
    v_mfma_f32_16x16x32_bf16 a[24:27], v[204:207], v[52:55], a[24:27]
    v_exp_f32 v11, v11
    v_mfma_f32_16x16x32_bf16 a[56:59], v[204:207], v[64:67], a[56:59]
    ds_read_b64_tr_b16 v[212:213], v231 offset:8192
    v_cvt_pk_bf16_f32 v125, v10, v11
    v_mfma_f32_16x16x32_bf16 a[56:59], v[200:203], v[60:63], a[56:59]
    v_exp_f32 v12, v12
    v_mfma_f32_16x16x32_bf16 a[56:59], v[196:199], v[56:59], a[56:59]
    s_mov_b32 s47, s40
    ds_read_b64_tr_b16 v[214:215], v231 offset:12288
    ds_read_b64_tr_b16 v[216:217], v231 offset:16384
    v_mfma_f32_16x16x32_bf16 a[88:91], v[196:199], v[68:71], a[88:91]
    s_mov_b32 s40, s41
    v_exp_f32 v13, v13
    v_mfma_f32_16x16x32_bf16 a[88:91], v[200:203], v[72:75], a[88:91]
    s_mov_b32 s41, s42
    ds_read_b64_tr_b16 v[218:219], v231 offset:20480
    v_cvt_pk_bf16_f32 v136, v12, v13
    v_mfma_f32_16x16x32_bf16 a[88:91], v[204:207], v[76:79], a[88:91]
    s_mov_b32 s42, s47
    v_exp_f32 v14, v14
    v_mfma_f32_16x16x32_bf16 a[120:123], v[204:207], v[88:91], a[120:123]
    v_add_u32 v231, s44, v231
    v_mfma_f32_16x16x32_bf16 a[120:123], v[200:203], v[84:87], a[120:123]
    v_exp_f32 v15, v15
    v_mfma_f32_16x16x32_bf16 a[120:123], v[196:199], v[80:83], a[120:123]
    v_cvt_pk_bf16_f32 v137, v14, v15
    v_mfma_f32_16x16x32_bf16 a[152:155], v[196:199], v[92:95], a[152:155]
    v_exp_f32 v16, v16
    v_mfma_f32_16x16x32_bf16 a[152:155], v[200:203], v[96:99], a[152:155]
    v_mfma_f32_16x16x32_bf16 a[152:155], v[204:207], v[100:103], a[152:155]
    s_waitcnt lgkmcnt(6)
    v_exp_f32 v17, v17
    v_mfma_f32_16x16x32_bf16 v[24:27], v[180:183], a[160:163], 0
    v_cvt_pk_bf16_f32 v148, v16, v17
    v_mfma_f32_16x16x32_bf16 v[24:27], v[184:187], a[164:167], v[24:27]
    v_exp_f32 v18, v18
    v_mfma_f32_16x16x32_bf16 v[24:27], v[188:191], a[168:171], v[24:27]
    v_mfma_f32_16x16x32_bf16 v[24:27], v[192:195], a[172:175], v[24:27]
    v_exp_f32 v19, v19
    v_mfma_f32_16x16x32_bf16 v[28:31], v[192:195], a[188:191], 0
    v_cvt_pk_bf16_f32 v149, v18, v19
    v_mfma_f32_16x16x32_bf16 v[28:31], v[188:191], a[184:187], v[28:31]
    v_exp_f32 v20, v20
    v_mfma_f32_16x16x32_bf16 v[28:31], v[184:187], a[180:183], v[28:31]
    v_mfma_f32_16x16x32_bf16 v[28:31], v[180:183], a[176:179], v[28:31]
    v_exp_f32 v21, v21
    v_mfma_f32_16x16x32_bf16 v[32:35], v[180:183], a[192:195], 0
    v_cvt_pk_bf16_f32 v160, v20, v21
    v_mfma_f32_16x16x32_bf16 v[32:35], v[184:187], a[196:199], v[32:35]
    v_exp_f32 v22, v22
    v_mfma_f32_16x16x32_bf16 v[32:35], v[188:191], a[200:203], v[32:35]
    v_mfma_f32_16x16x32_bf16 v[32:35], v[192:195], a[204:207], v[32:35]
    v_exp_f32 v23, v23
    v_mfma_f32_16x16x32_bf16 v[36:39], v[192:195], a[220:223], 0
    v_cvt_pk_bf16_f32 v161, v22, v23
    v_mfma_f32_16x16x32_bf16 v[36:39], v[188:191], a[216:219], v[36:39]
    v_exp_f32 v24, v24
    v_mfma_f32_16x16x32_bf16 v[36:39], v[184:187], a[212:215], v[36:39]
    v_mfma_f32_16x16x32_bf16 v[36:39], v[180:183], a[208:211], v[36:39]
    v_exp_f32 v25, v25
    v_mfma_f32_16x16x32_bf16 v[40:43], v[180:183], a[224:227], 0
    v_cvt_pk_bf16_f32 v114, v24, v25
    v_mfma_f32_16x16x32_bf16 v[40:43], v[184:187], a[228:231], v[40:43]
    v_exp_f32 v26, v26
    v_mfma_f32_16x16x32_bf16 v[40:43], v[188:191], a[232:235], v[40:43]
    v_mfma_f32_16x16x32_bf16 v[40:43], v[192:195], a[236:239], v[40:43]
    s_waitcnt vmcnt(0) lgkmcnt(0)
    s_barrier
    v_exp_f32 v27, v27
    v_mfma_f32_16x16x32_bf16 a[28:31], v[208:211], v[44:47], a[28:31]
    ds_read_b128 v[164:167], v220 offset:0
    v_cvt_pk_bf16_f32 v115, v26, v27
    v_mfma_f32_16x16x32_bf16 a[28:31], v[212:215], v[48:51], a[28:31]
    v_exp_f32 v28, v28
    v_mfma_f32_16x16x32_bf16 a[28:31], v[216:219], v[52:55], a[28:31]
    ds_read_b128 v[168:171], v221 offset:0
    ds_read_b128 v[172:175], v222 offset:0
    v_mfma_f32_16x16x32_bf16 a[60:63], v[216:219], v[64:67], a[60:63]
    v_exp_f32 v29, v29
    v_mfma_f32_16x16x32_bf16 a[60:63], v[212:215], v[60:63], a[60:63]
    ds_read_b128 v[176:179], v223 offset:0
    v_cvt_pk_bf16_f32 v126, v28, v29
    v_mfma_f32_16x16x32_bf16 a[60:63], v[208:211], v[56:59], a[60:63]
    v_exp_f32 v30, v30
    v_mfma_f32_16x16x32_bf16 a[92:95], v[208:211], v[68:71], a[92:95]
    v_mfma_f32_16x16x32_bf16 a[92:95], v[212:215], v[72:75], a[92:95]
    v_exp_f32 v31, v31
    v_mfma_f32_16x16x32_bf16 a[92:95], v[216:219], v[76:79], a[92:95]
    v_cvt_pk_bf16_f32 v127, v30, v31
    v_mfma_f32_16x16x32_bf16 a[124:127], v[216:219], v[88:91], a[124:127]
    v_exp_f32 v32, v32
    v_mfma_f32_16x16x32_bf16 a[124:127], v[212:215], v[84:87], a[124:127]
    v_mfma_f32_16x16x32_bf16 a[124:127], v[208:211], v[80:83], a[124:127]
    v_exp_f32 v33, v33
    v_mfma_f32_16x16x32_bf16 a[156:159], v[208:211], v[92:95], a[156:159]
    v_cvt_pk_bf16_f32 v138, v32, v33
    v_mfma_f32_16x16x32_bf16 a[156:159], v[212:215], v[96:99], a[156:159]
    v_exp_f32 v34, v34
    v_mfma_f32_16x16x32_bf16 a[156:159], v[216:219], v[100:103], a[156:159]
    s_waitcnt lgkmcnt(0)
    v_mfma_f32_16x16x32_bf16 v[4:7], v[164:167], a[160:163], 0
    s_sub_u32 s43, s42, s41
    v_exp_f32 v35, v35
    v_mfma_f32_16x16x32_bf16 v[4:7], v[168:171], a[164:167], v[4:7]
    s_sub_u32 s44, s41, s40
    ds_read_b64_tr_b16 v[196:197], v224 offset:0
    v_cvt_pk_bf16_f32 v139, v34, v35
    v_mfma_f32_16x16x32_bf16 v[4:7], v[172:175], a[168:171], v[4:7]
    v_exp_f32 v36, v36
    v_mfma_f32_16x16x32_bf16 v[4:7], v[176:179], a[172:175], v[4:7]
    ds_read_b64_tr_b16 v[198:199], v224 offset:4096
    ds_read_b64_tr_b16 v[200:201], v224 offset:8192
    v_mfma_f32_16x16x32_bf16 v[8:11], v[176:179], a[188:191], 0
    v_exp_f32 v37, v37
    v_mfma_f32_16x16x32_bf16 v[8:11], v[172:175], a[184:187], v[8:11]
    ds_read_b64_tr_b16 v[202:203], v224 offset:12288
    v_cvt_pk_bf16_f32 v150, v36, v37
    v_mfma_f32_16x16x32_bf16 v[8:11], v[168:171], a[180:183], v[8:11]
    v_exp_f32 v38, v38
    v_mfma_f32_16x16x32_bf16 v[8:11], v[164:167], a[176:179], v[8:11]
    ds_read_b64_tr_b16 v[204:205], v224 offset:16384
    ds_read_b64_tr_b16 v[206:207], v224 offset:20480
    v_mfma_f32_16x16x32_bf16 v[12:15], v[164:167], a[192:195], 0
    v_exp_f32 v39, v39
    v_mfma_f32_16x16x32_bf16 v[12:15], v[168:171], a[196:199], v[12:15]
    ds_read_b128 v[180:183], v220 offset:4096
    v_cvt_pk_bf16_f32 v151, v38, v39
    v_mfma_f32_16x16x32_bf16 v[12:15], v[172:175], a[200:203], v[12:15]
    v_exp_f32 v40, v40
    v_mfma_f32_16x16x32_bf16 v[12:15], v[176:179], a[204:207], v[12:15]
    ds_read_b128 v[184:187], v221 offset:4096
    ds_read_b128 v[188:191], v222 offset:4096
    v_mfma_f32_16x16x32_bf16 v[16:19], v[176:179], a[220:223], 0
    v_exp_f32 v41, v41
    v_mfma_f32_16x16x32_bf16 v[16:19], v[172:175], a[216:219], v[16:19]
    ds_read_b128 v[192:195], v223 offset:4096
    v_cvt_pk_bf16_f32 v162, v40, v41
    v_mfma_f32_16x16x32_bf16 v[16:19], v[168:171], a[212:215], v[16:19]
    v_exp_f32 v42, v42
    v_mfma_f32_16x16x32_bf16 v[16:19], v[164:167], a[208:211], v[16:19]
    v_add_u32 v224, s44, v224
    v_mfma_f32_16x16x32_bf16 v[20:23], v[164:167], a[224:227], 0
    v_exp_f32 v43, v43
    v_mfma_f32_16x16x32_bf16 v[20:23], v[168:171], a[228:231], v[20:23]
    v_cvt_pk_bf16_f32 v163, v42, v43
    v_mfma_f32_16x16x32_bf16 v[20:23], v[172:175], a[232:235], v[20:23]
    v_exp_f32 v4, v4
    v_mfma_f32_16x16x32_bf16 v[20:23], v[176:179], a[236:239], v[20:23]
    s_waitcnt lgkmcnt(4)
    v_mfma_f32_16x16x32_bf16 a[0:3], v[196:199], v[104:107], a[0:3]
    v_exp_f32 v5, v5
    v_mfma_f32_16x16x32_bf16 a[0:3], v[200:203], v[108:111], a[0:3]
    ds_read_b64_tr_b16 v[208:209], v225 offset:0
    v_cvt_pk_bf16_f32 v44, v4, v5
    v_mfma_f32_16x16x32_bf16 a[0:3], v[204:207], v[112:115], a[0:3]
    v_exp_f32 v6, v6
    v_mfma_f32_16x16x32_bf16 a[32:35], v[204:207], v[124:127], a[32:35]
    ds_read_b64_tr_b16 v[210:211], v225 offset:4096
    ds_read_b64_tr_b16 v[212:213], v225 offset:8192
    v_mfma_f32_16x16x32_bf16 a[32:35], v[200:203], v[120:123], a[32:35]
    v_exp_f32 v7, v7
    v_mfma_f32_16x16x32_bf16 a[32:35], v[196:199], v[116:119], a[32:35]
    ds_read_b64_tr_b16 v[214:215], v225 offset:12288
    v_cvt_pk_bf16_f32 v45, v6, v7
    v_mfma_f32_16x16x32_bf16 a[64:67], v[196:199], v[128:131], a[64:67]
    v_exp_f32 v8, v8
    v_mfma_f32_16x16x32_bf16 a[64:67], v[200:203], v[132:135], a[64:67]
    ds_read_b64_tr_b16 v[216:217], v225 offset:16384
    ds_read_b64_tr_b16 v[218:219], v225 offset:20480
    v_mfma_f32_16x16x32_bf16 a[64:67], v[204:207], v[136:139], a[64:67]
    v_exp_f32 v9, v9
    v_mfma_f32_16x16x32_bf16 a[96:99], v[204:207], v[148:151], a[96:99]
    v_cvt_pk_bf16_f32 v56, v8, v9
    v_add_u32 v225, s44, v225
    v_mfma_f32_16x16x32_bf16 a[96:99], v[200:203], v[144:147], a[96:99]
    v_exp_f32 v10, v10
    v_mfma_f32_16x16x32_bf16 a[96:99], v[196:199], v[140:143], a[96:99]
    v_mfma_f32_16x16x32_bf16 a[128:131], v[196:199], v[152:155], a[128:131]
    v_exp_f32 v11, v11
    v_mfma_f32_16x16x32_bf16 a[128:131], v[200:203], v[156:159], a[128:131]
    v_cvt_pk_bf16_f32 v57, v10, v11
    v_mfma_f32_16x16x32_bf16 a[128:131], v[204:207], v[160:163], a[128:131]
    s_waitcnt lgkmcnt(6)
    v_exp_f32 v12, v12
    v_mfma_f32_16x16x32_bf16 v[24:27], v[180:183], a[160:163], 0
    v_mfma_f32_16x16x32_bf16 v[24:27], v[184:187], a[164:167], v[24:27]
    s_add_u32 s47, s46, s42
    v_exp_f32 v13, v13
    v_mfma_f32_16x16x32_bf16 v[24:27], v[188:191], a[168:171], v[24:27]
    s_mov_b32 m0, s47
    ds_read_b64_tr_b16 v[196:197], v226 offset:0
    v_cvt_pk_bf16_f32 v68, v12, v13
    v_mfma_f32_16x16x32_bf16 v[24:27], v[192:195], a[172:175], v[24:27]
    v_exp_f32 v14, v14
    v_mfma_f32_16x16x32_bf16 v[28:31], v[192:195], a[188:191], 0
    buffer_load_dwordx4 v232, s[8:11], s45 offen offset:0 lds
    v_mfma_f32_16x16x32_bf16 v[28:31], v[188:191], a[184:187], v[28:31]
    v_exp_f32 v15, v15
    v_mfma_f32_16x16x32_bf16 v[28:31], v[184:187], a[180:183], v[28:31]
    ds_read_b64_tr_b16 v[198:199], v226 offset:4096
    v_cvt_pk_bf16_f32 v69, v14, v15
    v_mfma_f32_16x16x32_bf16 v[28:31], v[180:183], a[176:179], v[28:31]
    v_exp_f32 v16, v16
    v_mfma_f32_16x16x32_bf16 v[32:35], v[180:183], a[192:195], 0
    ds_read_b64_tr_b16 v[200:201], v226 offset:8192
    ds_read_b64_tr_b16 v[202:203], v226 offset:12288
    v_mfma_f32_16x16x32_bf16 v[32:35], v[184:187], a[196:199], v[32:35]
    v_exp_f32 v17, v17
    v_mfma_f32_16x16x32_bf16 v[32:35], v[188:191], a[200:203], v[32:35]
    ds_read_b64_tr_b16 v[204:205], v226 offset:16384
    v_cvt_pk_bf16_f32 v80, v16, v17
    v_mfma_f32_16x16x32_bf16 v[32:35], v[192:195], a[204:207], v[32:35]
    v_exp_f32 v18, v18
    v_mfma_f32_16x16x32_bf16 v[36:39], v[192:195], a[220:223], 0
    buffer_load_dwordx4 v232, s[8:11], s45 offen offset:1024 lds
    v_mfma_f32_16x16x32_bf16 v[36:39], v[188:191], a[216:219], v[36:39]
    v_exp_f32 v19, v19
    v_mfma_f32_16x16x32_bf16 v[36:39], v[184:187], a[212:215], v[36:39]
    ds_read_b64_tr_b16 v[206:207], v226 offset:20480
    v_cvt_pk_bf16_f32 v81, v18, v19
    v_mfma_f32_16x16x32_bf16 v[36:39], v[180:183], a[208:211], v[36:39]
    v_exp_f32 v20, v20
    v_mfma_f32_16x16x32_bf16 v[40:43], v[180:183], a[224:227], 0
    v_add_u32 v226, s44, v226
    v_mfma_f32_16x16x32_bf16 v[40:43], v[184:187], a[228:231], v[40:43]
    v_exp_f32 v21, v21
    v_mfma_f32_16x16x32_bf16 v[40:43], v[188:191], a[232:235], v[40:43]
    v_cvt_pk_bf16_f32 v92, v20, v21
    v_mfma_f32_16x16x32_bf16 v[40:43], v[192:195], a[236:239], v[40:43]
    s_waitcnt lgkmcnt(6)
    v_exp_f32 v22, v22
    v_mfma_f32_16x16x32_bf16 a[4:7], v[208:211], v[104:107], a[4:7]
    buffer_load_dwordx4 v232, s[8:11], s45 offen offset:2048 lds
    v_mfma_f32_16x16x32_bf16 a[4:7], v[212:215], v[108:111], a[4:7]
    v_exp_f32 v23, v23
    v_mfma_f32_16x16x32_bf16 a[4:7], v[216:219], v[112:115], a[4:7]
    ds_read_b128 v[164:167], v220 offset:8192
    v_cvt_pk_bf16_f32 v93, v22, v23
    v_mfma_f32_16x16x32_bf16 a[36:39], v[216:219], v[124:127], a[36:39]
    v_exp_f32 v24, v24
    v_mfma_f32_16x16x32_bf16 a[36:39], v[212:215], v[120:123], a[36:39]
    ds_read_b128 v[168:171], v221 offset:8192
    ds_read_b128 v[172:175], v222 offset:8192
    v_mfma_f32_16x16x32_bf16 a[36:39], v[208:211], v[116:119], a[36:39]
    v_exp_f32 v25, v25
    v_mfma_f32_16x16x32_bf16 a[68:71], v[208:211], v[128:131], a[68:71]
    ds_read_b128 v[176:179], v223 offset:8192
    v_cvt_pk_bf16_f32 v46, v24, v25
    v_mfma_f32_16x16x32_bf16 a[68:71], v[212:215], v[132:135], a[68:71]
    v_exp_f32 v26, v26
    v_mfma_f32_16x16x32_bf16 a[68:71], v[216:219], v[136:139], a[68:71]
    buffer_load_dwordx4 v232, s[8:11], s45 offen offset:3072 lds
    v_mfma_f32_16x16x32_bf16 a[100:103], v[216:219], v[148:151], a[100:103]
    v_exp_f32 v27, v27
    v_mfma_f32_16x16x32_bf16 a[100:103], v[212:215], v[144:147], a[100:103]
    v_cvt_pk_bf16_f32 v47, v26, v27
    v_mfma_f32_16x16x32_bf16 a[100:103], v[208:211], v[140:143], a[100:103]
    v_exp_f32 v28, v28
    v_mfma_f32_16x16x32_bf16 a[132:135], v[208:211], v[152:155], a[132:135]
    v_mfma_f32_16x16x32_bf16 a[132:135], v[212:215], v[156:159], a[132:135]
    v_exp_f32 v29, v29
    v_mfma_f32_16x16x32_bf16 a[132:135], v[216:219], v[160:163], a[132:135]
    s_waitcnt lgkmcnt(4)
    v_cvt_pk_bf16_f32 v58, v28, v29
    v_mfma_f32_16x16x32_bf16 a[8:11], v[196:199], v[104:107], a[8:11]
    s_add_u32 s45, s45, 4096
    v_exp_f32 v30, v30
    v_mfma_f32_16x16x32_bf16 a[8:11], v[200:203], v[108:111], a[8:11]
    s_add_u32 m0, m0, 4096
    ds_read_b64_tr_b16 v[208:209], v227 offset:0
    ds_read_b64_tr_b16 v[210:211], v227 offset:4096
    v_mfma_f32_16x16x32_bf16 a[8:11], v[204:207], v[112:115], a[8:11]
    v_exp_f32 v31, v31
    v_mfma_f32_16x16x32_bf16 a[40:43], v[204:207], v[124:127], a[40:43]
    ds_read_b64_tr_b16 v[212:213], v227 offset:8192
    v_cvt_pk_bf16_f32 v59, v30, v31
    v_mfma_f32_16x16x32_bf16 a[40:43], v[200:203], v[120:123], a[40:43]
    v_exp_f32 v32, v32
    v_mfma_f32_16x16x32_bf16 a[40:43], v[196:199], v[116:119], a[40:43]
    buffer_load_dwordx4 v232, s[8:11], s45 offen offset:0 lds
    v_mfma_f32_16x16x32_bf16 a[72:75], v[196:199], v[128:131], a[72:75]
    v_exp_f32 v33, v33
    v_mfma_f32_16x16x32_bf16 a[72:75], v[200:203], v[132:135], a[72:75]
    ds_read_b64_tr_b16 v[214:215], v227 offset:12288
    v_cvt_pk_bf16_f32 v70, v32, v33
    v_mfma_f32_16x16x32_bf16 a[72:75], v[204:207], v[136:139], a[72:75]
    v_exp_f32 v34, v34
    v_mfma_f32_16x16x32_bf16 a[104:107], v[204:207], v[148:151], a[104:107]
    ds_read_b64_tr_b16 v[216:217], v227 offset:16384
    ds_read_b64_tr_b16 v[218:219], v227 offset:20480
    v_mfma_f32_16x16x32_bf16 a[104:107], v[200:203], v[144:147], a[104:107]
    v_exp_f32 v35, v35
    v_mfma_f32_16x16x32_bf16 a[104:107], v[196:199], v[140:143], a[104:107]
    v_cvt_pk_bf16_f32 v71, v34, v35
    v_add_u32 v227, s44, v227
    v_mfma_f32_16x16x32_bf16 a[136:139], v[196:199], v[152:155], a[136:139]
    v_exp_f32 v36, v36
    v_mfma_f32_16x16x32_bf16 a[136:139], v[200:203], v[156:159], a[136:139]
    buffer_load_dwordx4 v232, s[8:11], s45 offen offset:1024 lds
    v_mfma_f32_16x16x32_bf16 a[136:139], v[204:207], v[160:163], a[136:139]
    s_waitcnt lgkmcnt(6)
    v_exp_f32 v37, v37
    v_mfma_f32_16x16x32_bf16 v[4:7], v[164:167], a[160:163], 0
    v_cvt_pk_bf16_f32 v82, v36, v37
    v_mfma_f32_16x16x32_bf16 v[4:7], v[168:171], a[164:167], v[4:7]
    v_exp_f32 v38, v38
    v_mfma_f32_16x16x32_bf16 v[4:7], v[172:175], a[168:171], v[4:7]
    v_mfma_f32_16x16x32_bf16 v[4:7], v[176:179], a[172:175], v[4:7]
    v_exp_f32 v39, v39
    v_mfma_f32_16x16x32_bf16 v[8:11], v[176:179], a[188:191], 0
    s_add_u32 s45, s45, 20480
    v_cvt_pk_bf16_f32 v83, v38, v39
    v_mfma_f32_16x16x32_bf16 v[8:11], v[172:175], a[184:187], v[8:11]
    v_exp_f32 v40, v40
    v_mfma_f32_16x16x32_bf16 v[8:11], v[168:171], a[180:183], v[8:11]
    v_mfma_f32_16x16x32_bf16 v[8:11], v[164:167], a[176:179], v[8:11]
    v_exp_f32 v41, v41
    v_mfma_f32_16x16x32_bf16 v[12:15], v[164:167], a[192:195], 0
    ds_read_b128 v[180:183], v220 offset:12288
    v_cvt_pk_bf16_f32 v94, v40, v41
    v_mfma_f32_16x16x32_bf16 v[12:15], v[168:171], a[196:199], v[12:15]
    v_exp_f32 v42, v42
    v_mfma_f32_16x16x32_bf16 v[12:15], v[172:175], a[200:203], v[12:15]
    ds_read_b128 v[184:187], v221 offset:12288
    ds_read_b128 v[188:191], v222 offset:12288
    v_mfma_f32_16x16x32_bf16 v[12:15], v[176:179], a[204:207], v[12:15]
    v_exp_f32 v43, v43
    v_mfma_f32_16x16x32_bf16 v[16:19], v[176:179], a[220:223], 0
    ds_read_b128 v[192:195], v223 offset:12288
    v_cvt_pk_bf16_f32 v95, v42, v43
    v_mfma_f32_16x16x32_bf16 v[16:19], v[172:175], a[216:219], v[16:19]
    v_exp_f32 v4, v4
    v_mfma_f32_16x16x32_bf16 v[16:19], v[168:171], a[212:215], v[16:19]
    v_mfma_f32_16x16x32_bf16 v[16:19], v[164:167], a[208:211], v[16:19]
    v_exp_f32 v5, v5
    v_mfma_f32_16x16x32_bf16 v[20:23], v[164:167], a[224:227], 0
    v_cvt_pk_bf16_f32 v48, v4, v5
    v_mfma_f32_16x16x32_bf16 v[20:23], v[168:171], a[228:231], v[20:23]
    v_exp_f32 v6, v6
    v_mfma_f32_16x16x32_bf16 v[20:23], v[172:175], a[232:235], v[20:23]
    buffer_load_dwordx4 v[248:251], v235, s[60:63], s12 offen sc1
    v_mfma_f32_16x16x32_bf16 v[20:23], v[176:179], a[236:239], v[20:23]
    s_waitcnt lgkmcnt(4)
    v_exp_f32 v7, v7
    v_mfma_f32_16x16x32_bf16 a[12:15], v[208:211], v[104:107], a[12:15]
    v_cvt_pk_bf16_f32 v49, v6, v7
    v_mfma_f32_16x16x32_bf16 a[12:15], v[212:215], v[108:111], a[12:15]
    v_exp_f32 v8, v8
    v_mfma_f32_16x16x32_bf16 a[12:15], v[216:219], v[112:115], a[12:15]
    ds_read_b64_tr_b16 v[196:197], v228 offset:0
    ds_read_b64_tr_b16 v[198:199], v228 offset:4096
    v_mfma_f32_16x16x32_bf16 a[44:47], v[216:219], v[124:127], a[44:47]
    s_add_u32 s12, s12, s6
    v_exp_f32 v9, v9
    v_mfma_f32_16x16x32_bf16 a[44:47], v[212:215], v[120:123], a[44:47]
    s_add_u32 m0, s51, 90112
    ds_read_b64_tr_b16 v[200:201], v228 offset:8192
    v_cvt_pk_bf16_f32 v60, v8, v9
    v_mfma_f32_16x16x32_bf16 a[44:47], v[208:211], v[116:119], a[44:47]
    v_exp_f32 v10, v10
    v_mfma_f32_16x16x32_bf16 a[76:79], v[208:211], v[128:131], a[76:79]
    buffer_load_dwordx4 v1, s[28:31], s51 offen lds
    v_mfma_f32_16x16x32_bf16 a[76:79], v[212:215], v[132:135], a[76:79]
    v_exp_f32 v11, v11
    v_mfma_f32_16x16x32_bf16 a[76:79], v[216:219], v[136:139], a[76:79]
    ds_read_b64_tr_b16 v[202:203], v228 offset:12288
    v_cvt_pk_bf16_f32 v61, v10, v11
    v_mfma_f32_16x16x32_bf16 a[108:111], v[216:219], v[148:151], a[108:111]
    v_exp_f32 v12, v12
    v_mfma_f32_16x16x32_bf16 a[108:111], v[212:215], v[144:147], a[108:111]
    ds_read_b64_tr_b16 v[204:205], v228 offset:16384
    ds_read_b64_tr_b16 v[206:207], v228 offset:20480
    v_mfma_f32_16x16x32_bf16 a[108:111], v[208:211], v[140:143], a[108:111]
    v_exp_f32 v13, v13
    v_mfma_f32_16x16x32_bf16 a[140:143], v[208:211], v[152:155], a[140:143]
    v_cvt_pk_bf16_f32 v72, v12, v13
    v_add_u32 v228, s44, v228
    v_mfma_f32_16x16x32_bf16 a[140:143], v[212:215], v[156:159], a[140:143]
    v_exp_f32 v14, v14
    v_mfma_f32_16x16x32_bf16 a[140:143], v[216:219], v[160:163], a[140:143]
    s_waitcnt lgkmcnt(6)
    v_mfma_f32_16x16x32_bf16 v[24:27], v[180:183], a[160:163], 0
    v_exp_f32 v15, v15
    v_mfma_f32_16x16x32_bf16 v[24:27], v[184:187], a[164:167], v[24:27]
    ds_read_b64_tr_b16 v[208:209], v229 offset:0
    v_cvt_pk_bf16_f32 v73, v14, v15
    v_mfma_f32_16x16x32_bf16 v[24:27], v[188:191], a[168:171], v[24:27]
    v_exp_f32 v16, v16
    v_mfma_f32_16x16x32_bf16 v[24:27], v[192:195], a[172:175], v[24:27]
    buffer_load_dwordx4 v1, s[28:31], s51 offen offset:1024 lds
    v_mfma_f32_16x16x32_bf16 v[28:31], v[192:195], a[188:191], 0
    v_exp_f32 v17, v17
    v_mfma_f32_16x16x32_bf16 v[28:31], v[188:191], a[184:187], v[28:31]
    ds_read_b64_tr_b16 v[210:211], v229 offset:4096
    v_cvt_pk_bf16_f32 v84, v16, v17
    v_mfma_f32_16x16x32_bf16 v[28:31], v[184:187], a[180:183], v[28:31]
    v_exp_f32 v18, v18
    v_mfma_f32_16x16x32_bf16 v[28:31], v[180:183], a[176:179], v[28:31]
    ds_read_b64_tr_b16 v[212:213], v229 offset:8192
    ds_read_b64_tr_b16 v[214:215], v229 offset:12288
    v_mfma_f32_16x16x32_bf16 v[32:35], v[180:183], a[192:195], 0
    s_add_u32 s51, s51, 2048
    v_exp_f32 v19, v19
    v_mfma_f32_16x16x32_bf16 v[32:35], v[184:187], a[196:199], v[32:35]
    s_min_u32 s51, s51, s50
    ds_read_b64_tr_b16 v[216:217], v229 offset:16384
    v_cvt_pk_bf16_f32 v85, v18, v19
    v_mfma_f32_16x16x32_bf16 v[32:35], v[188:191], a[200:203], v[32:35]
    v_exp_f32 v20, v20
    v_mfma_f32_16x16x32_bf16 v[32:35], v[192:195], a[204:207], v[32:35]
    ds_read_b64_tr_b16 v[218:219], v229 offset:20480
    v_add_u32 v229, s44, v229
    v_mfma_f32_16x16x32_bf16 v[36:39], v[192:195], a[220:223], 0
    v_exp_f32 v21, v21
    v_mfma_f32_16x16x32_bf16 v[36:39], v[188:191], a[216:219], v[36:39]
    v_cvt_pk_bf16_f32 v96, v20, v21
    v_mfma_f32_16x16x32_bf16 v[36:39], v[184:187], a[212:215], v[36:39]
    v_exp_f32 v22, v22
    v_mfma_f32_16x16x32_bf16 v[36:39], v[180:183], a[208:211], v[36:39]
    v_mfma_f32_16x16x32_bf16 v[40:43], v[180:183], a[224:227], 0
    v_exp_f32 v23, v23
    v_mfma_f32_16x16x32_bf16 v[40:43], v[184:187], a[228:231], v[40:43]
    v_cvt_pk_bf16_f32 v97, v22, v23
    v_mfma_f32_16x16x32_bf16 v[40:43], v[188:191], a[232:235], v[40:43]
    v_exp_f32 v24, v24
    v_mfma_f32_16x16x32_bf16 v[40:43], v[192:195], a[236:239], v[40:43]
    s_waitcnt lgkmcnt(6)
    v_mfma_f32_16x16x32_bf16 a[16:19], v[196:199], v[104:107], a[16:19]
    v_exp_f32 v25, v25
    v_mfma_f32_16x16x32_bf16 a[16:19], v[200:203], v[108:111], a[16:19]
    v_cvt_pk_bf16_f32 v50, v24, v25
    v_mfma_f32_16x16x32_bf16 a[16:19], v[204:207], v[112:115], a[16:19]
    v_exp_f32 v26, v26
    v_mfma_f32_16x16x32_bf16 a[48:51], v[204:207], v[124:127], a[48:51]
    ds_read_b128 v[164:167], v220 offset:16384
    ds_read_b128 v[168:171], v221 offset:16384
    v_mfma_f32_16x16x32_bf16 a[48:51], v[200:203], v[120:123], a[48:51]
    v_exp_f32 v27, v27
    v_mfma_f32_16x16x32_bf16 a[48:51], v[196:199], v[116:119], a[48:51]
    ds_read_b128 v[172:175], v222 offset:16384
    v_cvt_pk_bf16_f32 v51, v26, v27
    v_mfma_f32_16x16x32_bf16 a[80:83], v[196:199], v[128:131], a[80:83]
    v_exp_f32 v28, v28
    v_mfma_f32_16x16x32_bf16 a[80:83], v[200:203], v[132:135], a[80:83]
    ds_read_b128 v[176:179], v223 offset:16384
    v_mfma_f32_16x16x32_bf16 a[80:83], v[204:207], v[136:139], a[80:83]
    v_exp_f32 v29, v29
    v_mfma_f32_16x16x32_bf16 a[112:115], v[204:207], v[148:151], a[112:115]
    v_cvt_pk_bf16_f32 v62, v28, v29
    v_mfma_f32_16x16x32_bf16 a[112:115], v[200:203], v[144:147], a[112:115]
    v_exp_f32 v30, v30
    v_mfma_f32_16x16x32_bf16 a[112:115], v[196:199], v[140:143], a[112:115]
    v_mfma_f32_16x16x32_bf16 a[144:147], v[196:199], v[152:155], a[144:147]
    v_exp_f32 v31, v31
    v_mfma_f32_16x16x32_bf16 a[144:147], v[200:203], v[156:159], a[144:147]
    v_cvt_pk_bf16_f32 v63, v30, v31
    v_mfma_f32_16x16x32_bf16 a[144:147], v[204:207], v[160:163], a[144:147]
    s_waitcnt lgkmcnt(4)
    v_exp_f32 v32, v32
    v_mfma_f32_16x16x32_bf16 a[20:23], v[208:211], v[104:107], a[20:23]
    v_mfma_f32_16x16x32_bf16 a[20:23], v[212:215], v[108:111], a[20:23]
    v_exp_f32 v33, v33
    v_mfma_f32_16x16x32_bf16 a[20:23], v[216:219], v[112:115], a[20:23]
    ds_read_b64_tr_b16 v[196:197], v230 offset:0
    v_cvt_pk_bf16_f32 v74, v32, v33
    v_mfma_f32_16x16x32_bf16 a[52:55], v[216:219], v[124:127], a[52:55]
    v_exp_f32 v34, v34
    v_mfma_f32_16x16x32_bf16 a[52:55], v[212:215], v[120:123], a[52:55]
    ds_read_b64_tr_b16 v[198:199], v230 offset:4096
    ds_read_b64_tr_b16 v[200:201], v230 offset:8192
    v_mfma_f32_16x16x32_bf16 a[52:55], v[208:211], v[116:119], a[52:55]
    v_exp_f32 v35, v35
    v_mfma_f32_16x16x32_bf16 a[84:87], v[208:211], v[128:131], a[84:87]
    ds_read_b64_tr_b16 v[202:203], v230 offset:12288
    v_cvt_pk_bf16_f32 v75, v34, v35
    v_mfma_f32_16x16x32_bf16 a[84:87], v[212:215], v[132:135], a[84:87]
    v_exp_f32 v36, v36
    v_mfma_f32_16x16x32_bf16 a[84:87], v[216:219], v[136:139], a[84:87]
    ds_read_b64_tr_b16 v[204:205], v230 offset:16384
    ds_read_b64_tr_b16 v[206:207], v230 offset:20480
    v_mfma_f32_16x16x32_bf16 a[116:119], v[216:219], v[148:151], a[116:119]
    v_exp_f32 v37, v37
    v_mfma_f32_16x16x32_bf16 a[116:119], v[212:215], v[144:147], a[116:119]
    v_cvt_pk_bf16_f32 v86, v36, v37
    v_add_u32 v230, s44, v230
    v_mfma_f32_16x16x32_bf16 a[116:119], v[208:211], v[140:143], a[116:119]
    v_exp_f32 v38, v38
    v_mfma_f32_16x16x32_bf16 a[148:151], v[208:211], v[152:155], a[148:151]
    v_mfma_f32_16x16x32_bf16 a[148:151], v[212:215], v[156:159], a[148:151]
    v_exp_f32 v39, v39
    v_mfma_f32_16x16x32_bf16 a[148:151], v[216:219], v[160:163], a[148:151]
    s_waitcnt lgkmcnt(6)
    v_cvt_pk_bf16_f32 v87, v38, v39
    v_mfma_f32_16x16x32_bf16 v[4:7], v[164:167], a[160:163], 0
    v_exp_f32 v40, v40
    v_mfma_f32_16x16x32_bf16 v[4:7], v[168:171], a[164:167], v[4:7]
    v_mfma_f32_16x16x32_bf16 v[4:7], v[172:175], a[168:171], v[4:7]
    v_exp_f32 v41, v41
    v_mfma_f32_16x16x32_bf16 v[4:7], v[176:179], a[172:175], v[4:7]
    v_cvt_pk_bf16_f32 v98, v40, v41
    v_mfma_f32_16x16x32_bf16 v[8:11], v[176:179], a[188:191], 0
    v_exp_f32 v42, v42
    v_mfma_f32_16x16x32_bf16 v[8:11], v[172:175], a[184:187], v[8:11]
    v_mfma_f32_16x16x32_bf16 v[8:11], v[168:171], a[180:183], v[8:11]
    v_exp_f32 v43, v43
    v_mfma_f32_16x16x32_bf16 v[8:11], v[164:167], a[176:179], v[8:11]
    ds_read_b128 v[180:183], v220 offset:20480
    v_cvt_pk_bf16_f32 v99, v42, v43
    v_mfma_f32_16x16x32_bf16 v[12:15], v[164:167], a[192:195], 0
    v_exp_f32 v4, v4
    v_mfma_f32_16x16x32_bf16 v[12:15], v[168:171], a[196:199], v[12:15]
    ds_read_b128 v[184:187], v221 offset:20480
    ds_read_b128 v[188:191], v222 offset:20480
    v_mfma_f32_16x16x32_bf16 v[12:15], v[172:175], a[200:203], v[12:15]
    v_exp_f32 v5, v5
    v_mfma_f32_16x16x32_bf16 v[12:15], v[176:179], a[204:207], v[12:15]
    ds_read_b128 v[192:195], v223 offset:20480
    v_cvt_pk_bf16_f32 v52, v4, v5
    v_mfma_f32_16x16x32_bf16 v[16:19], v[176:179], a[220:223], 0
    v_exp_f32 v6, v6
    v_mfma_f32_16x16x32_bf16 v[16:19], v[172:175], a[216:219], v[16:19]
    v_add_u32 v220, s43, v220
    v_add_u32 v221, s43, v221
    v_mfma_f32_16x16x32_bf16 v[16:19], v[168:171], a[212:215], v[16:19]
    v_exp_f32 v7, v7
    v_mfma_f32_16x16x32_bf16 v[16:19], v[164:167], a[208:211], v[16:19]
    v_cvt_pk_bf16_f32 v53, v6, v7
    v_add_u32 v222, s43, v222
    v_mfma_f32_16x16x32_bf16 v[20:23], v[164:167], a[224:227], 0
    v_exp_f32 v8, v8
    v_mfma_f32_16x16x32_bf16 v[20:23], v[168:171], a[228:231], v[20:23]
    v_add_u32 v223, s43, v223
    v_mfma_f32_16x16x32_bf16 v[20:23], v[172:175], a[232:235], v[20:23]
    v_exp_f32 v9, v9
    v_mfma_f32_16x16x32_bf16 v[20:23], v[176:179], a[236:239], v[20:23]
    s_waitcnt lgkmcnt(4)
    v_cvt_pk_bf16_f32 v64, v8, v9
    v_mfma_f32_16x16x32_bf16 a[24:27], v[196:199], v[104:107], a[24:27]
    v_exp_f32 v10, v10
    v_mfma_f32_16x16x32_bf16 a[24:27], v[200:203], v[108:111], a[24:27]
    ds_read_b64_tr_b16 v[208:209], v231 offset:0
    ds_read_b64_tr_b16 v[210:211], v231 offset:4096
    v_mfma_f32_16x16x32_bf16 a[24:27], v[204:207], v[112:115], a[24:27]
    v_exp_f32 v11, v11
    v_mfma_f32_16x16x32_bf16 a[56:59], v[204:207], v[124:127], a[56:59]
    ds_read_b64_tr_b16 v[212:213], v231 offset:8192
    v_cvt_pk_bf16_f32 v65, v10, v11
    v_mfma_f32_16x16x32_bf16 a[56:59], v[200:203], v[120:123], a[56:59]
    v_exp_f32 v12, v12
    v_mfma_f32_16x16x32_bf16 a[56:59], v[196:199], v[116:119], a[56:59]
    s_mov_b32 s47, s40
    ds_read_b64_tr_b16 v[214:215], v231 offset:12288
    ds_read_b64_tr_b16 v[216:217], v231 offset:16384
    v_mfma_f32_16x16x32_bf16 a[88:91], v[196:199], v[128:131], a[88:91]
    s_mov_b32 s40, s41
    v_exp_f32 v13, v13
    v_mfma_f32_16x16x32_bf16 a[88:91], v[200:203], v[132:135], a[88:91]
    s_mov_b32 s41, s42
    ds_read_b64_tr_b16 v[218:219], v231 offset:20480
    v_cvt_pk_bf16_f32 v76, v12, v13
    v_mfma_f32_16x16x32_bf16 a[88:91], v[204:207], v[136:139], a[88:91]
    s_mov_b32 s42, s47
    v_exp_f32 v14, v14
    v_mfma_f32_16x16x32_bf16 a[120:123], v[204:207], v[148:151], a[120:123]
    v_add_u32 v231, s44, v231
    v_mfma_f32_16x16x32_bf16 a[120:123], v[200:203], v[144:147], a[120:123]
    v_exp_f32 v15, v15
    v_mfma_f32_16x16x32_bf16 a[120:123], v[196:199], v[140:143], a[120:123]
    v_cvt_pk_bf16_f32 v77, v14, v15
    v_mfma_f32_16x16x32_bf16 a[152:155], v[196:199], v[152:155], a[152:155]
    v_exp_f32 v16, v16
    v_mfma_f32_16x16x32_bf16 a[152:155], v[200:203], v[156:159], a[152:155]
    v_mfma_f32_16x16x32_bf16 a[152:155], v[204:207], v[160:163], a[152:155]
    s_waitcnt lgkmcnt(6)
    v_exp_f32 v17, v17
    v_mfma_f32_16x16x32_bf16 v[24:27], v[180:183], a[160:163], 0
    v_cvt_pk_bf16_f32 v88, v16, v17
    v_mfma_f32_16x16x32_bf16 v[24:27], v[184:187], a[164:167], v[24:27]
    v_exp_f32 v18, v18
    v_mfma_f32_16x16x32_bf16 v[24:27], v[188:191], a[168:171], v[24:27]
    v_mfma_f32_16x16x32_bf16 v[24:27], v[192:195], a[172:175], v[24:27]
    v_exp_f32 v19, v19
    v_mfma_f32_16x16x32_bf16 v[28:31], v[192:195], a[188:191], 0
    v_cvt_pk_bf16_f32 v89, v18, v19
    v_mfma_f32_16x16x32_bf16 v[28:31], v[188:191], a[184:187], v[28:31]
    v_exp_f32 v20, v20
    v_mfma_f32_16x16x32_bf16 v[28:31], v[184:187], a[180:183], v[28:31]
    v_mfma_f32_16x16x32_bf16 v[28:31], v[180:183], a[176:179], v[28:31]
    v_exp_f32 v21, v21
    v_mfma_f32_16x16x32_bf16 v[32:35], v[180:183], a[192:195], 0
    v_cvt_pk_bf16_f32 v100, v20, v21
    v_mfma_f32_16x16x32_bf16 v[32:35], v[184:187], a[196:199], v[32:35]
    v_exp_f32 v22, v22
    v_mfma_f32_16x16x32_bf16 v[32:35], v[188:191], a[200:203], v[32:35]
    v_mfma_f32_16x16x32_bf16 v[32:35], v[192:195], a[204:207], v[32:35]
    v_exp_f32 v23, v23
    v_mfma_f32_16x16x32_bf16 v[36:39], v[192:195], a[220:223], 0
    v_cvt_pk_bf16_f32 v101, v22, v23
    v_mfma_f32_16x16x32_bf16 v[36:39], v[188:191], a[216:219], v[36:39]
    v_exp_f32 v24, v24
    v_mfma_f32_16x16x32_bf16 v[36:39], v[184:187], a[212:215], v[36:39]
    v_mfma_f32_16x16x32_bf16 v[36:39], v[180:183], a[208:211], v[36:39]
    v_exp_f32 v25, v25
    v_mfma_f32_16x16x32_bf16 v[40:43], v[180:183], a[224:227], 0
    v_cvt_pk_bf16_f32 v54, v24, v25
    v_mfma_f32_16x16x32_bf16 v[40:43], v[184:187], a[228:231], v[40:43]
    v_exp_f32 v26, v26
    v_mfma_f32_16x16x32_bf16 v[40:43], v[188:191], a[232:235], v[40:43]
    v_mfma_f32_16x16x32_bf16 v[40:43], v[192:195], a[236:239], v[40:43]
    s_waitcnt vmcnt(0) lgkmcnt(0)
    s_barrier
    v_exp_f32 v27, v27
    v_mfma_f32_16x16x32_bf16 a[28:31], v[208:211], v[104:107], a[28:31]
    ds_read_b128 v[164:167], v220 offset:0
    v_cvt_pk_bf16_f32 v55, v26, v27
    v_mfma_f32_16x16x32_bf16 a[28:31], v[212:215], v[108:111], a[28:31]
    v_exp_f32 v28, v28
    v_mfma_f32_16x16x32_bf16 a[28:31], v[216:219], v[112:115], a[28:31]
    ds_read_b128 v[168:171], v221 offset:0
    ds_read_b128 v[172:175], v222 offset:0
    v_mfma_f32_16x16x32_bf16 a[60:63], v[216:219], v[124:127], a[60:63]
    v_exp_f32 v29, v29
    v_mfma_f32_16x16x32_bf16 a[60:63], v[212:215], v[120:123], a[60:63]
    ds_read_b128 v[176:179], v223 offset:0
    v_cvt_pk_bf16_f32 v66, v28, v29
    v_mfma_f32_16x16x32_bf16 a[60:63], v[208:211], v[116:119], a[60:63]
    v_exp_f32 v30, v30
    v_mfma_f32_16x16x32_bf16 a[92:95], v[208:211], v[128:131], a[92:95]
    v_mfma_f32_16x16x32_bf16 a[92:95], v[212:215], v[132:135], a[92:95]
    s_add_u32 s48, s48, 1
    v_exp_f32 v31, v31
    v_mfma_f32_16x16x32_bf16 a[92:95], v[216:219], v[136:139], a[92:95]
    v_cvt_pk_bf16_f32 v67, v30, v31
    v_mfma_f32_16x16x32_bf16 a[124:127], v[216:219], v[148:151], a[124:127]
    v_exp_f32 v32, v32
    v_mfma_f32_16x16x32_bf16 a[124:127], v[212:215], v[144:147], a[124:127]
    v_mfma_f32_16x16x32_bf16 a[124:127], v[208:211], v[140:143], a[124:127]
    v_exp_f32 v33, v33
    v_mfma_f32_16x16x32_bf16 a[156:159], v[208:211], v[152:155], a[156:159]
    v_cvt_pk_bf16_f32 v78, v32, v33
    v_mfma_f32_16x16x32_bf16 a[156:159], v[212:215], v[156:159], a[156:159]
    v_exp_f32 v34, v34
    v_mfma_f32_16x16x32_bf16 a[156:159], v[216:219], v[160:163], a[156:159]
    s_waitcnt lgkmcnt(0)
    s_cbranch_scc0 L_k2_loop
    s_cmp_eq_u32 s13, 4
    s_cbranch_scc0 L_k2_between
    ds_read_b64_tr_b16 v[196:197], v224 offset:0
    ds_read_b64_tr_b16 v[198:199], v224 offset:4096
    ds_read_b64_tr_b16 v[200:201], v224 offset:8192
    ds_read_b64_tr_b16 v[202:203], v224 offset:12288
    ds_read_b64_tr_b16 v[204:205], v224 offset:16384
    ds_read_b64_tr_b16 v[206:207], v224 offset:20480
    v_exp_f32 v35, v35
    v_mfma_f32_16x16x32_bf16 v[4:7], v[164:167], a[224:227], 0
    v_cvt_pk_bf16_f32 v79, v34, v35
    v_exp_f32 v36, v36
    v_exp_f32 v37, v37
    v_mfma_f32_16x16x32_bf16 v[4:7], v[168:171], a[228:231], v[4:7]
    v_cvt_pk_bf16_f32 v90, v36, v37
    v_exp_f32 v38, v38
    v_exp_f32 v39, v39
    v_mfma_f32_16x16x32_bf16 v[4:7], v[172:175], a[232:235], v[4:7]
    v_cvt_pk_bf16_f32 v91, v38, v39
    v_exp_f32 v40, v40
    v_exp_f32 v41, v41
    v_mfma_f32_16x16x32_bf16 v[4:7], v[176:179], a[236:239], v[4:7]
    v_cvt_pk_bf16_f32 v102, v40, v41
    v_exp_f32 v42, v42
    v_exp_f32 v43, v43
    s_nop 0
    v_cvt_pk_bf16_f32 v103, v42, v43
    s_waitcnt lgkmcnt(0)
    v_mfma_f32_16x16x32_bf16 a[0:3], v[196:199], v[44:47], a[0:3]
    ds_read_b64_tr_b16 v[208:209], v225 offset:0
    ds_read_b64_tr_b16 v[210:211], v225 offset:4096
    v_mfma_f32_16x16x32_bf16 a[0:3], v[200:203], v[48:51], a[0:3]
    ds_read_b64_tr_b16 v[212:213], v225 offset:8192
    ds_read_b64_tr_b16 v[214:215], v225 offset:12288
    v_mfma_f32_16x16x32_bf16 a[0:3], v[204:207], v[52:55], a[0:3]
    ds_read_b64_tr_b16 v[216:217], v225 offset:16384
    ds_read_b64_tr_b16 v[218:219], v225 offset:20480
    v_mfma_f32_16x16x32_bf16 a[32:35], v[204:207], v[64:67], a[32:35]
    ds_read_b64_tr_b16 v[8:9], v224 offset:24576
    ds_read_b64_tr_b16 v[10:11], v225 offset:24576
    v_mfma_f32_16x16x32_bf16 a[32:35], v[200:203], v[60:63], a[32:35]
    ds_read_b64_tr_b16 v[12:13], v226 offset:24576
    ds_read_b64_tr_b16 v[14:15], v227 offset:24576
    v_mfma_f32_16x16x32_bf16 a[32:35], v[196:199], v[56:59], a[32:35]
    ds_read_b64_tr_b16 v[16:17], v228 offset:24576
    ds_read_b64_tr_b16 v[18:19], v229 offset:24576
    v_mfma_f32_16x16x32_bf16 a[64:67], v[196:199], v[68:71], a[64:67]
    ds_read_b64_tr_b16 v[20:21], v230 offset:24576
    ds_read_b64_tr_b16 v[22:23], v231 offset:24576
    s_cmp_eq_u32 s57, 1
    s_cselect_b32 s38, 0, 0x7f800000
    v_mfma_f32_16x16x32_bf16 a[64:67], v[200:203], v[72:75], a[64:67]
    v_add_f32 v3, s38, v246
    v_sub_f32 v4, v4, v3
    v_mfma_f32_16x16x32_bf16 a[64:67], v[204:207], v[76:79], a[64:67]
    v_sub_f32 v5, v5, v3
    v_sub_f32 v6, v6, v3
    v_mfma_f32_16x16x32_bf16 a[96:99], v[204:207], v[88:91], a[96:99]
    v_sub_f32 v7, v7, v3
    v_exp_f32 v4, v4
    v_mfma_f32_16x16x32_bf16 a[96:99], v[200:203], v[84:87], a[96:99]
    v_exp_f32 v5, v5
    v_exp_f32 v6, v6
    v_mfma_f32_16x16x32_bf16 a[96:99], v[196:199], v[80:83], a[96:99]
    v_exp_f32 v7, v7
    s_nop 0
    v_cvt_pk_bf16_f32 v40, v4, v5
    v_mfma_f32_16x16x32_bf16 a[128:131], v[196:199], v[92:95], a[128:131]
    v_cvt_pk_bf16_f32 v41, v6, v7
    v_add_u32 v24, 0, v1
    v_mfma_f32_16x16x32_bf16 a[128:131], v[200:203], v[96:99], a[128:131]
    v_add_u32 v25, 20480, v1
    v_add_u32 v26, 40960, v1
    v_mfma_f32_16x16x32_bf16 a[128:131], v[204:207], v[100:103], a[128:131]
    s_waitcnt lgkmcnt(8)
    v_add_u32 v27, 61440, v1
    v_mfma_f32_16x16x32_bf16 a[4:7], v[208:211], v[44:47], a[4:7]
    ds_read_b64_tr_b16 v[196:197], v226 offset:0
    ds_read_b64_tr_b16 v[198:199], v226 offset:4096
    v_mfma_f32_16x16x32_bf16 a[4:7], v[212:215], v[48:51], a[4:7]
    ds_read_b64_tr_b16 v[200:201], v226 offset:8192
    ds_read_b64_tr_b16 v[202:203], v226 offset:12288
    v_mfma_f32_16x16x32_bf16 a[4:7], v[216:219], v[52:55], a[4:7]
    s_waitcnt lgkmcnt(4)
    ds_read_b64_tr_b16 v[204:205], v226 offset:16384
    ds_read_b64_tr_b16 v[206:207], v226 offset:20480
    v_mfma_f32_16x16x16_bf16 a[132:135], v[10:11], v[40:41], a[132:135]
    buffer_load_dwordx4 a[160:163], v240, s[72:75], 0 offen offset:0 nt
    buffer_load_dwordx4 a[164:167], v240, s[72:75], 0 offen offset:64 nt
    v_mfma_f32_16x16x16_bf16 a[136:139], v[12:13], v[40:41], a[136:139]
    buffer_load_dwordx4 a[168:171], v240, s[72:75], 0 offen offset:128 nt
    buffer_load_dwordx4 a[172:175], v240, s[72:75], 0 offen offset:192 nt
    v_mfma_f32_16x16x16_bf16 a[140:143], v[14:15], v[40:41], a[140:143]
    v_lshrrev_b32 v2, 8, v240
    v_lshlrev_b32 v2, 1, v2
    v_mfma_f32_16x16x16_bf16 a[144:147], v[16:17], v[40:41], a[144:147]
    buffer_load_ushort v232, v2, s[96:99], 0 offen
    v_lshlrev_b32 v2, 7, v0
    v_mfma_f32_16x16x16_bf16 a[148:151], v[18:19], v[40:41], a[148:151]
    buffer_load_dword v42, v2, s[68:71], 0 offen sc1
    v_accvgpr_read_b32 v108, a0
    v_mfma_f32_16x16x16_bf16 a[152:155], v[20:21], v[40:41], a[152:155]
    v_accvgpr_read_b32 v109, a1
    v_accvgpr_read_b32 v110, a2
    v_mfma_f32_16x16x16_bf16 a[156:159], v[22:23], v[40:41], a[156:159]
    v_accvgpr_read_b32 v111, a3
    v_accvgpr_read_b32 v112, a4
    v_mfma_f32_16x16x16_bf16 a[128:131], v[8:9], v[40:41], a[128:131]
    v_accvgpr_read_b32 v113, a5
    v_accvgpr_read_b32 v114, a6
    v_mfma_f32_16x16x32_bf16 a[36:39], v[216:219], v[64:67], a[36:39]
    v_accvgpr_read_b32 v115, a7
    v_cvt_pk_bf16_f32 v104, v108, v109
    v_mfma_f32_16x16x32_bf16 a[36:39], v[212:215], v[60:63], a[36:39]
    v_cvt_pk_bf16_f32 v105, v110, v111
    v_cvt_pk_bf16_f32 v106, v112, v113
    v_mfma_f32_16x16x32_bf16 a[36:39], v[208:211], v[56:59], a[36:39]
    v_cvt_pk_bf16_f32 v107, v114, v115
    v_mfma_f32_16x16x32_bf16 a[68:71], v[208:211], v[68:71], a[68:71]
    buffer_store_dwordx4 v[104:107], v24, s[24:27], s52 offen
    v_mfma_f32_16x16x32_bf16 a[68:71], v[212:215], v[72:75], a[68:71]
    v_mfma_f32_16x16x32_bf16 a[68:71], v[216:219], v[76:79], a[68:71]
    v_mfma_f32_16x16x32_bf16 a[100:103], v[216:219], v[88:91], a[100:103]
    v_accvgpr_read_b32 v120, a32
    v_accvgpr_read_b32 v121, a33
    v_mfma_f32_16x16x32_bf16 a[100:103], v[212:215], v[84:87], a[100:103]
    v_accvgpr_read_b32 v122, a34
    v_accvgpr_read_b32 v123, a35
    v_mfma_f32_16x16x32_bf16 a[100:103], v[208:211], v[80:83], a[100:103]
    v_accvgpr_read_b32 v124, a36
    v_accvgpr_read_b32 v125, a37
    v_mfma_f32_16x16x32_bf16 a[132:135], v[208:211], v[92:95], a[132:135]
    v_accvgpr_read_b32 v126, a38
    v_accvgpr_read_b32 v127, a39
    v_mfma_f32_16x16x32_bf16 a[132:135], v[212:215], v[96:99], a[132:135]
    v_cvt_pk_bf16_f32 v116, v120, v121
    v_cvt_pk_bf16_f32 v117, v122, v123
    v_mfma_f32_16x16x32_bf16 a[132:135], v[216:219], v[100:103], a[132:135]
    s_waitcnt lgkmcnt(0)
    v_cvt_pk_bf16_f32 v118, v124, v125
    v_cvt_pk_bf16_f32 v119, v126, v127
    v_mfma_f32_16x16x32_bf16 a[8:11], v[196:199], v[44:47], a[8:11]
    ds_read_b64_tr_b16 v[208:209], v227 offset:0
    ds_read_b64_tr_b16 v[210:211], v227 offset:4096
    v_mfma_f32_16x16x32_bf16 a[8:11], v[200:203], v[48:51], a[8:11]
    ds_read_b64_tr_b16 v[212:213], v227 offset:8192
    ds_read_b64_tr_b16 v[214:215], v227 offset:12288
    v_mfma_f32_16x16x32_bf16 a[8:11], v[204:207], v[52:55], a[8:11]
    ds_read_b64_tr_b16 v[216:217], v227 offset:16384
    ds_read_b64_tr_b16 v[218:219], v227 offset:20480
    v_mfma_f32_16x16x32_bf16 a[40:43], v[204:207], v[64:67], a[40:43]
    buffer_store_dwordx4 v[116:119], v24, s[24:27], s53 offen
    v_accvgpr_read_b32 v108, a64
    v_mfma_f32_16x16x32_bf16 a[40:43], v[200:203], v[60:63], a[40:43]
    v_accvgpr_read_b32 v109, a65
    v_accvgpr_read_b32 v110, a66
    v_mfma_f32_16x16x32_bf16 a[40:43], v[196:199], v[56:59], a[40:43]
    v_accvgpr_read_b32 v111, a67
    v_accvgpr_read_b32 v112, a68
    v_mfma_f32_16x16x32_bf16 a[72:75], v[196:199], v[68:71], a[72:75]
    v_accvgpr_read_b32 v113, a69
    v_accvgpr_read_b32 v114, a70
    v_mfma_f32_16x16x32_bf16 a[72:75], v[200:203], v[72:75], a[72:75]
    v_accvgpr_read_b32 v115, a71
    v_cvt_pk_bf16_f32 v104, v108, v109
    v_mfma_f32_16x16x32_bf16 a[72:75], v[204:207], v[76:79], a[72:75]
    v_cvt_pk_bf16_f32 v105, v110, v111
    v_cvt_pk_bf16_f32 v106, v112, v113
    v_mfma_f32_16x16x32_bf16 a[104:107], v[204:207], v[88:91], a[104:107]
    v_cvt_pk_bf16_f32 v107, v114, v115
    v_mfma_f32_16x16x32_bf16 a[104:107], v[200:203], v[84:87], a[104:107]
    buffer_store_dwordx4 v[104:107], v24, s[24:27], s54 offen
    v_accvgpr_read_b32 v120, a96
    v_mfma_f32_16x16x32_bf16 a[104:107], v[196:199], v[80:83], a[104:107]
    v_accvgpr_read_b32 v121, a97
    v_accvgpr_read_b32 v122, a98
    v_mfma_f32_16x16x32_bf16 a[136:139], v[196:199], v[92:95], a[136:139]
    v_accvgpr_read_b32 v123, a99
    v_accvgpr_read_b32 v124, a100
    v_mfma_f32_16x16x32_bf16 a[136:139], v[200:203], v[96:99], a[136:139]
    v_accvgpr_read_b32 v125, a101
    v_accvgpr_read_b32 v126, a102
    v_mfma_f32_16x16x32_bf16 a[136:139], v[204:207], v[100:103], a[136:139]
    s_waitcnt lgkmcnt(0)
    v_accvgpr_read_b32 v127, a103
    v_cvt_pk_bf16_f32 v116, v120, v121
    v_mfma_f32_16x16x32_bf16 a[12:15], v[208:211], v[44:47], a[12:15]
    ds_read_b64_tr_b16 v[196:197], v228 offset:0
    ds_read_b64_tr_b16 v[198:199], v228 offset:4096
    v_mfma_f32_16x16x32_bf16 a[12:15], v[212:215], v[48:51], a[12:15]
    ds_read_b64_tr_b16 v[200:201], v228 offset:8192
    ds_read_b64_tr_b16 v[202:203], v228 offset:12288
    v_mfma_f32_16x16x32_bf16 a[12:15], v[216:219], v[52:55], a[12:15]
    ds_read_b64_tr_b16 v[204:205], v228 offset:16384
    ds_read_b64_tr_b16 v[206:207], v228 offset:20480
    v_mfma_f32_16x16x32_bf16 a[44:47], v[216:219], v[64:67], a[44:47]
    v_cvt_pk_bf16_f32 v117, v122, v123
    v_cvt_pk_bf16_f32 v118, v124, v125
    v_mfma_f32_16x16x32_bf16 a[44:47], v[212:215], v[60:63], a[44:47]
    v_cvt_pk_bf16_f32 v119, v126, v127
    v_mfma_f32_16x16x32_bf16 a[44:47], v[208:211], v[56:59], a[44:47]
    buffer_store_dwordx4 v[116:119], v24, s[24:27], s55 offen
    v_accvgpr_read_b32 v108, a128
    v_mfma_f32_16x16x32_bf16 a[76:79], v[208:211], v[68:71], a[76:79]
    v_accvgpr_read_b32 v109, a129
    v_accvgpr_read_b32 v110, a130
    v_mfma_f32_16x16x32_bf16 a[76:79], v[212:215], v[72:75], a[76:79]
    v_accvgpr_read_b32 v111, a131
    v_accvgpr_read_b32 v112, a132
    v_mfma_f32_16x16x32_bf16 a[76:79], v[216:219], v[76:79], a[76:79]
    v_accvgpr_read_b32 v113, a133
    v_accvgpr_read_b32 v114, a134
    v_mfma_f32_16x16x32_bf16 a[108:111], v[216:219], v[88:91], a[108:111]
    v_accvgpr_read_b32 v115, a135
    v_cvt_pk_bf16_f32 v104, v108, v109
    v_mfma_f32_16x16x32_bf16 a[108:111], v[212:215], v[84:87], a[108:111]
    v_cvt_pk_bf16_f32 v105, v110, v111
    v_cvt_pk_bf16_f32 v106, v112, v113
    v_mfma_f32_16x16x32_bf16 a[108:111], v[208:211], v[80:83], a[108:111]
    v_cvt_pk_bf16_f32 v107, v114, v115
    v_mfma_f32_16x16x32_bf16 a[140:143], v[208:211], v[92:95], a[140:143]
    buffer_store_dwordx4 v[104:107], v24, s[24:27], s56 offen
    v_accvgpr_read_b32 v120, a8
    v_mfma_f32_16x16x32_bf16 a[140:143], v[212:215], v[96:99], a[140:143]
    v_accvgpr_read_b32 v121, a9
    v_accvgpr_read_b32 v122, a10
    v_mfma_f32_16x16x32_bf16 a[140:143], v[216:219], v[100:103], a[140:143]
    s_waitcnt lgkmcnt(0)
    v_accvgpr_read_b32 v123, a11
    v_accvgpr_read_b32 v124, a12
    v_mfma_f32_16x16x32_bf16 a[16:19], v[196:199], v[44:47], a[16:19]
    ds_read_b64_tr_b16 v[208:209], v229 offset:0
    ds_read_b64_tr_b16 v[210:211], v229 offset:4096
    v_mfma_f32_16x16x32_bf16 a[16:19], v[200:203], v[48:51], a[16:19]
    ds_read_b64_tr_b16 v[212:213], v229 offset:8192
    ds_read_b64_tr_b16 v[214:215], v229 offset:12288
    v_mfma_f32_16x16x32_bf16 a[16:19], v[204:207], v[52:55], a[16:19]
    ds_read_b64_tr_b16 v[216:217], v229 offset:16384
    ds_read_b64_tr_b16 v[218:219], v229 offset:20480
    v_mfma_f32_16x16x32_bf16 a[48:51], v[204:207], v[64:67], a[48:51]
    v_accvgpr_read_b32 v125, a13
    v_accvgpr_read_b32 v126, a14
    v_mfma_f32_16x16x32_bf16 a[48:51], v[200:203], v[60:63], a[48:51]
    v_accvgpr_read_b32 v127, a15
    v_cvt_pk_bf16_f32 v116, v120, v121
    v_mfma_f32_16x16x32_bf16 a[48:51], v[196:199], v[56:59], a[48:51]
    v_cvt_pk_bf16_f32 v117, v122, v123
    v_cvt_pk_bf16_f32 v118, v124, v125
    v_mfma_f32_16x16x32_bf16 a[80:83], v[196:199], v[68:71], a[80:83]
    v_cvt_pk_bf16_f32 v119, v126, v127
    v_mfma_f32_16x16x32_bf16 a[80:83], v[200:203], v[72:75], a[80:83]
    buffer_store_dwordx4 v[116:119], v25, s[24:27], s52 offen
    v_accvgpr_read_b32 v108, a40
    v_mfma_f32_16x16x32_bf16 a[80:83], v[204:207], v[76:79], a[80:83]
    v_accvgpr_read_b32 v109, a41
    v_accvgpr_read_b32 v110, a42
    v_mfma_f32_16x16x32_bf16 a[112:115], v[204:207], v[88:91], a[112:115]
    v_accvgpr_read_b32 v111, a43
    v_accvgpr_read_b32 v112, a44
    v_mfma_f32_16x16x32_bf16 a[112:115], v[200:203], v[84:87], a[112:115]
    v_accvgpr_read_b32 v113, a45
    v_accvgpr_read_b32 v114, a46
    v_mfma_f32_16x16x32_bf16 a[112:115], v[196:199], v[80:83], a[112:115]
    v_accvgpr_read_b32 v115, a47
    v_cvt_pk_bf16_f32 v104, v108, v109
    v_mfma_f32_16x16x32_bf16 a[144:147], v[196:199], v[92:95], a[144:147]
    v_cvt_pk_bf16_f32 v105, v110, v111
    v_cvt_pk_bf16_f32 v106, v112, v113
    v_mfma_f32_16x16x32_bf16 a[144:147], v[200:203], v[96:99], a[144:147]
    v_cvt_pk_bf16_f32 v107, v114, v115
    v_mfma_f32_16x16x32_bf16 a[144:147], v[204:207], v[100:103], a[144:147]
    s_waitcnt lgkmcnt(0)
    buffer_store_dwordx4 v[104:107], v25, s[24:27], s53 offen
    v_accvgpr_read_b32 v120, a72
    v_mfma_f32_16x16x32_bf16 a[20:23], v[208:211], v[44:47], a[20:23]
    ds_read_b64_tr_b16 v[196:197], v230 offset:0
    ds_read_b64_tr_b16 v[198:199], v230 offset:4096
    v_mfma_f32_16x16x32_bf16 a[20:23], v[212:215], v[48:51], a[20:23]
    ds_read_b64_tr_b16 v[200:201], v230 offset:8192
    ds_read_b64_tr_b16 v[202:203], v230 offset:12288
    v_mfma_f32_16x16x32_bf16 a[20:23], v[216:219], v[52:55], a[20:23]
    ds_read_b64_tr_b16 v[204:205], v230 offset:16384
    ds_read_b64_tr_b16 v[206:207], v230 offset:20480
    v_mfma_f32_16x16x32_bf16 a[52:55], v[216:219], v[64:67], a[52:55]
    v_accvgpr_read_b32 v121, a73
    v_accvgpr_read_b32 v122, a74
    v_mfma_f32_16x16x32_bf16 a[52:55], v[212:215], v[60:63], a[52:55]
    v_accvgpr_read_b32 v123, a75
    v_accvgpr_read_b32 v124, a76
    v_mfma_f32_16x16x32_bf16 a[52:55], v[208:211], v[56:59], a[52:55]
    v_accvgpr_read_b32 v125, a77
    v_accvgpr_read_b32 v126, a78
    v_mfma_f32_16x16x32_bf16 a[84:87], v[208:211], v[68:71], a[84:87]
    v_accvgpr_read_b32 v127, a79
    v_cvt_pk_bf16_f32 v116, v120, v121
    v_mfma_f32_16x16x32_bf16 a[84:87], v[212:215], v[72:75], a[84:87]
    v_cvt_pk_bf16_f32 v117, v122, v123
    v_cvt_pk_bf16_f32 v118, v124, v125
    v_mfma_f32_16x16x32_bf16 a[84:87], v[216:219], v[76:79], a[84:87]
    v_cvt_pk_bf16_f32 v119, v126, v127
    v_mfma_f32_16x16x32_bf16 a[116:119], v[216:219], v[88:91], a[116:119]
    buffer_store_dwordx4 v[116:119], v25, s[24:27], s54 offen
    v_accvgpr_read_b32 v108, a104
    v_mfma_f32_16x16x32_bf16 a[116:119], v[212:215], v[84:87], a[116:119]
    v_accvgpr_read_b32 v109, a105
    v_accvgpr_read_b32 v110, a106
    v_mfma_f32_16x16x32_bf16 a[116:119], v[208:211], v[80:83], a[116:119]
    v_accvgpr_read_b32 v111, a107
    v_accvgpr_read_b32 v112, a108
    v_mfma_f32_16x16x32_bf16 a[148:151], v[208:211], v[92:95], a[148:151]
    v_accvgpr_read_b32 v113, a109
    v_accvgpr_read_b32 v114, a110
    v_mfma_f32_16x16x32_bf16 a[148:151], v[212:215], v[96:99], a[148:151]
    v_accvgpr_read_b32 v115, a111
    v_cvt_pk_bf16_f32 v104, v108, v109
    v_mfma_f32_16x16x32_bf16 a[148:151], v[216:219], v[100:103], a[148:151]
    s_waitcnt lgkmcnt(0)
    v_cvt_pk_bf16_f32 v105, v110, v111
    v_cvt_pk_bf16_f32 v106, v112, v113
    v_mfma_f32_16x16x32_bf16 a[24:27], v[196:199], v[44:47], a[24:27]
    ds_read_b64_tr_b16 v[208:209], v231 offset:0
    ds_read_b64_tr_b16 v[210:211], v231 offset:4096
    v_mfma_f32_16x16x32_bf16 a[24:27], v[200:203], v[48:51], a[24:27]
    ds_read_b64_tr_b16 v[212:213], v231 offset:8192
    ds_read_b64_tr_b16 v[214:215], v231 offset:12288
    v_mfma_f32_16x16x32_bf16 a[24:27], v[204:207], v[52:55], a[24:27]
    ds_read_b64_tr_b16 v[216:217], v231 offset:16384
    ds_read_b64_tr_b16 v[218:219], v231 offset:20480
    v_mfma_f32_16x16x32_bf16 a[56:59], v[204:207], v[64:67], a[56:59]
    v_cvt_pk_bf16_f32 v107, v114, v115
    v_mfma_f32_16x16x32_bf16 a[56:59], v[200:203], v[60:63], a[56:59]
    buffer_store_dwordx4 v[104:107], v25, s[24:27], s55 offen
    v_accvgpr_read_b32 v120, a136
    v_mfma_f32_16x16x32_bf16 a[56:59], v[196:199], v[56:59], a[56:59]
    v_accvgpr_read_b32 v121, a137
    v_accvgpr_read_b32 v122, a138
    v_mfma_f32_16x16x32_bf16 a[88:91], v[196:199], v[68:71], a[88:91]
    v_accvgpr_read_b32 v123, a139
    v_accvgpr_read_b32 v124, a140
    v_mfma_f32_16x16x32_bf16 a[88:91], v[200:203], v[72:75], a[88:91]
    v_accvgpr_read_b32 v125, a141
    v_accvgpr_read_b32 v126, a142
    v_mfma_f32_16x16x32_bf16 a[88:91], v[204:207], v[76:79], a[88:91]
    v_accvgpr_read_b32 v127, a143
    v_cvt_pk_bf16_f32 v116, v120, v121
    v_mfma_f32_16x16x32_bf16 a[120:123], v[204:207], v[88:91], a[120:123]
    v_cvt_pk_bf16_f32 v117, v122, v123
    v_cvt_pk_bf16_f32 v118, v124, v125
    v_mfma_f32_16x16x32_bf16 a[120:123], v[200:203], v[84:87], a[120:123]
    v_cvt_pk_bf16_f32 v119, v126, v127
    v_mfma_f32_16x16x32_bf16 a[120:123], v[196:199], v[80:83], a[120:123]
    buffer_store_dwordx4 v[116:119], v25, s[24:27], s56 offen
    v_accvgpr_read_b32 v108, a16
    v_mfma_f32_16x16x32_bf16 a[152:155], v[196:199], v[92:95], a[152:155]
    v_accvgpr_read_b32 v109, a17
    v_accvgpr_read_b32 v110, a18
    v_mfma_f32_16x16x32_bf16 a[152:155], v[200:203], v[96:99], a[152:155]
    v_accvgpr_read_b32 v111, a19
    v_accvgpr_read_b32 v112, a20
    v_mfma_f32_16x16x32_bf16 a[152:155], v[204:207], v[100:103], a[152:155]
    s_waitcnt lgkmcnt(0)
    v_accvgpr_read_b32 v113, a21
    v_accvgpr_read_b32 v114, a22
    v_mfma_f32_16x16x32_bf16 a[28:31], v[208:211], v[44:47], a[28:31]
    v_accvgpr_read_b32 v115, a23
    v_cvt_pk_bf16_f32 v104, v108, v109
    v_mfma_f32_16x16x32_bf16 a[28:31], v[212:215], v[48:51], a[28:31]
    v_cvt_pk_bf16_f32 v105, v110, v111
    v_cvt_pk_bf16_f32 v106, v112, v113
    v_mfma_f32_16x16x32_bf16 a[28:31], v[216:219], v[52:55], a[28:31]
    v_cvt_pk_bf16_f32 v107, v114, v115
    v_mfma_f32_16x16x32_bf16 a[60:63], v[216:219], v[64:67], a[60:63]
    buffer_store_dwordx4 v[104:107], v26, s[24:27], s52 offen
    v_accvgpr_read_b32 v120, a48
    v_mfma_f32_16x16x32_bf16 a[60:63], v[212:215], v[60:63], a[60:63]
    v_accvgpr_read_b32 v121, a49
    v_accvgpr_read_b32 v122, a50
    v_mfma_f32_16x16x32_bf16 a[60:63], v[208:211], v[56:59], a[60:63]
    v_accvgpr_read_b32 v123, a51
    v_accvgpr_read_b32 v124, a52
    v_mfma_f32_16x16x32_bf16 a[92:95], v[208:211], v[68:71], a[92:95]
    v_accvgpr_read_b32 v125, a53
    v_accvgpr_read_b32 v126, a54
    v_mfma_f32_16x16x32_bf16 a[92:95], v[212:215], v[72:75], a[92:95]
    v_accvgpr_read_b32 v127, a55
    v_cvt_pk_bf16_f32 v116, v120, v121
    v_mfma_f32_16x16x32_bf16 a[92:95], v[216:219], v[76:79], a[92:95]
    v_cvt_pk_bf16_f32 v117, v122, v123
    v_cvt_pk_bf16_f32 v118, v124, v125
    v_mfma_f32_16x16x32_bf16 a[124:127], v[216:219], v[88:91], a[124:127]
    v_cvt_pk_bf16_f32 v119, v126, v127
    v_mfma_f32_16x16x32_bf16 a[124:127], v[212:215], v[84:87], a[124:127]
    buffer_store_dwordx4 v[116:119], v26, s[24:27], s53 offen
    v_accvgpr_read_b32 v108, a80
    v_mfma_f32_16x16x32_bf16 a[124:127], v[208:211], v[80:83], a[124:127]
    v_accvgpr_read_b32 v109, a81
    v_accvgpr_read_b32 v110, a82
    v_mfma_f32_16x16x32_bf16 a[156:159], v[208:211], v[92:95], a[156:159]
    v_accvgpr_read_b32 v111, a83
    v_accvgpr_read_b32 v112, a84
    v_mfma_f32_16x16x32_bf16 a[156:159], v[212:215], v[96:99], a[156:159]
    v_accvgpr_read_b32 v113, a85
    v_accvgpr_read_b32 v114, a86
    v_mfma_f32_16x16x32_bf16 a[156:159], v[216:219], v[100:103], a[156:159]
    v_accvgpr_read_b32 v115, a87
    v_cvt_pk_bf16_f32 v104, v108, v109
    v_cvt_pk_bf16_f32 v105, v110, v111
    v_cvt_pk_bf16_f32 v106, v112, v113
    v_cvt_pk_bf16_f32 v107, v114, v115
    buffer_store_dwordx4 v[104:107], v26, s[24:27], s54 offen
    v_accvgpr_read_b32 v120, a112
    v_accvgpr_read_b32 v121, a113
    v_accvgpr_read_b32 v122, a114
    v_accvgpr_read_b32 v123, a115
    v_accvgpr_read_b32 v124, a116
    v_accvgpr_read_b32 v125, a117
    v_accvgpr_read_b32 v126, a118
    v_accvgpr_read_b32 v127, a119
    v_cvt_pk_bf16_f32 v116, v120, v121
    v_cvt_pk_bf16_f32 v117, v122, v123
    v_cvt_pk_bf16_f32 v118, v124, v125
    v_cvt_pk_bf16_f32 v119, v126, v127
    buffer_store_dwordx4 v[116:119], v26, s[24:27], s55 offen
    v_accvgpr_read_b32 v108, a144
    v_accvgpr_read_b32 v109, a145
    v_accvgpr_read_b32 v110, a146
    v_accvgpr_read_b32 v111, a147
    v_accvgpr_read_b32 v112, a148
    v_accvgpr_read_b32 v113, a149
    v_accvgpr_read_b32 v114, a150
    v_accvgpr_read_b32 v115, a151
    v_cvt_pk_bf16_f32 v104, v108, v109
    v_cvt_pk_bf16_f32 v105, v110, v111
    v_cvt_pk_bf16_f32 v106, v112, v113
    v_cvt_pk_bf16_f32 v107, v114, v115
    buffer_store_dwordx4 v[104:107], v26, s[24:27], s56 offen
    v_accvgpr_read_b32 v120, a24
    v_accvgpr_read_b32 v121, a25
    v_accvgpr_read_b32 v122, a26
    v_accvgpr_read_b32 v123, a27
    v_accvgpr_read_b32 v124, a28
    v_accvgpr_read_b32 v125, a29
    v_accvgpr_read_b32 v126, a30
    v_accvgpr_read_b32 v127, a31
    v_cvt_pk_bf16_f32 v116, v120, v121
    v_cvt_pk_bf16_f32 v117, v122, v123
    v_cvt_pk_bf16_f32 v118, v124, v125
    v_cvt_pk_bf16_f32 v119, v126, v127
    buffer_store_dwordx4 v[116:119], v27, s[24:27], s52 offen
    v_accvgpr_read_b32 v108, a56
    v_accvgpr_read_b32 v109, a57
    v_accvgpr_read_b32 v110, a58
    v_accvgpr_read_b32 v111, a59
    v_accvgpr_read_b32 v112, a60
    v_accvgpr_read_b32 v113, a61
    v_accvgpr_read_b32 v114, a62
    v_accvgpr_read_b32 v115, a63
    v_cvt_pk_bf16_f32 v104, v108, v109
    v_cvt_pk_bf16_f32 v105, v110, v111
    v_cvt_pk_bf16_f32 v106, v112, v113
    v_cvt_pk_bf16_f32 v107, v114, v115
    buffer_store_dwordx4 v[104:107], v27, s[24:27], s53 offen
    v_accvgpr_read_b32 v120, a88
    v_accvgpr_read_b32 v121, a89
    v_accvgpr_read_b32 v122, a90
    v_accvgpr_read_b32 v123, a91
    v_accvgpr_read_b32 v124, a92
    v_accvgpr_read_b32 v125, a93
    v_accvgpr_read_b32 v126, a94
    v_accvgpr_read_b32 v127, a95
    v_cvt_pk_bf16_f32 v116, v120, v121
    v_cvt_pk_bf16_f32 v117, v122, v123
    v_cvt_pk_bf16_f32 v118, v124, v125
    v_cvt_pk_bf16_f32 v119, v126, v127
    buffer_store_dwordx4 v[116:119], v27, s[24:27], s54 offen
    v_accvgpr_read_b32 v108, a120
    v_accvgpr_read_b32 v109, a121
    v_accvgpr_read_b32 v110, a122
    v_accvgpr_read_b32 v111, a123
    v_accvgpr_read_b32 v112, a124
    v_accvgpr_read_b32 v113, a125
    v_accvgpr_read_b32 v114, a126
    v_accvgpr_read_b32 v115, a127
    v_cvt_pk_bf16_f32 v104, v108, v109
    v_cvt_pk_bf16_f32 v105, v110, v111
    v_cvt_pk_bf16_f32 v106, v112, v113
    v_cvt_pk_bf16_f32 v107, v114, v115
    buffer_store_dwordx4 v[104:107], v27, s[24:27], s55 offen
    v_accvgpr_read_b32 v120, a152
    v_accvgpr_read_b32 v121, a153
    v_accvgpr_read_b32 v122, a154
    v_accvgpr_read_b32 v123, a155
    v_accvgpr_read_b32 v124, a156
    v_accvgpr_read_b32 v125, a157
    v_accvgpr_read_b32 v126, a158
    v_accvgpr_read_b32 v127, a159
    v_cvt_pk_bf16_f32 v116, v120, v121
    v_cvt_pk_bf16_f32 v117, v122, v123
    v_cvt_pk_bf16_f32 v118, v124, v125
    v_cvt_pk_bf16_f32 v119, v126, v127
    buffer_store_dwordx4 v[116:119], v27, s[24:27], s56 offen
L_k2_tail:
    s_lshl_b32 s38, s20, 4
    v_add_u32 v3, s38, v238
    v_mul_u32_u24 v2, 26, v3
    v_lshrrev_b32 v2, 8, v2
    v_mad_i32_i24 v3, v2, -10, v3
    v_lshl_add_u32 v3, v239, 4, v3
    v_lshlrev_b32 v3, 4, v3
    v_lshl_add_u32 v2, v2, 12, v3
    v_add_u32 v2, 73728, v2
    ds_read_b128 v[4:7], v2 offset:0
    ds_read_b128 v[8:11], v2 offset:1024
    ds_read_b128 v[12:15], v2 offset:2048
    ds_read_b128 v[16:19], v2 offset:3072
    v_lshrrev_b32 v2, 2, v238
    v_cmp_eq_u32 vcc, v2, v239
    v_and_b32 v3, 1, v238
    v_lshlrev_b32 v3, 4, v3
    v_mov_b32 v2, 0x3f80
    v_lshlrev_b32 v2, v3, v2
    v_cndmask_b32 v2, 0, v2, vcc
    v_and_b32 v3, 2, v238
    v_cmp_eq_u32 vcc, 0, v3
    v_mov_b32 v230, 0
    v_mov_b32 v231, 0
    v_mov_b32 v224, 0
    v_mov_b32 v225, 0
    v_cndmask_b32 v228, 0, v2, vcc
    v_cndmask_b32 v229, v2, 0, vcc
    v_cndmask_b32 v226, 0, v2, vcc
    v_cndmask_b32 v227, v2, 0, vcc
    v_add_u32 v36, 90112, v1
    s_mov_b32 s40, 0xffff0000
    ds_read_b128 v[140:143], v36 offset:32768
    ds_read_b128 v[144:147], v36 offset:33792
    ds_read_b128 v[148:151], v36 offset:34816
    ds_read_b128 v[152:155], v36 offset:35840
    ds_read_b128 v[156:159], v36 offset:36864
    ds_read_b128 v[160:163], v36 offset:37888
    ds_read_b128 v[164:167], v36 offset:38912
    ds_read_b128 v[168:171], v36 offset:39936
    v_lshrrev_b32 v2, 12, v240
    v_bfe_u32 v3, v240, 8, 4
    v_lshl_add_u32 v3, v239, 4, v3
    v_lshlrev_b32 v3, 4, v3
    v_lshl_add_u32 v2, v2, 10, v3
    v_subrev_u32 v2, s58, v2
    v_cmp_gt_u32 vcc, 0x10000000, v240
    v_mov_b32 v3, 0x10000000
    s_nop 0
    v_cndmask_b32 v236, v3, v2, vcc
    s_lshl_b32 s38, s3, 7
    v_and_b32 v2, 7, v0
    v_lshl_add_u32 v237, v2, 2, s38
    s_cmp_eq_u32 s20, 3
    s_cselect_b32 s32, 1000, s32
    s_cmp_lt_u32 s32, 1000
    s_cbranch_scc1 L_k2_owner
    s_waitcnt vmcnt(0)
    s_lshl_b32 s38, s20, 5
    s_add_u32 s38, s38, s22
    s_lshl_b32 s38, s38, 2
    v_lshl_add_u32 v3, v0, 24, s38
    s_cmp_eq_u32 s59, 1
    s_cbranch_scc1 L_k2_sign
    buffer_wbl2 sc1
    v_or_b32 v2, s34, 2
    s_waitcnt vmcnt(0)
    buffer_store_dword v2, v3, s[68:71], 0 offen sc1
    s_branch L_k2_sigen
L_k2_sign:
    v_or_b32 v2, s34, 1
    buffer_store_dword v2, v3, s[68:71], 0 offen
L_k2_sigen:
    s_endpgm
L_k2_owner:
    s_waitcnt vmcnt(20) lgkmcnt(0)
    v_mfma_f32_16x16x32_bf16 v[76:79], v[140:143], v[4:7], 0
    ds_read_b128 v[172:175], v36 offset:40960
    ds_read_b128 v[176:179], v36 offset:41984
    v_mfma_f32_16x16x32_bf16 v[76:79], v[144:147], v[8:11], v[76:79]
    ds_read_b128 v[180:183], v36 offset:43008
    ds_read_b128 v[184:187], v36 offset:44032
    v_mfma_f32_16x16x32_bf16 v[76:79], v[148:151], v[12:15], v[76:79]
    v_accvgpr_read_b32 v109, a160
    v_lshlrev_b32 v108, 16, v109
    v_mfma_f32_16x16x32_bf16 v[76:79], v[152:155], v[16:19], v[76:79]
    v_and_b32 v109, s40, v109
    v_accvgpr_read_b32 v111, a161
    v_mfma_f32_16x16x32_bf16 v[80:83], v[156:159], v[4:7], 0
    ds_read_b128 v[188:191], v36 offset:45056
    ds_read_b128 v[192:195], v36 offset:46080
    v_mfma_f32_16x16x32_bf16 v[80:83], v[160:163], v[8:11], v[80:83]
    ds_read_b128 v[196:199], v36 offset:47104
    ds_read_b128 v[200:203], v36 offset:48128
    v_mfma_f32_16x16x32_bf16 v[80:83], v[164:167], v[12:15], v[80:83]
    v_lshlrev_b32 v110, 16, v111
    v_and_b32 v111, s40, v111
    v_mfma_f32_16x16x32_bf16 v[80:83], v[168:171], v[16:19], v[80:83]
    v_accvgpr_read_b32 v113, a162
    v_lshlrev_b32 v112, 16, v113
    s_waitcnt lgkmcnt(4)
    v_mfma_f32_16x16x32_bf16 v[84:87], v[172:175], v[4:7], 0
    ds_read_b128 v[204:207], v36 offset:49152
    ds_read_b128 v[208:211], v36 offset:50176
    v_mfma_f32_16x16x32_bf16 v[84:87], v[176:179], v[8:11], v[84:87]
    ds_read_b128 v[212:215], v36 offset:51200
    ds_read_b128 v[216:219], v36 offset:52224
    v_mfma_f32_16x16x32_bf16 v[84:87], v[180:183], v[12:15], v[84:87]
    v_and_b32 v113, s40, v113
    v_accvgpr_read_b32 v115, a163
    v_mfma_f32_16x16x32_bf16 v[84:87], v[184:187], v[16:19], v[84:87]
    v_lshlrev_b32 v114, 16, v115
    v_and_b32 v115, s40, v115
    s_waitcnt lgkmcnt(4)
    v_mfma_f32_16x16x32_bf16 v[88:91], v[188:191], v[4:7], 0
    ds_read_b128 a[176:179], v36 offset:53248
    ds_read_b128 a[180:183], v36 offset:54272
    v_mfma_f32_16x16x32_bf16 v[88:91], v[192:195], v[8:11], v[88:91]
    ds_read_b128 a[184:187], v36 offset:55296
    ds_read_b128 a[188:191], v36 offset:56320
    v_mfma_f32_16x16x32_bf16 v[88:91], v[196:199], v[12:15], v[88:91]
    v_accvgpr_read_b32 v117, a164
    v_lshlrev_b32 v116, 16, v117
    v_mfma_f32_16x16x32_bf16 v[88:91], v[200:203], v[16:19], v[88:91]
    v_and_b32 v117, s40, v117
    v_accvgpr_read_b32 v119, a165
    s_waitcnt lgkmcnt(4)
    v_mfma_f32_16x16x32_bf16 v[92:95], v[204:207], v[4:7], 0
    ds_read_b128 a[192:195], v36 offset:57344
    ds_read_b128 a[196:199], v36 offset:58368
    v_mfma_f32_16x16x32_bf16 v[92:95], v[208:211], v[8:11], v[92:95]
    ds_read_b128 a[200:203], v36 offset:59392
    ds_read_b128 a[204:207], v36 offset:60416
    v_mfma_f32_16x16x32_bf16 v[92:95], v[212:215], v[12:15], v[92:95]
    v_lshlrev_b32 v118, 16, v119
    v_and_b32 v119, s40, v119
    v_mfma_f32_16x16x32_bf16 v[92:95], v[216:219], v[16:19], v[92:95]
    v_accvgpr_read_b32 v121, a166
    v_lshlrev_b32 v120, 16, v121
    s_waitcnt lgkmcnt(4)
    v_mfma_f32_16x16x32_bf16 v[96:99], a[176:179], v[4:7], 0
    ds_read_b128 a[208:211], v36 offset:61440
    ds_read_b128 a[212:215], v36 offset:62464
    v_mfma_f32_16x16x32_bf16 v[96:99], a[180:183], v[8:11], v[96:99]
    ds_read_b128 a[216:219], v36 offset:63488
    ds_read_b128 a[220:223], v36 offset:64512
    v_mfma_f32_16x16x32_bf16 v[96:99], a[184:187], v[12:15], v[96:99]
    v_and_b32 v121, s40, v121
    v_accvgpr_read_b32 v123, a167
    v_mfma_f32_16x16x32_bf16 v[96:99], a[188:191], v[16:19], v[96:99]
    v_lshlrev_b32 v122, 16, v123
    v_and_b32 v123, s40, v123
    s_waitcnt lgkmcnt(4)
    s_waitcnt vmcnt(0)
    s_lshl_b32 s38, s20, 5
    s_add_u32 s38, s38, s22
    s_lshl_b32 s38, s38, 2
    v_lshl_add_u32 v3, v0, 24, s38
    s_cmp_eq_u32 s59, 1
    s_cbranch_scc1 L_k2_sigo
    buffer_wbl2 sc1
    v_or_b32 v2, s34, 2
    s_waitcnt vmcnt(0)
    buffer_store_dword v2, v3, s[68:71], 0 offen sc1
    s_branch L_k2_sigeo
L_k2_sigo:
    v_or_b32 v2, s34, 1
    buffer_store_dword v2, v3, s[68:71], 0 offen
L_k2_sigeo:
    v_mfma_f32_16x16x32_bf16 v[100:103], a[192:195], v[4:7], 0
    v_accvgpr_read_b32 v125, a168
    v_lshlrev_b32 v124, 16, v125
    v_mfma_f32_16x16x32_bf16 v[100:103], a[196:199], v[8:11], v[100:103]
    v_and_b32 v125, s40, v125
    v_accvgpr_read_b32 v127, a169
    v_mfma_f32_16x16x32_bf16 v[100:103], a[200:203], v[12:15], v[100:103]
    v_lshlrev_b32 v126, 16, v127
    v_and_b32 v127, s40, v127
    v_mfma_f32_16x16x32_bf16 v[100:103], a[204:207], v[16:19], v[100:103]
    v_accvgpr_read_b32 v129, a170
    v_lshlrev_b32 v128, 16, v129
    s_waitcnt lgkmcnt(0)
    v_mfma_f32_16x16x32_bf16 v[104:107], a[208:211], v[4:7], 0
    v_and_b32 v129, s40, v129
    v_accvgpr_read_b32 v131, a171
    v_mfma_f32_16x16x32_bf16 v[104:107], a[212:215], v[8:11], v[104:107]
    v_lshlrev_b32 v130, 16, v131
    v_and_b32 v131, s40, v131
    v_mfma_f32_16x16x32_bf16 v[104:107], a[216:219], v[12:15], v[104:107]
    v_accvgpr_read_b32 v133, a172
    v_lshlrev_b32 v132, 16, v133
    v_mfma_f32_16x16x32_bf16 v[104:107], a[220:223], v[16:19], v[104:107]
    v_and_b32 v133, s40, v133
    v_accvgpr_read_b32 v135, a173
    v_lshlrev_b32 v134, 16, v135
    v_and_b32 v135, s40, v135
    v_accvgpr_read_b32 v137, a174
    v_lshlrev_b32 v136, 16, v137
    v_and_b32 v137, s40, v137
    v_accvgpr_read_b32 v139, a175
    v_lshlrev_b32 v138, 16, v139
    v_and_b32 v139, s40, v139
    v_lshlrev_b32 v38, 16, v232
    v_mul_f32 v38, 0x6f000000, v38
    buffer_load_dword v39, v237, s[68:71], 0 offen sc1
    v_fmac_f32 v108, v76, v38
    v_fmac_f32 v109, v77, v38
    v_fmac_f32 v110, v78, v38
    v_fmac_f32 v111, v79, v38
    v_fmac_f32 v112, v80, v38
    v_fmac_f32 v113, v81, v38
    v_fmac_f32 v114, v82, v38
    v_fmac_f32 v115, v83, v38
    v_fmac_f32 v116, v84, v38
    v_fmac_f32 v117, v85, v38
    v_fmac_f32 v118, v86, v38
    v_fmac_f32 v119, v87, v38
    v_fmac_f32 v120, v88, v38
    v_fmac_f32 v121, v89, v38
    v_fmac_f32 v122, v90, v38
    v_fmac_f32 v123, v91, v38
    v_fmac_f32 v124, v92, v38
    v_fmac_f32 v125, v93, v38
    v_fmac_f32 v126, v94, v38
    v_fmac_f32 v127, v95, v38
    v_fmac_f32 v128, v96, v38
    v_fmac_f32 v129, v97, v38
    v_fmac_f32 v130, v98, v38
    v_fmac_f32 v131, v99, v38
    v_fmac_f32 v132, v100, v38
    v_fmac_f32 v133, v101, v38
    v_fmac_f32 v134, v102, v38
    v_fmac_f32 v135, v103, v38
    v_fmac_f32 v136, v104, v38
    v_fmac_f32 v137, v105, v38
    v_fmac_f32 v138, v106, v38
    v_fmac_f32 v139, v107, v38
    s_mul_i32 s38, s22, 81920
    s_sub_u32 s24, s24, s38
    s_subb_u32 s25, s25, 0
    s_mov_b32 s26, 655360
    s_mov_b32 s42, 0
L_k2_poll:
    s_waitcnt vmcnt(0)
    v_xor_b32 v39, s34, v39
    v_cmp_lt_u32 vcc, 7, v39
    s_cmp_eq_u32 vcc_lo, 0
    s_cbranch_scc1 L_k2_ready
    buffer_load_dword v39, v237, s[68:71], 0 offen sc1
    s_add_u32 s42, s42, 1
    s_cmp_lt_u32 s42, 0x100000
    s_cbranch_scc1 L_k2_poll
L_k2_ready:
    v_cmp_eq_u32 vcc, 2, v39
    s_cmp_eq_u32 vcc_lo, 0
    s_cbranch_scc1 L_k2_near
    buffer_inv sc1
    s_waitcnt vmcnt(0)
L_k2_near:
    s_mov_b32 s38, 61440
    buffer_load_dwordx4 a[96:99], v236, s[24:27], s38 offen sc1
    s_add_u32 s38, s38, 0x14000
    buffer_load_dwordx4 a[100:103], v236, s[24:27], s38 offen sc1
    s_add_u32 s38, s38, 0x14000
    buffer_load_dwordx4 a[104:107], v236, s[24:27], s38 offen sc1
    s_add_u32 s38, s38, 0x14000
    buffer_load_dwordx4 a[108:111], v236, s[24:27], s38 offen sc1
    s_add_u32 s38, s38, 0x14000
    buffer_load_dwordx4 a[112:115], v236, s[24:27], s38 offen sc1
    s_add_u32 s38, s38, 0x14000
    buffer_load_dwordx4 a[116:119], v236, s[24:27], s38 offen sc1
    s_add_u32 s38, s38, 0x14000
    buffer_load_dwordx4 a[120:123], v236, s[24:27], s38 offen sc1
    s_add_u32 s38, s38, 0x14000
    buffer_load_dwordx4 a[124:127], v236, s[24:27], s38 offen sc1
    s_mov_b32 s38, 0
    buffer_load_dwordx4 a[0:3], v236, s[24:27], s38 offen sc1
    s_add_u32 s38, s38, 0x14000
    buffer_load_dwordx4 a[4:7], v236, s[24:27], s38 offen sc1
    s_add_u32 s38, s38, 0x14000
    buffer_load_dwordx4 a[8:11], v236, s[24:27], s38 offen sc1
    s_add_u32 s38, s38, 0x14000
    buffer_load_dwordx4 a[12:15], v236, s[24:27], s38 offen sc1
    s_waitcnt vmcnt(10)
    v_mfma_f32_16x16x32_bf16 v[68:71], v[228:231], a[96:99], 0
    s_add_u32 s38, s38, 0x14000
    buffer_load_dwordx4 a[16:19], v236, s[24:27], s38 offen sc1
    v_mfma_f32_16x16x32_bf16 v[72:75], v[224:227], a[96:99], 0
    ds_read_b128 a[224:227], v36 offset:0
    ds_read_b128 a[228:231], v36 offset:1024
    v_mfma_f32_16x16x32_bf16 v[68:71], v[228:231], a[100:103], v[68:71]
    s_add_u32 s38, s38, 0x14000
    buffer_load_dwordx4 a[20:23], v236, s[24:27], s38 offen sc1
    v_mfma_f32_16x16x32_bf16 v[72:75], v[224:227], a[100:103], v[72:75]
    ds_read_b128 a[232:235], v36 offset:2048
    ds_read_b128 a[236:239], v36 offset:3072
    s_waitcnt vmcnt(10)
    v_mfma_f32_16x16x32_bf16 v[68:71], v[228:231], a[104:107], v[68:71]
    s_add_u32 s38, s38, 0x14000
    buffer_load_dwordx4 a[24:27], v236, s[24:27], s38 offen sc1
    v_mfma_f32_16x16x32_bf16 v[72:75], v[224:227], a[104:107], v[72:75]
    ds_read_b128 a[240:243], v36 offset:4096
    ds_read_b128 a[244:247], v36 offset:5120
    v_mfma_f32_16x16x32_bf16 v[68:71], v[228:231], a[108:111], v[68:71]
    s_add_u32 s38, s38, 0x14000
    buffer_load_dwordx4 a[28:31], v236, s[24:27], s38 offen sc1
    v_mfma_f32_16x16x32_bf16 v[72:75], v[224:227], a[108:111], v[72:75]
    ds_read_b128 a[248:251], v36 offset:6144
    ds_read_b128 a[252:255], v36 offset:7168
    s_waitcnt vmcnt(10)
    v_mfma_f32_16x16x32_bf16 v[68:71], v[228:231], a[112:115], v[68:71]
    s_mov_b32 s38, 20480
    buffer_load_dwordx4 a[32:35], v236, s[24:27], s38 offen sc1
    v_mfma_f32_16x16x32_bf16 v[72:75], v[224:227], a[112:115], v[72:75]
    ds_read_b128 v[140:143], v36 offset:8192
    ds_read_b128 v[144:147], v36 offset:9216
    v_mfma_f32_16x16x32_bf16 v[68:71], v[228:231], a[116:119], v[68:71]
    s_add_u32 s38, s38, 0x14000
    buffer_load_dwordx4 a[36:39], v236, s[24:27], s38 offen sc1
    v_mfma_f32_16x16x32_bf16 v[72:75], v[224:227], a[116:119], v[72:75]
    ds_read_b128 v[148:151], v36 offset:10240
    ds_read_b128 v[152:155], v36 offset:11264
    s_waitcnt vmcnt(10)
    v_mfma_f32_16x16x32_bf16 v[68:71], v[228:231], a[120:123], v[68:71]
    s_add_u32 s38, s38, 0x14000
    buffer_load_dwordx4 a[40:43], v236, s[24:27], s38 offen sc1
    v_mfma_f32_16x16x32_bf16 v[72:75], v[224:227], a[120:123], v[72:75]
    v_mfma_f32_16x16x32_bf16 v[68:71], v[228:231], a[124:127], v[68:71]
    s_add_u32 s38, s38, 0x14000
    buffer_load_dwordx4 a[44:47], v236, s[24:27], s38 offen sc1
    v_mfma_f32_16x16x32_bf16 v[72:75], v[224:227], a[124:127], v[72:75]
    s_waitcnt vmcnt(10)
    v_mfma_f32_16x16x32_bf16 v[44:47], v[228:231], a[0:3], 0
    s_add_u32 s38, s38, 0x14000
    buffer_load_dwordx4 a[48:51], v236, s[24:27], s38 offen sc1
    v_mfma_f32_16x16x32_bf16 v[48:51], v[224:227], a[0:3], 0
    v_mfma_f32_16x16x32_bf16 v[44:47], v[228:231], a[4:7], v[44:47]
    s_add_u32 s38, s38, 0x14000
    buffer_load_dwordx4 a[52:55], v236, s[24:27], s38 offen sc1
    v_mfma_f32_16x16x32_bf16 v[48:51], v[224:227], a[4:7], v[48:51]
    v_mov_b32 v3, v75
    v_mov_b32 v2, v75
    s_waitcnt vmcnt(10)
    v_mfma_f32_16x16x32_bf16 v[44:47], v[228:231], a[8:11], v[44:47]
    s_add_u32 s38, s38, 0x14000
    buffer_load_dwordx4 a[56:59], v236, s[24:27], s38 offen sc1
    v_mfma_f32_16x16x32_bf16 v[48:51], v[224:227], a[8:11], v[48:51]
    v_permlane32_swap_b32 v3, v2
    v_mov_b32 v3, v2
    v_mfma_f32_16x16x32_bf16 v[44:47], v[228:231], a[12:15], v[44:47]
    s_add_u32 s38, s38, 0x14000
    buffer_load_dwordx4 a[60:63], v236, s[24:27], s38 offen sc1
    v_mfma_f32_16x16x32_bf16 v[48:51], v[224:227], a[12:15], v[48:51]
    v_permlane16_swap_b32 v3, v2
    s_waitcnt vmcnt(10)
    v_mfma_f32_16x16x32_bf16 v[44:47], v[228:231], a[16:19], v[44:47]
    s_mov_b32 s38, 40960
    buffer_load_dwordx4 a[64:67], v236, s[24:27], s38 offen sc1
    v_mfma_f32_16x16x32_bf16 v[48:51], v[224:227], a[16:19], v[48:51]
    v_rcp_f32 v2, v2
    v_mfma_f32_16x16x32_bf16 v[44:47], v[228:231], a[20:23], v[44:47]
    s_add_u32 s38, s38, 0x14000
    buffer_load_dwordx4 a[68:71], v236, s[24:27], s38 offen sc1
    v_mfma_f32_16x16x32_bf16 v[48:51], v[224:227], a[20:23], v[48:51]
    v_mul_f32 v68, v68, v2
    v_mul_f32 v69, v69, v2
    s_waitcnt vmcnt(10)
    v_mfma_f32_16x16x32_bf16 v[44:47], v[228:231], a[24:27], v[44:47]
    s_add_u32 s38, s38, 0x14000
    buffer_load_dwordx4 a[72:75], v236, s[24:27], s38 offen sc1
    v_mfma_f32_16x16x32_bf16 v[48:51], v[224:227], a[24:27], v[48:51]
    v_cvt_pk_bf16_f32 v32, v68, v69
    v_mul_f32 v70, v70, v2
    v_mfma_f32_16x16x32_bf16 v[44:47], v[228:231], a[28:31], v[44:47]
    s_add_u32 s38, s38, 0x14000
    buffer_load_dwordx4 a[76:79], v236, s[24:27], s38 offen sc1
    v_mfma_f32_16x16x32_bf16 v[48:51], v[224:227], a[28:31], v[48:51]
    v_mul_f32 v71, v71, v2
    v_cvt_pk_bf16_f32 v33, v70, v71
    s_waitcnt vmcnt(10)
    v_mfma_f32_16x16x32_bf16 v[52:55], v[228:231], a[32:35], 0
    s_add_u32 s38, s38, 0x14000
    buffer_load_dwordx4 a[80:83], v236, s[24:27], s38 offen sc1
    v_mfma_f32_16x16x32_bf16 v[56:59], v[224:227], a[32:35], 0
    v_mul_f32 v72, v72, v2
    v_mul_f32 v73, v73, v2
    v_mfma_f32_16x16x32_bf16 v[52:55], v[228:231], a[36:39], v[52:55]
    s_add_u32 s38, s38, 0x14000
    buffer_load_dwordx4 a[84:87], v236, s[24:27], s38 offen sc1
    v_mfma_f32_16x16x32_bf16 v[56:59], v[224:227], a[36:39], v[56:59]
    v_cvt_pk_bf16_f32 v34, v72, v73
    v_mul_f32 v74, v74, v2
    s_waitcnt vmcnt(10)
    v_mfma_f32_16x16x32_bf16 v[52:55], v[228:231], a[40:43], v[52:55]
    s_add_u32 s38, s38, 0x14000
    buffer_load_dwordx4 a[88:91], v236, s[24:27], s38 offen sc1
    v_mfma_f32_16x16x32_bf16 v[56:59], v[224:227], a[40:43], v[56:59]
    v_mul_f32 v75, v75, v2
    v_cvt_pk_bf16_f32 v35, v74, v75
    v_mfma_f32_16x16x32_bf16 v[52:55], v[228:231], a[44:47], v[52:55]
    s_add_u32 s38, s38, 0x14000
    buffer_load_dwordx4 a[92:95], v236, s[24:27], s38 offen sc1
    v_mfma_f32_16x16x32_bf16 v[56:59], v[224:227], a[44:47], v[56:59]
    v_mul_f32 v44, v44, v2
    v_mul_f32 v45, v45, v2
    s_waitcnt vmcnt(10)
    v_mfma_f32_16x16x32_bf16 v[52:55], v[228:231], a[48:51], v[52:55]
    ds_read_b128 v[156:159], v36 offset:12288
    ds_read_b128 v[160:163], v36 offset:13312
    v_mfma_f32_16x16x32_bf16 v[56:59], v[224:227], a[48:51], v[56:59]
    ds_read_b128 v[164:167], v36 offset:14336
    ds_read_b128 v[168:171], v36 offset:15360
    v_mfma_f32_16x16x32_bf16 v[52:55], v[228:231], a[52:55], v[52:55]
    v_cvt_pk_bf16_f32 v20, v44, v45
    v_mul_f32 v46, v46, v2
    v_mfma_f32_16x16x32_bf16 v[56:59], v[224:227], a[52:55], v[56:59]
    v_mul_f32 v47, v47, v2
    v_cvt_pk_bf16_f32 v21, v46, v47
    s_waitcnt vmcnt(8)
    v_mfma_f32_16x16x32_bf16 v[52:55], v[228:231], a[56:59], v[52:55]
    ds_read_b128 v[172:175], v36 offset:16384
    ds_read_b128 v[176:179], v36 offset:17408
    v_mfma_f32_16x16x32_bf16 v[56:59], v[224:227], a[56:59], v[56:59]
    ds_read_b128 v[180:183], v36 offset:18432
    ds_read_b128 v[184:187], v36 offset:19456
    v_mfma_f32_16x16x32_bf16 v[52:55], v[228:231], a[60:63], v[52:55]
    v_mul_f32 v48, v48, v2
    v_mul_f32 v49, v49, v2
    v_mfma_f32_16x16x32_bf16 v[56:59], v[224:227], a[60:63], v[56:59]
    v_cvt_pk_bf16_f32 v22, v48, v49
    v_mul_f32 v50, v50, v2
    s_waitcnt vmcnt(6)
    v_mfma_f32_16x16x32_bf16 v[60:63], v[228:231], a[64:67], 0
    ds_read_b128 v[188:191], v36 offset:20480
    ds_read_b128 v[192:195], v36 offset:21504
    v_mfma_f32_16x16x32_bf16 v[64:67], v[224:227], a[64:67], 0
    ds_read_b128 v[196:199], v36 offset:22528
    ds_read_b128 v[200:203], v36 offset:23552
    v_mfma_f32_16x16x32_bf16 v[60:63], v[228:231], a[68:71], v[60:63]
    v_mul_f32 v51, v51, v2
    v_cvt_pk_bf16_f32 v23, v50, v51
    v_mfma_f32_16x16x32_bf16 v[64:67], v[224:227], a[68:71], v[64:67]
    v_mul_f32 v52, v52, v2
    v_mul_f32 v53, v53, v2
    s_waitcnt vmcnt(4)
    v_mfma_f32_16x16x32_bf16 v[60:63], v[228:231], a[72:75], v[60:63]
    ds_read_b128 v[204:207], v36 offset:24576
    ds_read_b128 v[208:211], v36 offset:25600
    v_mfma_f32_16x16x32_bf16 v[64:67], v[224:227], a[72:75], v[64:67]
    ds_read_b128 v[212:215], v36 offset:26624
    ds_read_b128 v[216:219], v36 offset:27648
    v_mfma_f32_16x16x32_bf16 v[60:63], v[228:231], a[76:79], v[60:63]
    v_cvt_pk_bf16_f32 v24, v52, v53
    v_mul_f32 v54, v54, v2
    v_mfma_f32_16x16x32_bf16 v[64:67], v[224:227], a[76:79], v[64:67]
    v_mul_f32 v55, v55, v2
    v_cvt_pk_bf16_f32 v25, v54, v55
    s_waitcnt vmcnt(2)
    v_mfma_f32_16x16x32_bf16 v[60:63], v[228:231], a[80:83], v[60:63]
    ds_read_b128 a[176:179], v36 offset:28672
    ds_read_b128 a[180:183], v36 offset:29696
    v_mfma_f32_16x16x32_bf16 v[64:67], v[224:227], a[80:83], v[64:67]
    ds_read_b128 a[184:187], v36 offset:30720
    ds_read_b128 a[188:191], v36 offset:31744
    v_mfma_f32_16x16x32_bf16 v[60:63], v[228:231], a[84:87], v[60:63]
    v_mul_f32 v56, v56, v2
    v_mul_f32 v57, v57, v2
    v_mfma_f32_16x16x32_bf16 v[64:67], v[224:227], a[84:87], v[64:67]
    v_cvt_pk_bf16_f32 v26, v56, v57
    v_mul_f32 v58, v58, v2
    s_waitcnt vmcnt(0)
    v_mfma_f32_16x16x32_bf16 v[60:63], v[228:231], a[88:91], v[60:63]
    v_mul_f32 v59, v59, v2
    v_cvt_pk_bf16_f32 v27, v58, v59
    v_mfma_f32_16x16x32_bf16 v[64:67], v[224:227], a[88:91], v[64:67]
    v_mfma_f32_16x16x32_bf16 v[60:63], v[228:231], a[92:95], v[60:63]
    v_mfma_f32_16x16x32_bf16 v[64:67], v[224:227], a[92:95], v[64:67]
    s_waitcnt lgkmcnt(15)
    v_mfma_f32_16x16x32_bf16 v[108:111], a[236:239], v[32:35], v[108:111]
    v_mfma_f32_16x16x32_bf16 v[108:111], a[224:227], v[20:23], v[108:111]
    v_mfma_f32_16x16x32_bf16 v[108:111], a[228:231], v[24:27], v[108:111]
    s_nop 2
    v_mul_f32 v60, v60, v2
    v_mul_f32 v61, v61, v2
    v_cvt_pk_bf16_f32 v28, v60, v61
    v_mul_f32 v62, v62, v2
    v_mul_f32 v63, v63, v2
    v_cvt_pk_bf16_f32 v29, v62, v63
    v_mul_f32 v64, v64, v2
    v_mul_f32 v65, v65, v2
    v_cvt_pk_bf16_f32 v30, v64, v65
    v_mul_f32 v66, v66, v2
    v_mul_f32 v67, v67, v2
    v_cvt_pk_bf16_f32 v31, v66, v67
    s_nop 1
    v_mfma_f32_16x16x32_bf16 v[108:111], a[232:235], v[28:31], v[108:111]
    v_mfma_f32_16x16x32_bf16 v[112:115], a[252:255], v[32:35], v[112:115]
    v_mfma_f32_16x16x32_bf16 v[112:115], a[240:243], v[20:23], v[112:115]
    v_mfma_f32_16x16x32_bf16 v[112:115], a[244:247], v[24:27], v[112:115]
    v_mfma_f32_16x16x32_bf16 v[112:115], a[248:251], v[28:31], v[112:115]
    v_mfma_f32_16x16x32_bf16 v[116:119], v[152:155], v[32:35], v[116:119]
    v_mfma_f32_16x16x32_bf16 v[116:119], v[140:143], v[20:23], v[116:119]
    v_mfma_f32_16x16x32_bf16 v[116:119], v[144:147], v[24:27], v[116:119]
    v_mfma_f32_16x16x32_bf16 v[116:119], v[148:151], v[28:31], v[116:119]
    v_cvt_pk_bf16_f32 v4, v108, v109
    v_cvt_pk_bf16_f32 v5, v110, v111
    v_mfma_f32_16x16x32_bf16 v[120:123], v[168:171], v[32:35], v[120:123]
    s_nop 0
    v_cvt_pk_bf16_f32 v6, v112, v113
    v_cvt_pk_bf16_f32 v7, v114, v115
    v_mfma_f32_16x16x32_bf16 v[120:123], v[156:159], v[20:23], v[120:123]
    buffer_store_dwordx4 v[4:7], v240, s[76:79], 0 offen offset:0 nt
    v_mfma_f32_16x16x32_bf16 v[120:123], v[160:163], v[24:27], v[120:123]
    v_mfma_f32_16x16x32_bf16 v[120:123], v[164:167], v[28:31], v[120:123]
    s_waitcnt lgkmcnt(12)
    v_mfma_f32_16x16x32_bf16 v[124:127], v[184:187], v[32:35], v[124:127]
    v_mfma_f32_16x16x32_bf16 v[124:127], v[172:175], v[20:23], v[124:127]
    v_mfma_f32_16x16x32_bf16 v[124:127], v[176:179], v[24:27], v[124:127]
    v_mfma_f32_16x16x32_bf16 v[124:127], v[180:183], v[28:31], v[124:127]
    v_cvt_pk_bf16_f32 v8, v116, v117
    v_cvt_pk_bf16_f32 v9, v118, v119
    s_waitcnt lgkmcnt(8)
    v_mfma_f32_16x16x32_bf16 v[128:131], v[200:203], v[32:35], v[128:131]
    v_cvt_pk_bf16_f32 v10, v120, v121
    v_cvt_pk_bf16_f32 v11, v122, v123
    v_mfma_f32_16x16x32_bf16 v[128:131], v[188:191], v[20:23], v[128:131]
    buffer_store_dwordx4 v[8:11], v240, s[76:79], 0 offen offset:64 nt
    v_mfma_f32_16x16x32_bf16 v[128:131], v[192:195], v[24:27], v[128:131]
    v_mfma_f32_16x16x32_bf16 v[128:131], v[196:199], v[28:31], v[128:131]
    s_waitcnt lgkmcnt(4)
    v_mfma_f32_16x16x32_bf16 v[132:135], v[216:219], v[32:35], v[132:135]
    v_mfma_f32_16x16x32_bf16 v[132:135], v[204:207], v[20:23], v[132:135]
    v_mfma_f32_16x16x32_bf16 v[132:135], v[208:211], v[24:27], v[132:135]
    v_mfma_f32_16x16x32_bf16 v[132:135], v[212:215], v[28:31], v[132:135]
    v_cvt_pk_bf16_f32 v12, v124, v125
    v_cvt_pk_bf16_f32 v13, v126, v127
    s_waitcnt lgkmcnt(0)
    v_mfma_f32_16x16x32_bf16 v[136:139], a[188:191], v[32:35], v[136:139]
    v_cvt_pk_bf16_f32 v14, v128, v129
    v_cvt_pk_bf16_f32 v15, v130, v131
    v_mfma_f32_16x16x32_bf16 v[136:139], a[176:179], v[20:23], v[136:139]
    buffer_store_dwordx4 v[12:15], v240, s[76:79], 0 offen offset:128 nt
    v_mfma_f32_16x16x32_bf16 v[136:139], a[180:183], v[24:27], v[136:139]
    v_mfma_f32_16x16x32_bf16 v[136:139], a[184:187], v[28:31], v[136:139]
    v_cvt_pk_bf16_f32 v16, v132, v133
    v_cvt_pk_bf16_f32 v17, v134, v135
    s_nop 5
    v_cvt_pk_bf16_f32 v18, v136, v137
    v_cvt_pk_bf16_f32 v19, v138, v139
    buffer_store_dwordx4 v[16:19], v240, s[76:79], 0 offen offset:192 nt
    s_endpgm
L_k2_between:
    s_cmp_eq_u32 s13, 3
    s_cbranch_scc1 L_k2_local
    s_cmp_eq_u32 s13, 0
    s_cbranch_scc0 L_k2_between2
    v_xor_b32 v248, s34, v248
    v_xor_b32 v249, s34, v249
    v_xor_b32 v250, s34, v250
    v_xor_b32 v251, s34, v251
    v_or_b32 v248, v248, v249
    v_or3_b32 v248, v248, v250, v251
    v_cmp_lt_u32 vcc, 7, v248
    s_cmp_lg_u64 vcc, 0
    s_cbranch_scc1 L_km_rdyh
L_km_rdyeh:
    s_add_u32 s96, s4, 0x520000
    s_addc_u32 s97, s5, 0
    s_mov_b32 s98, 0x40000
    s_mov_b32 s99, 0x20000
    s_lshl_b32 s38, s32, 2
    v_lshlrev_b32 v233, 12, v0
    buffer_load_dword v247, v233, s[96:99], s38 offen
    s_lshr_b32 s36, s2, 3
    s_lshl_b32 s36, s36, 2
    s_add_u32 s36, s36, s20
    s_mul_i32 s36, s36, 20096
    s_add_u32 s60, s4, s36
    s_addc_u32 s61, s5, 0
    s_mov_b32 s62, 20096
    s_mov_b32 s12, 0
    s_sub_u32 s51, s50, 14336
    s_mov_b32 s13, 5
    s_mov_b32 s48, -1
    s_branch L_k2_loop
L_k2_between2:
    v_mul_u32_u24 v233, 2500, v0
    v_and_b32 v2, 0xffff, v247
    v_lshrrev_b32 v247, 16, v247
    v_add_lshl_u32 v233, v233, v2, 2
    buffer_load_dwordx4 a[240:243], v233, s[64:67], 0 offen offset:0
    buffer_load_dwordx4 a[244:247], v233, s[64:67], 0 offen offset:16
    buffer_load_dwordx4 a[248:251], v233, s[64:67], 0 offen offset:32
    buffer_load_dwordx4 a[252:255], v233, s[64:67], 0 offen offset:48
    s_mov_b32 s13, 3
    s_sub_u32 s48, -4, s14
    s_branch L_k2_loop
L_k2_local:
    v_min_u32 v236, 14, v247
    v_mov_b32 v237, v236
    s_nop 1
    v_add_u32_dpp v237, v237, v237 row_shr:1 row_mask:0xf bank_mask:0xf
    s_nop 1
    v_add_u32_dpp v237, v237, v237 row_shr:2 row_mask:0xf bank_mask:0xf
    s_nop 1
    v_add_u32_dpp v237, v237, v237 row_shr:4 row_mask:0xf bank_mask:0xf
    s_nop 1
    v_add_u32_dpp v237, v237, v237 row_shr:8 row_mask:0xf bank_mask:0xf
    s_nop 1
    v_add_u32_dpp v237, v237, v237 row_bcast:15 row_mask:0xa bank_mask:0xf
    s_nop 1
    v_add_u32_dpp v237, v237, v237 row_bcast:31 row_mask:0xc bank_mask:0xf
    s_nop 0
    v_readlane_b32 s39, v237, 63
    v_sub_u32 v237, v237, v236
    v_lshl_add_u32 v237, v237, 2, s37
    v_sub_u32 v247, v247, v236
    v_add_u32 v233, 56, v233
    v_add_u32 v2, s39, v0
    v_lshl_add_u32 v2, v2, 2, s37
    v_mov_b32 v3, 0xfffff0
    ds_write_b32 v2, v3
    ds_write_b32 v2, v3 offset:256
    s_add_u32 s39, s39, 31
    s_lshr_b32 s39, s39, 5
    v_and_b32 v234, 48, v0
    v_lshl_add_u32 v234, v234, 1, s37
    s_waitcnt vmcnt(0)
    v_cmp_lt_u32 vcc, 0, v236
    s_mov_b64 exec, vcc
    s_cbranch_execz L_k2_listeda
    ds_write_b32 v237, a240 offset:0
    v_cmp_lt_u32 vcc, 1, v236
    s_mov_b64 exec, vcc
    ds_write_b32 v237, a241 offset:4
    v_cmp_lt_u32 vcc, 2, v236
    s_mov_b64 exec, vcc
    ds_write_b32 v237, a242 offset:8
    v_cmp_lt_u32 vcc, 3, v236
    s_mov_b64 exec, vcc
    ds_write_b32 v237, a243 offset:12
    v_cmp_lt_u32 vcc, 4, v236
    s_mov_b64 exec, vcc
    s_cbranch_execz L_k2_listeda
    ds_write_b32 v237, a244 offset:16
    v_cmp_lt_u32 vcc, 5, v236
    s_mov_b64 exec, vcc
    ds_write_b32 v237, a245 offset:20
    v_cmp_lt_u32 vcc, 6, v236
    s_mov_b64 exec, vcc
    ds_write_b32 v237, a246 offset:24
    v_cmp_lt_u32 vcc, 7, v236
    s_mov_b64 exec, vcc
    ds_write_b32 v237, a247 offset:28
    v_cmp_lt_u32 vcc, 8, v236
    s_mov_b64 exec, vcc
    s_cbranch_execz L_k2_listeda
    ds_write_b32 v237, a248 offset:32
    v_cmp_lt_u32 vcc, 9, v236
    s_mov_b64 exec, vcc
    ds_write_b32 v237, a249 offset:36
    v_cmp_lt_u32 vcc, 10, v236
    s_mov_b64 exec, vcc
    ds_write_b32 v237, a250 offset:40
    v_cmp_lt_u32 vcc, 11, v236
    s_mov_b64 exec, vcc
    ds_write_b32 v237, a251 offset:44
    v_cmp_lt_u32 vcc, 12, v236
    s_mov_b64 exec, vcc
    s_cbranch_execz L_k2_listeda
    ds_write_b32 v237, a252 offset:48
    v_cmp_lt_u32 vcc, 13, v236
    s_mov_b64 exec, vcc
    ds_write_b32 v237, a253 offset:52
L_k2_listeda:
    s_mov_b64 exec, -1
    ds_read_b128 v[248:251], v234
    ds_read_b128 v[252:255], v234 offset:16
    v_add_u32 v234, 128, v234
    ds_read_b128 v[16:19], v234
    ds_read_b128 v[20:23], v234 offset:16
    v_add_u32 v234, 128, v234
    v_lshlrev_b32 v236, 4, v238
    v_lshlrev_b32 v237, 12, v238
    v_lshl_or_b32 v237, v238, 28, v237
    s_waitcnt lgkmcnt(2)
    v_bitop3_b32 v2, v248, s16, v236 bitop3:0x6a
    buffer_load_dwordx4 v[104:107], v2, s[8:11], 0 offen
    v_bitop3_b32 v3, v249, s16, v236 bitop3:0x6a
    buffer_load_dwordx4 v[108:111], v3, s[8:11], 0 offen
    v_bitop3_b32 v2, v250, s16, v236 bitop3:0x6a
    buffer_load_dwordx4 v[112:115], v2, s[8:11], 0 offen
    v_bitop3_b32 v3, v251, s16, v236 bitop3:0x6a
    buffer_load_dwordx4 v[116:119], v3, s[8:11], 0 offen
    v_bitop3_b32 v2, v252, s16, v236 bitop3:0x6a
    buffer_load_dwordx4 v[120:123], v2, s[8:11], 0 offen
    v_bitop3_b32 v3, v253, s16, v236 bitop3:0x6a
    buffer_load_dwordx4 v[124:127], v3, s[8:11], 0 offen
    v_bitop3_b32 v2, v254, s16, v236 bitop3:0x6a
    buffer_load_dwordx4 v[128:131], v2, s[8:11], 0 offen
    v_bitop3_b32 v3, v255, s16, v236 bitop3:0x6a
    buffer_load_dwordx4 v[132:135], v3, s[8:11], 0 offen
    v_perm_b32 v4, v249, v248, s17
    v_xor_b32 v4, v4, v237
    v_pk_sub_u16 v4, s18, v4 clamp
    v_perm_b32 v5, v251, v250, s17
    v_xor_b32 v5, v5, v237
    v_pk_sub_u16 v5, s18, v5 clamp
    v_perm_b32 v6, v253, v252, s17
    v_xor_b32 v6, v6, v237
    v_pk_sub_u16 v6, s18, v6 clamp
    v_perm_b32 v7, v255, v254, s17
    v_xor_b32 v7, v7, v237
    v_pk_sub_u16 v7, s18, v7 clamp
    ds_read_b128 v[248:251], v234
    ds_read_b128 v[252:255], v234 offset:16
    v_add_u32 v234, 128, v234
    s_waitcnt lgkmcnt(2)
    v_bitop3_b32 v2, v16, s16, v236 bitop3:0x6a
    buffer_load_dwordx4 v[136:139], v2, s[8:11], 0 offen
    v_bitop3_b32 v3, v17, s16, v236 bitop3:0x6a
    buffer_load_dwordx4 v[140:143], v3, s[8:11], 0 offen
    v_bitop3_b32 v2, v18, s16, v236 bitop3:0x6a
    buffer_load_dwordx4 v[144:147], v2, s[8:11], 0 offen
    v_bitop3_b32 v3, v19, s16, v236 bitop3:0x6a
    buffer_load_dwordx4 v[148:151], v3, s[8:11], 0 offen
    v_bitop3_b32 v2, v20, s16, v236 bitop3:0x6a
    buffer_load_dwordx4 v[152:155], v2, s[8:11], 0 offen
    v_bitop3_b32 v3, v21, s16, v236 bitop3:0x6a
    buffer_load_dwordx4 v[156:159], v3, s[8:11], 0 offen
    v_bitop3_b32 v2, v22, s16, v236 bitop3:0x6a
    buffer_load_dwordx4 v[160:163], v2, s[8:11], 0 offen
    v_bitop3_b32 v3, v23, s16, v236 bitop3:0x6a
    buffer_load_dwordx4 v[164:167], v3, s[8:11], 0 offen
    v_perm_b32 v8, v17, v16, s17
    v_xor_b32 v8, v8, v237
    v_pk_sub_u16 v8, s18, v8 clamp
    v_perm_b32 v9, v19, v18, s17
    v_xor_b32 v9, v9, v237
    v_pk_sub_u16 v9, s18, v9 clamp
    v_perm_b32 v10, v21, v20, s17
    v_xor_b32 v10, v10, v237
    v_pk_sub_u16 v10, s18, v10 clamp
    v_perm_b32 v11, v23, v22, s17
    v_xor_b32 v11, v11, v237
    v_pk_sub_u16 v11, s18, v11 clamp
    s_mov_b32 s15, 1
    s_waitcnt vmcnt(8) lgkmcnt(0)
    v_perm_b32 v16, v108, v104, s19
    v_perm_b32 v17, v116, v112, s19
    v_perm_b32 v18, v124, v120, s19
    v_perm_b32 v19, v132, v128, s19
    v_bitop3_b32 v2, v248, s16, v236 bitop3:0x6a
    v_perm_b32 v20, v108, v104, s23
    v_perm_b32 v21, v116, v112, s23
    v_mfma_f32_16x16x32_bf16 v[200:203], v[16:19], v[4:7], 0
    buffer_load_dwordx4 v[168:171], v2, s[8:11], 0 offen
    v_bitop3_b32 v3, v249, s16, v236 bitop3:0x6a
    v_perm_b32 v22, v124, v120, s23
    v_perm_b32 v23, v132, v128, s23
    v_perm_b32 v16, v109, v105, s19
    v_perm_b32 v17, v117, v113, s19
    v_mfma_f32_16x16x32_bf16 v[204:207], v[20:23], v[4:7], 0
    buffer_load_dwordx4 v[172:175], v3, s[8:11], 0 offen
    v_bitop3_b32 v2, v250, s16, v236 bitop3:0x6a
    v_perm_b32 v18, v125, v121, s19
    v_perm_b32 v19, v133, v129, s19
    v_perm_b32 v20, v109, v105, s23
    v_perm_b32 v21, v117, v113, s23
    v_mfma_f32_16x16x32_bf16 v[208:211], v[16:19], v[4:7], 0
    buffer_load_dwordx4 v[176:179], v2, s[8:11], 0 offen
    v_bitop3_b32 v3, v251, s16, v236 bitop3:0x6a
    v_perm_b32 v22, v125, v121, s23
    v_perm_b32 v23, v133, v129, s23
    v_perm_b32 v16, v110, v106, s19
    v_perm_b32 v17, v118, v114, s19
    v_mfma_f32_16x16x32_bf16 v[212:215], v[20:23], v[4:7], 0
    buffer_load_dwordx4 v[180:183], v3, s[8:11], 0 offen
    v_bitop3_b32 v2, v252, s16, v236 bitop3:0x6a
    v_perm_b32 v18, v126, v122, s19
    v_perm_b32 v19, v134, v130, s19
    v_perm_b32 v20, v110, v106, s23
    v_perm_b32 v21, v118, v114, s23
    v_mfma_f32_16x16x32_bf16 v[216:219], v[16:19], v[4:7], 0
    buffer_load_dwordx4 v[184:187], v2, s[8:11], 0 offen
    v_bitop3_b32 v3, v253, s16, v236 bitop3:0x6a
    v_perm_b32 v22, v126, v122, s23
    v_perm_b32 v23, v134, v130, s23
    v_perm_b32 v16, v111, v107, s19
    v_perm_b32 v17, v119, v115, s19
    v_mfma_f32_16x16x32_bf16 v[24:27], v[20:23], v[4:7], 0
    buffer_load_dwordx4 v[188:191], v3, s[8:11], 0 offen
    v_bitop3_b32 v2, v254, s16, v236 bitop3:0x6a
    v_perm_b32 v18, v127, v123, s19
    v_perm_b32 v19, v135, v131, s19
    v_perm_b32 v20, v111, v107, s23
    v_perm_b32 v21, v119, v115, s23
    v_mfma_f32_16x16x32_bf16 v[28:31], v[16:19], v[4:7], 0
    buffer_load_dwordx4 v[192:195], v2, s[8:11], 0 offen
    v_bitop3_b32 v3, v255, s16, v236 bitop3:0x6a
    v_perm_b32 v22, v127, v123, s23
    v_perm_b32 v23, v135, v131, s23
    s_nop 1
    v_mfma_f32_16x16x32_bf16 a[252:255], v[20:23], v[4:7], 0
    buffer_load_dwordx4 v[196:199], v3, s[8:11], 0 offen
    v_perm_b32 v12, v249, v248, s17
    v_xor_b32 v12, v12, v237
    v_pk_sub_u16 v12, s18, v12 clamp
    v_perm_b32 v13, v251, v250, s17
    v_xor_b32 v13, v13, v237
    v_pk_sub_u16 v13, s18, v13 clamp
    v_perm_b32 v14, v253, v252, s17
    v_xor_b32 v14, v14, v237
    v_pk_sub_u16 v14, s18, v14 clamp
    v_perm_b32 v15, v255, v254, s17
    v_xor_b32 v15, v15, v237
    v_pk_sub_u16 v15, s18, v15 clamp
    s_branch L_k2_n0
L_k2_round:
    buffer_load_dwordx4 a[240:243], v233, s[64:67], 0 offen offset:0
    buffer_load_dwordx4 a[244:247], v233, s[64:67], 0 offen offset:16
    buffer_load_dwordx4 a[248:251], v233, s[64:67], 0 offen offset:32
    v_min_u32 v236, 12, v247
    v_mov_b32 v237, v236
    s_nop 1
    v_add_u32_dpp v237, v237, v237 row_shr:1 row_mask:0xf bank_mask:0xf
    s_nop 1
    v_add_u32_dpp v237, v237, v237 row_shr:2 row_mask:0xf bank_mask:0xf
    s_nop 1
    v_add_u32_dpp v237, v237, v237 row_shr:4 row_mask:0xf bank_mask:0xf
    s_nop 1
    v_add_u32_dpp v237, v237, v237 row_shr:8 row_mask:0xf bank_mask:0xf
    s_nop 1
    v_add_u32_dpp v237, v237, v237 row_bcast:15 row_mask:0xa bank_mask:0xf
    s_nop 1
    v_add_u32_dpp v237, v237, v237 row_bcast:31 row_mask:0xc bank_mask:0xf
    s_nop 0
    v_readlane_b32 s39, v237, 63
    v_sub_u32 v237, v237, v236
    v_lshl_add_u32 v237, v237, 2, s37
    v_sub_u32 v247, v247, v236
    v_add_u32 v233, 48, v233
    v_add_u32 v2, s39, v0
    v_lshl_add_u32 v2, v2, 2, s37
    v_mov_b32 v3, 0xfffff0
    ds_write_b32 v2, v3
    ds_write_b32 v2, v3 offset:256
    s_add_u32 s39, s39, 31
    s_lshr_b32 s39, s39, 5
    v_and_b32 v234, 48, v0
    v_lshl_add_u32 v234, v234, 1, s37
    s_waitcnt vmcnt(0)
    v_cmp_lt_u32 vcc, 0, v236
    s_mov_b64 exec, vcc
    s_cbranch_execz L_k2_listedb
    ds_write_b32 v237, a240 offset:0
    v_cmp_lt_u32 vcc, 1, v236
    s_mov_b64 exec, vcc
    ds_write_b32 v237, a241 offset:4
    v_cmp_lt_u32 vcc, 2, v236
    s_mov_b64 exec, vcc
    ds_write_b32 v237, a242 offset:8
    v_cmp_lt_u32 vcc, 3, v236
    s_mov_b64 exec, vcc
    ds_write_b32 v237, a243 offset:12
    v_cmp_lt_u32 vcc, 4, v236
    s_mov_b64 exec, vcc
    s_cbranch_execz L_k2_listedb
    ds_write_b32 v237, a244 offset:16
    v_cmp_lt_u32 vcc, 5, v236
    s_mov_b64 exec, vcc
    ds_write_b32 v237, a245 offset:20
    v_cmp_lt_u32 vcc, 6, v236
    s_mov_b64 exec, vcc
    ds_write_b32 v237, a246 offset:24
    v_cmp_lt_u32 vcc, 7, v236
    s_mov_b64 exec, vcc
    ds_write_b32 v237, a247 offset:28
    v_cmp_lt_u32 vcc, 8, v236
    s_mov_b64 exec, vcc
    s_cbranch_execz L_k2_listedb
    ds_write_b32 v237, a248 offset:32
    v_cmp_lt_u32 vcc, 9, v236
    s_mov_b64 exec, vcc
    ds_write_b32 v237, a249 offset:36
    v_cmp_lt_u32 vcc, 10, v236
    s_mov_b64 exec, vcc
    ds_write_b32 v237, a250 offset:40
    v_cmp_lt_u32 vcc, 11, v236
    s_mov_b64 exec, vcc
    ds_write_b32 v237, a251 offset:44
L_k2_listedb:
    s_mov_b64 exec, -1
    ds_read_b128 v[248:251], v234
    ds_read_b128 v[252:255], v234 offset:16
    v_add_u32 v234, 128, v234
    ds_read_b128 v[16:19], v234
    ds_read_b128 v[20:23], v234 offset:16
    v_add_u32 v234, 128, v234
    v_lshlrev_b32 v236, 4, v238
    v_lshlrev_b32 v237, 12, v238
    v_lshl_or_b32 v237, v238, 28, v237
    s_waitcnt lgkmcnt(2)
    v_bitop3_b32 v2, v248, s16, v236 bitop3:0x6a
    buffer_load_dwordx4 v[104:107], v2, s[8:11], 0 offen
    v_bitop3_b32 v3, v249, s16, v236 bitop3:0x6a
    buffer_load_dwordx4 v[108:111], v3, s[8:11], 0 offen
    v_bitop3_b32 v2, v250, s16, v236 bitop3:0x6a
    buffer_load_dwordx4 v[112:115], v2, s[8:11], 0 offen
    v_bitop3_b32 v3, v251, s16, v236 bitop3:0x6a
    buffer_load_dwordx4 v[116:119], v3, s[8:11], 0 offen
    v_bitop3_b32 v2, v252, s16, v236 bitop3:0x6a
    buffer_load_dwordx4 v[120:123], v2, s[8:11], 0 offen
    v_bitop3_b32 v3, v253, s16, v236 bitop3:0x6a
    buffer_load_dwordx4 v[124:127], v3, s[8:11], 0 offen
    v_bitop3_b32 v2, v254, s16, v236 bitop3:0x6a
    buffer_load_dwordx4 v[128:131], v2, s[8:11], 0 offen
    v_bitop3_b32 v3, v255, s16, v236 bitop3:0x6a
    buffer_load_dwordx4 v[132:135], v3, s[8:11], 0 offen
    v_perm_b32 v4, v249, v248, s17
    v_xor_b32 v4, v4, v237
    v_pk_sub_u16 v4, s18, v4 clamp
    v_perm_b32 v5, v251, v250, s17
    v_xor_b32 v5, v5, v237
    v_pk_sub_u16 v5, s18, v5 clamp
    v_perm_b32 v6, v253, v252, s17
    v_xor_b32 v6, v6, v237
    v_pk_sub_u16 v6, s18, v6 clamp
    v_perm_b32 v7, v255, v254, s17
    v_xor_b32 v7, v7, v237
    v_pk_sub_u16 v7, s18, v7 clamp
    ds_read_b128 v[248:251], v234
    ds_read_b128 v[252:255], v234 offset:16
    v_add_u32 v234, 128, v234
    s_waitcnt lgkmcnt(2)
    v_bitop3_b32 v2, v16, s16, v236 bitop3:0x6a
    buffer_load_dwordx4 v[136:139], v2, s[8:11], 0 offen
    v_bitop3_b32 v3, v17, s16, v236 bitop3:0x6a
    buffer_load_dwordx4 v[140:143], v3, s[8:11], 0 offen
    v_bitop3_b32 v2, v18, s16, v236 bitop3:0x6a
    buffer_load_dwordx4 v[144:147], v2, s[8:11], 0 offen
    v_bitop3_b32 v3, v19, s16, v236 bitop3:0x6a
    buffer_load_dwordx4 v[148:151], v3, s[8:11], 0 offen
    v_bitop3_b32 v2, v20, s16, v236 bitop3:0x6a
    buffer_load_dwordx4 v[152:155], v2, s[8:11], 0 offen
    v_bitop3_b32 v3, v21, s16, v236 bitop3:0x6a
    buffer_load_dwordx4 v[156:159], v3, s[8:11], 0 offen
    v_bitop3_b32 v2, v22, s16, v236 bitop3:0x6a
    buffer_load_dwordx4 v[160:163], v2, s[8:11], 0 offen
    v_bitop3_b32 v3, v23, s16, v236 bitop3:0x6a
    buffer_load_dwordx4 v[164:167], v3, s[8:11], 0 offen
    v_perm_b32 v8, v17, v16, s17
    v_xor_b32 v8, v8, v237
    v_pk_sub_u16 v8, s18, v8 clamp
    v_perm_b32 v9, v19, v18, s17
    v_xor_b32 v9, v9, v237
    v_pk_sub_u16 v9, s18, v9 clamp
    v_perm_b32 v10, v21, v20, s17
    v_xor_b32 v10, v10, v237
    v_pk_sub_u16 v10, s18, v10 clamp
    v_perm_b32 v11, v23, v22, s17
    v_xor_b32 v11, v11, v237
    v_pk_sub_u16 v11, s18, v11 clamp
    v_subrev_u32 v234, 128, v234
    s_mov_b32 s15, 0
L_k2_steps:
    s_cmp_ge_u32 s15, s39
    s_cbranch_scc1 L_k2_round_done
    s_add_u32 s15, s15, 1
    s_add_u32 s36, s15, 1
    s_cmp_lt_u32 s36, s39
    s_cbranch_scc1 L_k2_more0
    s_cmp_eq_u32 s36, s39
    s_cbranch_scc1 L_k2_two0
    s_waitcnt vmcnt(0)
L_k2_two0:
    s_waitcnt vmcnt(8)
    v_perm_b32 v16, v108, v104, s19
    v_perm_b32 v17, v116, v112, s19
    v_perm_b32 v18, v124, v120, s19
    v_perm_b32 v19, v132, v128, s19
    v_perm_b32 v20, v108, v104, s23
    v_perm_b32 v21, v116, v112, s23
    v_mfma_f32_16x16x32_bf16 v[200:203], v[16:19], v[4:7], v[200:203]
    v_perm_b32 v22, v124, v120, s23
    v_perm_b32 v23, v132, v128, s23
    v_perm_b32 v16, v109, v105, s19
    v_perm_b32 v17, v117, v113, s19
    v_mfma_f32_16x16x32_bf16 v[204:207], v[20:23], v[4:7], v[204:207]
    v_perm_b32 v18, v125, v121, s19
    v_perm_b32 v19, v133, v129, s19
    v_perm_b32 v20, v109, v105, s23
    v_perm_b32 v21, v117, v113, s23
    v_mfma_f32_16x16x32_bf16 v[208:211], v[16:19], v[4:7], v[208:211]
    v_perm_b32 v22, v125, v121, s23
    v_perm_b32 v23, v133, v129, s23
    v_perm_b32 v16, v110, v106, s19
    v_perm_b32 v17, v118, v114, s19
    v_mfma_f32_16x16x32_bf16 v[212:215], v[20:23], v[4:7], v[212:215]
    v_perm_b32 v18, v126, v122, s19
    v_perm_b32 v19, v134, v130, s19
    v_perm_b32 v20, v110, v106, s23
    v_perm_b32 v21, v118, v114, s23
    v_mfma_f32_16x16x32_bf16 v[216:219], v[16:19], v[4:7], v[216:219]
    v_perm_b32 v22, v126, v122, s23
    v_perm_b32 v23, v134, v130, s23
    v_perm_b32 v16, v111, v107, s19
    v_perm_b32 v17, v119, v115, s19
    v_mfma_f32_16x16x32_bf16 v[24:27], v[20:23], v[4:7], v[24:27]
    v_perm_b32 v18, v127, v123, s19
    v_perm_b32 v19, v135, v131, s19
    v_perm_b32 v20, v111, v107, s23
    v_perm_b32 v21, v119, v115, s23
    v_mfma_f32_16x16x32_bf16 v[28:31], v[16:19], v[4:7], v[28:31]
    v_perm_b32 v22, v127, v123, s23
    v_perm_b32 v23, v135, v131, s23
    s_nop 1
    v_mfma_f32_16x16x32_bf16 a[252:255], v[20:23], v[4:7], a[252:255]
    s_branch L_k2_n0
L_k2_more0:
    ds_read_b128 v[248:251], v234
    ds_read_b128 v[252:255], v234 offset:16
    v_add_u32 v234, 128, v234
    s_waitcnt vmcnt(8) lgkmcnt(0)
    v_perm_b32 v16, v108, v104, s19
    v_perm_b32 v17, v116, v112, s19
    v_perm_b32 v18, v124, v120, s19
    v_perm_b32 v19, v132, v128, s19
    v_bitop3_b32 v2, v248, s16, v236 bitop3:0x6a
    v_perm_b32 v20, v108, v104, s23
    v_perm_b32 v21, v116, v112, s23
    v_mfma_f32_16x16x32_bf16 v[200:203], v[16:19], v[4:7], v[200:203]
    buffer_load_dwordx4 v[168:171], v2, s[8:11], 0 offen
    v_bitop3_b32 v3, v249, s16, v236 bitop3:0x6a
    v_perm_b32 v22, v124, v120, s23
    v_perm_b32 v23, v132, v128, s23
    v_perm_b32 v16, v109, v105, s19
    v_perm_b32 v17, v117, v113, s19
    v_mfma_f32_16x16x32_bf16 v[204:207], v[20:23], v[4:7], v[204:207]
    buffer_load_dwordx4 v[172:175], v3, s[8:11], 0 offen
    v_bitop3_b32 v2, v250, s16, v236 bitop3:0x6a
    v_perm_b32 v18, v125, v121, s19
    v_perm_b32 v19, v133, v129, s19
    v_perm_b32 v20, v109, v105, s23
    v_perm_b32 v21, v117, v113, s23
    v_mfma_f32_16x16x32_bf16 v[208:211], v[16:19], v[4:7], v[208:211]
    buffer_load_dwordx4 v[176:179], v2, s[8:11], 0 offen
    v_bitop3_b32 v3, v251, s16, v236 bitop3:0x6a
    v_perm_b32 v22, v125, v121, s23
    v_perm_b32 v23, v133, v129, s23
    v_perm_b32 v16, v110, v106, s19
    v_perm_b32 v17, v118, v114, s19
    v_mfma_f32_16x16x32_bf16 v[212:215], v[20:23], v[4:7], v[212:215]
    buffer_load_dwordx4 v[180:183], v3, s[8:11], 0 offen
    v_bitop3_b32 v2, v252, s16, v236 bitop3:0x6a
    v_perm_b32 v18, v126, v122, s19
    v_perm_b32 v19, v134, v130, s19
    v_perm_b32 v20, v110, v106, s23
    v_perm_b32 v21, v118, v114, s23
    v_mfma_f32_16x16x32_bf16 v[216:219], v[16:19], v[4:7], v[216:219]
    buffer_load_dwordx4 v[184:187], v2, s[8:11], 0 offen
    v_bitop3_b32 v3, v253, s16, v236 bitop3:0x6a
    v_perm_b32 v22, v126, v122, s23
    v_perm_b32 v23, v134, v130, s23
    v_perm_b32 v16, v111, v107, s19
    v_perm_b32 v17, v119, v115, s19
    v_mfma_f32_16x16x32_bf16 v[24:27], v[20:23], v[4:7], v[24:27]
    buffer_load_dwordx4 v[188:191], v3, s[8:11], 0 offen
    v_bitop3_b32 v2, v254, s16, v236 bitop3:0x6a
    v_perm_b32 v18, v127, v123, s19
    v_perm_b32 v19, v135, v131, s19
    v_perm_b32 v20, v111, v107, s23
    v_perm_b32 v21, v119, v115, s23
    v_mfma_f32_16x16x32_bf16 v[28:31], v[16:19], v[4:7], v[28:31]
    buffer_load_dwordx4 v[192:195], v2, s[8:11], 0 offen
    v_bitop3_b32 v3, v255, s16, v236 bitop3:0x6a
    v_perm_b32 v22, v127, v123, s23
    v_perm_b32 v23, v135, v131, s23
    s_nop 1
    v_mfma_f32_16x16x32_bf16 a[252:255], v[20:23], v[4:7], a[252:255]
    buffer_load_dwordx4 v[196:199], v3, s[8:11], 0 offen
    v_perm_b32 v12, v249, v248, s17
    v_xor_b32 v12, v12, v237
    v_pk_sub_u16 v12, s18, v12 clamp
    v_perm_b32 v13, v251, v250, s17
    v_xor_b32 v13, v13, v237
    v_pk_sub_u16 v13, s18, v13 clamp
    v_perm_b32 v14, v253, v252, s17
    v_xor_b32 v14, v14, v237
    v_pk_sub_u16 v14, s18, v14 clamp
    v_perm_b32 v15, v255, v254, s17
    v_xor_b32 v15, v15, v237
    v_pk_sub_u16 v15, s18, v15 clamp
L_k2_n0:
    s_cmp_ge_u32 s15, s39
    s_cbranch_scc1 L_k2_round_done
    s_add_u32 s15, s15, 1
    s_add_u32 s36, s15, 1
    s_cmp_lt_u32 s36, s39
    s_cbranch_scc1 L_k2_more1
    s_cmp_eq_u32 s36, s39
    s_cbranch_scc1 L_k2_two1
    s_waitcnt vmcnt(0)
L_k2_two1:
    s_waitcnt vmcnt(8)
    v_perm_b32 v16, v140, v136, s19
    v_perm_b32 v17, v148, v144, s19
    v_perm_b32 v18, v156, v152, s19
    v_perm_b32 v19, v164, v160, s19
    v_perm_b32 v20, v140, v136, s23
    v_perm_b32 v21, v148, v144, s23
    v_mfma_f32_16x16x32_bf16 v[200:203], v[16:19], v[8:11], v[200:203]
    v_perm_b32 v22, v156, v152, s23
    v_perm_b32 v23, v164, v160, s23
    v_perm_b32 v16, v141, v137, s19
    v_perm_b32 v17, v149, v145, s19
    v_mfma_f32_16x16x32_bf16 v[204:207], v[20:23], v[8:11], v[204:207]
    v_perm_b32 v18, v157, v153, s19
    v_perm_b32 v19, v165, v161, s19
    v_perm_b32 v20, v141, v137, s23
    v_perm_b32 v21, v149, v145, s23
    v_mfma_f32_16x16x32_bf16 v[208:211], v[16:19], v[8:11], v[208:211]
    v_perm_b32 v22, v157, v153, s23
    v_perm_b32 v23, v165, v161, s23
    v_perm_b32 v16, v142, v138, s19
    v_perm_b32 v17, v150, v146, s19
    v_mfma_f32_16x16x32_bf16 v[212:215], v[20:23], v[8:11], v[212:215]
    v_perm_b32 v18, v158, v154, s19
    v_perm_b32 v19, v166, v162, s19
    v_perm_b32 v20, v142, v138, s23
    v_perm_b32 v21, v150, v146, s23
    v_mfma_f32_16x16x32_bf16 v[216:219], v[16:19], v[8:11], v[216:219]
    v_perm_b32 v22, v158, v154, s23
    v_perm_b32 v23, v166, v162, s23
    v_perm_b32 v16, v143, v139, s19
    v_perm_b32 v17, v151, v147, s19
    v_mfma_f32_16x16x32_bf16 v[24:27], v[20:23], v[8:11], v[24:27]
    v_perm_b32 v18, v159, v155, s19
    v_perm_b32 v19, v167, v163, s19
    v_perm_b32 v20, v143, v139, s23
    v_perm_b32 v21, v151, v147, s23
    v_mfma_f32_16x16x32_bf16 v[28:31], v[16:19], v[8:11], v[28:31]
    v_perm_b32 v22, v159, v155, s23
    v_perm_b32 v23, v167, v163, s23
    s_nop 1
    v_mfma_f32_16x16x32_bf16 a[252:255], v[20:23], v[8:11], a[252:255]
    s_branch L_k2_n1
L_k2_more1:
    ds_read_b128 v[248:251], v234
    ds_read_b128 v[252:255], v234 offset:16
    v_add_u32 v234, 128, v234
    s_waitcnt vmcnt(8) lgkmcnt(0)
    v_perm_b32 v16, v140, v136, s19
    v_perm_b32 v17, v148, v144, s19
    v_perm_b32 v18, v156, v152, s19
    v_perm_b32 v19, v164, v160, s19
    v_bitop3_b32 v2, v248, s16, v236 bitop3:0x6a
    v_perm_b32 v20, v140, v136, s23
    v_perm_b32 v21, v148, v144, s23
    v_mfma_f32_16x16x32_bf16 v[200:203], v[16:19], v[8:11], v[200:203]
    buffer_load_dwordx4 v[104:107], v2, s[8:11], 0 offen
    v_bitop3_b32 v3, v249, s16, v236 bitop3:0x6a
    v_perm_b32 v22, v156, v152, s23
    v_perm_b32 v23, v164, v160, s23
    v_perm_b32 v16, v141, v137, s19
    v_perm_b32 v17, v149, v145, s19
    v_mfma_f32_16x16x32_bf16 v[204:207], v[20:23], v[8:11], v[204:207]
    buffer_load_dwordx4 v[108:111], v3, s[8:11], 0 offen
    v_bitop3_b32 v2, v250, s16, v236 bitop3:0x6a
    v_perm_b32 v18, v157, v153, s19
    v_perm_b32 v19, v165, v161, s19
    v_perm_b32 v20, v141, v137, s23
    v_perm_b32 v21, v149, v145, s23
    v_mfma_f32_16x16x32_bf16 v[208:211], v[16:19], v[8:11], v[208:211]
    buffer_load_dwordx4 v[112:115], v2, s[8:11], 0 offen
    v_bitop3_b32 v3, v251, s16, v236 bitop3:0x6a
    v_perm_b32 v22, v157, v153, s23
    v_perm_b32 v23, v165, v161, s23
    v_perm_b32 v16, v142, v138, s19
    v_perm_b32 v17, v150, v146, s19
    v_mfma_f32_16x16x32_bf16 v[212:215], v[20:23], v[8:11], v[212:215]
    buffer_load_dwordx4 v[116:119], v3, s[8:11], 0 offen
    v_bitop3_b32 v2, v252, s16, v236 bitop3:0x6a
    v_perm_b32 v18, v158, v154, s19
    v_perm_b32 v19, v166, v162, s19
    v_perm_b32 v20, v142, v138, s23
    v_perm_b32 v21, v150, v146, s23
    v_mfma_f32_16x16x32_bf16 v[216:219], v[16:19], v[8:11], v[216:219]
    buffer_load_dwordx4 v[120:123], v2, s[8:11], 0 offen
    v_bitop3_b32 v3, v253, s16, v236 bitop3:0x6a
    v_perm_b32 v22, v158, v154, s23
    v_perm_b32 v23, v166, v162, s23
    v_perm_b32 v16, v143, v139, s19
    v_perm_b32 v17, v151, v147, s19
    v_mfma_f32_16x16x32_bf16 v[24:27], v[20:23], v[8:11], v[24:27]
    buffer_load_dwordx4 v[124:127], v3, s[8:11], 0 offen
    v_bitop3_b32 v2, v254, s16, v236 bitop3:0x6a
    v_perm_b32 v18, v159, v155, s19
    v_perm_b32 v19, v167, v163, s19
    v_perm_b32 v20, v143, v139, s23
    v_perm_b32 v21, v151, v147, s23
    v_mfma_f32_16x16x32_bf16 v[28:31], v[16:19], v[8:11], v[28:31]
    buffer_load_dwordx4 v[128:131], v2, s[8:11], 0 offen
    v_bitop3_b32 v3, v255, s16, v236 bitop3:0x6a
    v_perm_b32 v22, v159, v155, s23
    v_perm_b32 v23, v167, v163, s23
    s_nop 1
    v_mfma_f32_16x16x32_bf16 a[252:255], v[20:23], v[8:11], a[252:255]
    buffer_load_dwordx4 v[132:135], v3, s[8:11], 0 offen
    v_perm_b32 v4, v249, v248, s17
    v_xor_b32 v4, v4, v237
    v_pk_sub_u16 v4, s18, v4 clamp
    v_perm_b32 v5, v251, v250, s17
    v_xor_b32 v5, v5, v237
    v_pk_sub_u16 v5, s18, v5 clamp
    v_perm_b32 v6, v253, v252, s17
    v_xor_b32 v6, v6, v237
    v_pk_sub_u16 v6, s18, v6 clamp
    v_perm_b32 v7, v255, v254, s17
    v_xor_b32 v7, v7, v237
    v_pk_sub_u16 v7, s18, v7 clamp
L_k2_n1:
    s_cmp_ge_u32 s15, s39
    s_cbranch_scc1 L_k2_round_done
    s_add_u32 s15, s15, 1
    s_add_u32 s36, s15, 1
    s_cmp_lt_u32 s36, s39
    s_cbranch_scc1 L_k2_more2
    s_cmp_eq_u32 s36, s39
    s_cbranch_scc1 L_k2_two2
    s_waitcnt vmcnt(0)
L_k2_two2:
    s_waitcnt vmcnt(8)
    v_perm_b32 v16, v172, v168, s19
    v_perm_b32 v17, v180, v176, s19
    v_perm_b32 v18, v188, v184, s19
    v_perm_b32 v19, v196, v192, s19
    v_perm_b32 v20, v172, v168, s23
    v_perm_b32 v21, v180, v176, s23
    v_mfma_f32_16x16x32_bf16 v[200:203], v[16:19], v[12:15], v[200:203]
    v_perm_b32 v22, v188, v184, s23
    v_perm_b32 v23, v196, v192, s23
    v_perm_b32 v16, v173, v169, s19
    v_perm_b32 v17, v181, v177, s19
    v_mfma_f32_16x16x32_bf16 v[204:207], v[20:23], v[12:15], v[204:207]
    v_perm_b32 v18, v189, v185, s19
    v_perm_b32 v19, v197, v193, s19
    v_perm_b32 v20, v173, v169, s23
    v_perm_b32 v21, v181, v177, s23
    v_mfma_f32_16x16x32_bf16 v[208:211], v[16:19], v[12:15], v[208:211]
    v_perm_b32 v22, v189, v185, s23
    v_perm_b32 v23, v197, v193, s23
    v_perm_b32 v16, v174, v170, s19
    v_perm_b32 v17, v182, v178, s19
    v_mfma_f32_16x16x32_bf16 v[212:215], v[20:23], v[12:15], v[212:215]
    v_perm_b32 v18, v190, v186, s19
    v_perm_b32 v19, v198, v194, s19
    v_perm_b32 v20, v174, v170, s23
    v_perm_b32 v21, v182, v178, s23
    v_mfma_f32_16x16x32_bf16 v[216:219], v[16:19], v[12:15], v[216:219]
    v_perm_b32 v22, v190, v186, s23
    v_perm_b32 v23, v198, v194, s23
    v_perm_b32 v16, v175, v171, s19
    v_perm_b32 v17, v183, v179, s19
    v_mfma_f32_16x16x32_bf16 v[24:27], v[20:23], v[12:15], v[24:27]
    v_perm_b32 v18, v191, v187, s19
    v_perm_b32 v19, v199, v195, s19
    v_perm_b32 v20, v175, v171, s23
    v_perm_b32 v21, v183, v179, s23
    v_mfma_f32_16x16x32_bf16 v[28:31], v[16:19], v[12:15], v[28:31]
    v_perm_b32 v22, v191, v187, s23
    v_perm_b32 v23, v199, v195, s23
    s_nop 1
    v_mfma_f32_16x16x32_bf16 a[252:255], v[20:23], v[12:15], a[252:255]
    s_branch L_k2_n2
L_k2_more2:
    ds_read_b128 v[248:251], v234
    ds_read_b128 v[252:255], v234 offset:16
    v_add_u32 v234, 128, v234
    s_waitcnt vmcnt(8) lgkmcnt(0)
    v_perm_b32 v16, v172, v168, s19
    v_perm_b32 v17, v180, v176, s19
    v_perm_b32 v18, v188, v184, s19
    v_perm_b32 v19, v196, v192, s19
    v_bitop3_b32 v2, v248, s16, v236 bitop3:0x6a
    v_perm_b32 v20, v172, v168, s23
    v_perm_b32 v21, v180, v176, s23
    v_mfma_f32_16x16x32_bf16 v[200:203], v[16:19], v[12:15], v[200:203]
    buffer_load_dwordx4 v[136:139], v2, s[8:11], 0 offen
    v_bitop3_b32 v3, v249, s16, v236 bitop3:0x6a
    v_perm_b32 v22, v188, v184, s23
    v_perm_b32 v23, v196, v192, s23
    v_perm_b32 v16, v173, v169, s19
    v_perm_b32 v17, v181, v177, s19
    v_mfma_f32_16x16x32_bf16 v[204:207], v[20:23], v[12:15], v[204:207]
    buffer_load_dwordx4 v[140:143], v3, s[8:11], 0 offen
    v_bitop3_b32 v2, v250, s16, v236 bitop3:0x6a
    v_perm_b32 v18, v189, v185, s19
    v_perm_b32 v19, v197, v193, s19
    v_perm_b32 v20, v173, v169, s23
    v_perm_b32 v21, v181, v177, s23
    v_mfma_f32_16x16x32_bf16 v[208:211], v[16:19], v[12:15], v[208:211]
    buffer_load_dwordx4 v[144:147], v2, s[8:11], 0 offen
    v_bitop3_b32 v3, v251, s16, v236 bitop3:0x6a
    v_perm_b32 v22, v189, v185, s23
    v_perm_b32 v23, v197, v193, s23
    v_perm_b32 v16, v174, v170, s19
    v_perm_b32 v17, v182, v178, s19
    v_mfma_f32_16x16x32_bf16 v[212:215], v[20:23], v[12:15], v[212:215]
    buffer_load_dwordx4 v[148:151], v3, s[8:11], 0 offen
    v_bitop3_b32 v2, v252, s16, v236 bitop3:0x6a
    v_perm_b32 v18, v190, v186, s19
    v_perm_b32 v19, v198, v194, s19
    v_perm_b32 v20, v174, v170, s23
    v_perm_b32 v21, v182, v178, s23
    v_mfma_f32_16x16x32_bf16 v[216:219], v[16:19], v[12:15], v[216:219]
    buffer_load_dwordx4 v[152:155], v2, s[8:11], 0 offen
    v_bitop3_b32 v3, v253, s16, v236 bitop3:0x6a
    v_perm_b32 v22, v190, v186, s23
    v_perm_b32 v23, v198, v194, s23
    v_perm_b32 v16, v175, v171, s19
    v_perm_b32 v17, v183, v179, s19
    v_mfma_f32_16x16x32_bf16 v[24:27], v[20:23], v[12:15], v[24:27]
    buffer_load_dwordx4 v[156:159], v3, s[8:11], 0 offen
    v_bitop3_b32 v2, v254, s16, v236 bitop3:0x6a
    v_perm_b32 v18, v191, v187, s19
    v_perm_b32 v19, v199, v195, s19
    v_perm_b32 v20, v175, v171, s23
    v_perm_b32 v21, v183, v179, s23
    v_mfma_f32_16x16x32_bf16 v[28:31], v[16:19], v[12:15], v[28:31]
    buffer_load_dwordx4 v[160:163], v2, s[8:11], 0 offen
    v_bitop3_b32 v3, v255, s16, v236 bitop3:0x6a
    v_perm_b32 v22, v191, v187, s23
    v_perm_b32 v23, v199, v195, s23
    s_nop 1
    v_mfma_f32_16x16x32_bf16 a[252:255], v[20:23], v[12:15], a[252:255]
    buffer_load_dwordx4 v[164:167], v3, s[8:11], 0 offen
    v_perm_b32 v8, v249, v248, s17
    v_xor_b32 v8, v8, v237
    v_pk_sub_u16 v8, s18, v8 clamp
    v_perm_b32 v9, v251, v250, s17
    v_xor_b32 v9, v9, v237
    v_pk_sub_u16 v9, s18, v9 clamp
    v_perm_b32 v10, v253, v252, s17
    v_xor_b32 v10, v10, v237
    v_pk_sub_u16 v10, s18, v10 clamp
    v_perm_b32 v11, v255, v254, s17
    v_xor_b32 v11, v11, v237
    v_pk_sub_u16 v11, s18, v11 clamp
L_k2_n2:
    s_branch L_k2_steps
L_k2_round_done:
    v_cmp_ne_u32 vcc, 0, v247
    s_waitcnt vmcnt(0)
    s_cmp_lg_u64 vcc, 0
    s_cbranch_scc1 L_k2_round
    ds_read_b128 v[164:167], v220 offset:0
    ds_read_b128 v[168:171], v221 offset:0
    ds_read_b128 v[172:175], v222 offset:0
    ds_read_b128 v[176:179], v223 offset:0
    v_add_u32 v2, s37, v1
    v_accvgpr_read_b32 v248, a252
    v_accvgpr_read_b32 v249, a253
    v_accvgpr_read_b32 v250, a254
    v_accvgpr_read_b32 v251, a255
    v_cvt_pk_bf16_f32 v16, v200, v204
    v_cvt_pk_bf16_f32 v17, v208, v212
    v_cvt_pk_bf16_f32 v18, v216, v24
    v_cvt_pk_bf16_f32 v19, v28, v248
    ds_write_b128 v2, v[16:19] offset:0
    v_cvt_pk_bf16_f32 v20, v201, v205
    v_cvt_pk_bf16_f32 v21, v209, v213
    v_cvt_pk_bf16_f32 v22, v217, v25
    v_cvt_pk_bf16_f32 v23, v29, v249
    ds_write_b128 v2, v[20:23] offset:1024
    v_cvt_pk_bf16_f32 v16, v202, v206
    v_cvt_pk_bf16_f32 v17, v210, v214
    v_cvt_pk_bf16_f32 v18, v218, v26
    v_cvt_pk_bf16_f32 v19, v30, v250
    ds_write_b128 v2, v[16:19] offset:2048
    v_cvt_pk_bf16_f32 v20, v203, v207
    v_cvt_pk_bf16_f32 v21, v211, v215
    v_cvt_pk_bf16_f32 v22, v219, v27
    v_cvt_pk_bf16_f32 v23, v31, v251
    ds_write_b128 v2, v[20:23] offset:3072
    s_mov_b32 s96, s100
    s_mov_b32 s97, s101
    s_mov_b32 s98, 0x4e20
    s_mov_b32 s99, 0x20000
    s_mul_i32 s38, s20, 5120
    s_add_u32 s60, s24, s38
    s_addc_u32 s61, s25, 0
    s_mov_b32 s62, 66560
    s_mov_b32 s6, 20480
    s_lshl_b32 s38, s14, 1
    s_add_u32 s38, s38, 4
    s_mul_i32 s12, s38, 20480
    v_cmp_gt_u32 vcc, 40, v0
    v_mov_b32 v3, 0x10000000
    s_nop 0
    v_cndmask_b32 v235, v3, v235, vcc
    s_waitcnt lgkmcnt(4)
    s_cmp_eq_u32 s13, 1
    s_cbranch_scc1 L_k2_idle_back
    s_cmp_eq_u32 s13, 2
    s_cbranch_scc1 L_k2_slow_back
    s_mov_b32 s13, 4
    s_mov_b32 s48, s14
    s_branch L_k2_loop
L_k2_idle:
    buffer_load_dwordx4 a[192:195], v1, s[12:15], s54 offen offset:0 sc1
    buffer_load_dwordx4 a[196:199], v1, s[12:15], s54 offen offset:1024 sc1
    buffer_load_dwordx4 a[200:203], v1, s[12:15], s54 offen offset:2048 sc1
    buffer_load_dwordx4 a[204:207], v1, s[12:15], s54 offen offset:3072 sc1
    buffer_load_dwordx4 a[208:211], v1, s[12:15], s55 offen offset:0 sc1
    buffer_load_dwordx4 a[212:215], v1, s[12:15], s55 offen offset:1024 sc1
    buffer_load_dwordx4 a[216:219], v1, s[12:15], s55 offen offset:2048 sc1
    buffer_load_dwordx4 a[220:223], v1, s[12:15], s55 offen offset:3072 sc1
    buffer_load_dwordx4 a[224:227], v1, s[12:15], s56 offen offset:0 sc1
    buffer_load_dwordx4 a[228:231], v1, s[12:15], s56 offen offset:1024 sc1
    buffer_load_dwordx4 a[232:235], v1, s[12:15], s56 offen offset:2048 sc1
    buffer_load_dwordx4 a[236:239], v1, s[12:15], s56 offen offset:3072 sc1
    s_add_u32 s45, s45, 24576
    s_add_u32 s47, s46, s42
    s_mov_b32 m0, s47
    s_nop 0
    buffer_load_dwordx4 v232, s[8:11], s45 offen offset:0 lds
    buffer_load_dwordx4 v232, s[8:11], s45 offen offset:1024 lds
    buffer_load_dwordx4 v232, s[8:11], s45 offen offset:2048 lds
    buffer_load_dwordx4 v232, s[8:11], s45 offen offset:3072 lds
    s_add_u32 s45, s45, 4096
    s_add_u32 m0, m0, 4096
    s_nop 0
    buffer_load_dwordx4 v232, s[8:11], s45 offen offset:0 lds
    buffer_load_dwordx4 v232, s[8:11], s45 offen offset:1024 lds
    s_add_u32 s45, s45, 20480
    s_lshl_b32 s36, s20, 20
    s_lshr_b32 s38, s6, 2
    s_lshl_b32 s38, s38, 7
    s_add_u32 s36, s36, s38
    s_and_b32 s38, s6, 3
    s_lshl_b32 s38, s38, 2
    s_add_u32 s36, s36, s38
    s_add_u32 s36, s36, 32768
    v_mov_b32 v250, s34
    v_lshl_add_u32 v251, v0, 24, s36
    s_add_u32 s96, s4, 0x1a00000
    s_addc_u32 s97, s5, 0
    s_mov_b32 s98, 0x2c000
    s_mov_b32 s99, 0x20000
    buffer_store_dword v250, v251, s[96:99], 0 offen sc1
    s_mul_i32 s36, s20, 17
    v_min_u32 v2, 16, v0
    v_add_u32 v2, s36, v2
    s_mul_i32 s36, s22, 78
    s_add_u32 s36, s36, 12
    v_cmp_gt_u32 vcc, 66, v2
    v_add_u32 v2, s36, v2
    v_mov_b32 v3, 624
    v_cndmask_b32 v2, v3, v2, vcc
    v_mov_b32 v3, 65536
    v_lshl_add_u32 v249, v2, 7, v3
    v_mov_b32 v3, 32768
    v_lshl_add_u32 v233, v0, 7, v3
    v_lshlrev_b32 v235, 7, v0
    s_mov_b32 s49, 2555904
    s_lshl_b32 s37, s20, 12
    s_add_u32 s37, s37, 73728
    s_lshl_b32 s51, s20, 14
    s_add_u32 s64, s4, 0x560000
    s_addc_u32 s65, s5, 0
    s_mov_b32 s66, 0x9c400
    s_mov_b32 s67, 0x20000
    s_add_u32 s60, s4, 0x1a08000
    s_addc_u32 s61, s5, 0
    s_mov_b32 s62, 0x2000
    s_mov_b32 s63, 0x20000
    s_mov_b32 s12, -8192
    s_bfe_u32 s36, s2, 0x10003
    s_add_u32 s36, s36, 1
    s_mov_b32 s48, -1
    s_sub_u32 s14, s36, 4
    s_mov_b32 s13, 0
    s_add_u32 s50, s51, 14336
    s_lshl_b32 s36, s21, 3
    s_add_u32 s36, s36, s22
    s_mul_i32 s36, s36, 81920
    s_add_u32 s36, s36, 0x600000
    s_add_u32 s24, s4, s36
    s_addc_u32 s25, s5, 0
    s_mov_b32 s26, 81920
    s_lshl_b32 s58, s23, 10
    s_lshr_b32 s52, s52, 2
    s_sub_u32 s52, s52, s58
    s_lshr_b32 s53, s53, 2
    s_sub_u32 s53, s53, s58
    s_lshr_b32 s54, s54, 2
    s_sub_u32 s54, s54, s58
    s_lshr_b32 s55, s55, 2
    s_sub_u32 s55, s55, s58
    s_lshr_b32 s56, s56, 2
    s_sub_u32 s56, s56, s58
    s_mov_b32 s27, 0x20000
    s_add_u32 s28, s4, 0x500000
    s_addc_u32 s29, s5, 0
    s_mov_b32 s30, 0x10000
    s_mov_b32 s31, 0x20000
    s_lshl_b32 s36, s21, 10
    s_add_u32 s36, s36, 0x1a24000
    s_add_u32 s68, s4, s36
    s_addc_u32 s69, s5, 0
    s_mov_b32 s70, 512
    s_mov_b32 s71, 0x20000
    s_add_u32 s36, s22, 1
    s_mul_i32 s7, s36, 319488
    s_mov_b32 s6, 8192
    v_and_b32 v238, 15, v0
    v_lshrrev_b32 v239, 4, v0
    s_sub_u32 s36, s32, s20
    s_mul_i32 s36, s36, 10
    s_lshl_b32 s38, s20, 4
    v_add_u32 v3, s38, v238
    v_add_u32 v2, s36, v3
    v_lshlrev_b32 v2, 8, v2
    v_lshl_add_u32 v2, v239, 4, v2
    v_cmp_gt_u32 vcc, 40, v3
    v_mov_b32 v240, 0x10000000
    s_nop 0
    v_cndmask_b32 v240, v240, v2, vcc
    v_mov_b32 v242, 0
    v_mov_b32 v243, 0
    v_mov_b32 v244, 0
    v_mov_b32 v245, 0
    v_mov_b32 v246, 0
    s_mov_b32 s16, 0x00ffffff
    s_mov_b32 s17, 0x070c030c
    s_mov_b32 s18, 0x10001000
    s_mov_b32 s19, 0x05040100
    s_mov_b32 s23, 0x07060302
    buffer_load_dword v248, v249, s[96:99], 0 offen sc1
    s_waitcnt vmcnt(0)
    v_xor_b32 v248, s34, v248
    v_cmp_lt_u32 vcc, 7, v248
    s_cmp_lg_u64 vcc, 0
    s_cbranch_scc1 L_km_rdyi
L_km_rdyei:
    s_barrier
    s_mov_b32 s48, -12
L_k2_idle_loop:
    s_mov_b32 s47, s40
    s_mov_b32 s40, s41
    s_mov_b32 s41, s42
    s_mov_b32 s42, s47
    s_add_u32 s47, s46, s42
    s_mov_b32 m0, s47
    s_nop 0
    buffer_load_dwordx4 v232, s[8:11], s45 offen offset:0 lds
    buffer_load_dwordx4 v232, s[8:11], s45 offen offset:1024 lds
    buffer_load_dwordx4 v232, s[8:11], s45 offen offset:2048 lds
    buffer_load_dwordx4 v232, s[8:11], s45 offen offset:3072 lds
    s_add_u32 s45, s45, 4096
    s_add_u32 m0, m0, 4096
    s_nop 0
    buffer_load_dwordx4 v232, s[8:11], s45 offen offset:0 lds
    buffer_load_dwordx4 v232, s[8:11], s45 offen offset:1024 lds
    s_add_u32 s45, s45, 20480
    s_cmp_eq_u32 s48, -2
    s_cselect_b32 s45, s49, s45
    s_mov_b32 s13, 1
    s_cmp_eq_u32 s48, -7
    s_cbranch_scc1 L_k2_local
    s_cmp_eq_u32 s48, -10
    s_cbranch_scc0 L_k2_idle_back
    buffer_load_dwordx4 v[248:251], v233, s[96:99], 0 offen sc1
    s_waitcnt vmcnt(0)
    v_xor_b32 v248, s34, v248
    v_xor_b32 v249, s34, v249
    v_xor_b32 v250, s34, v250
    v_xor_b32 v251, s34, v251
    v_or_b32 v248, v248, v249
    v_or3_b32 v248, v248, v250, v251
    v_cmp_lt_u32 vcc, 7, v248
    s_cmp_lg_u64 vcc, 0
    s_cbranch_scc1 L_km_rdyj
L_km_rdyej:
    s_add_u32 s96, s4, 0x520000
    s_addc_u32 s97, s5, 0
    s_mov_b32 s98, 0x40000
    s_mov_b32 s99, 0x20000
    s_lshl_b32 s38, s32, 2
    v_lshlrev_b32 v233, 12, v0
    buffer_load_dword v247, v233, s[96:99], s38 offen
    s_waitcnt vmcnt(0)
    v_mul_u32_u24 v233, 2500, v0
    v_and_b32 v2, 0xffff, v247
    v_lshrrev_b32 v247, 16, v247
    v_add_lshl_u32 v233, v233, v2, 2
    buffer_load_dwordx4 a[240:243], v233, s[64:67], 0 offen offset:0
    buffer_load_dwordx4 a[244:247], v233, s[64:67], 0 offen offset:16
    buffer_load_dwordx4 a[248:251], v233, s[64:67], 0 offen offset:32
    buffer_load_dwordx4 a[252:255], v233, s[64:67], 0 offen offset:48
    s_add_u32 s50, s51, 0
    s_add_u32 m0, s50, 90112
    s_nop 0
    buffer_load_dwordx4 v1, s[28:31], s50 offen offset:0 lds
    buffer_load_dwordx4 v1, s[28:31], s50 offen offset:1024 lds
    buffer_load_dwordx4 v1, s[28:31], s50 offen offset:2048 lds
    buffer_load_dwordx4 v1, s[28:31], s50 offen offset:3072 lds
    s_add_u32 s50, s51, 4096
    s_add_u32 m0, s50, 90112
    s_nop 0
    buffer_load_dwordx4 v1, s[28:31], s50 offen offset:0 lds
    buffer_load_dwordx4 v1, s[28:31], s50 offen offset:1024 lds
    buffer_load_dwordx4 v1, s[28:31], s50 offen offset:2048 lds
    buffer_load_dwordx4 v1, s[28:31], s50 offen offset:3072 lds
    s_add_u32 s50, s51, 8192
    s_add_u32 m0, s50, 90112
    s_nop 0
    buffer_load_dwordx4 v1, s[28:31], s50 offen offset:0 lds
    buffer_load_dwordx4 v1, s[28:31], s50 offen offset:1024 lds
    buffer_load_dwordx4 v1, s[28:31], s50 offen offset:2048 lds
    buffer_load_dwordx4 v1, s[28:31], s50 offen offset:3072 lds
    s_add_u32 s50, s51, 12288
    s_add_u32 m0, s50, 90112
    s_nop 0
    buffer_load_dwordx4 v1, s[28:31], s50 offen offset:0 lds
    buffer_load_dwordx4 v1, s[28:31], s50 offen offset:1024 lds
    buffer_load_dwordx4 v1, s[28:31], s50 offen offset:2048 lds
    buffer_load_dwordx4 v1, s[28:31], s50 offen offset:3072 lds
L_k2_idle_back:
    s_waitcnt vmcnt(0)
    s_barrier
    s_add_u32 s48, s48, 1
    s_cbranch_scc0 L_k2_idle_loop
L_k2_idle_tail:
    buffer_load_dwordx4 a[160:163], v240, s[72:75], 0 offen offset:0 nt
    buffer_load_dwordx4 a[164:167], v240, s[72:75], 0 offen offset:64 nt
    buffer_load_dwordx4 a[168:171], v240, s[72:75], 0 offen offset:128 nt
    buffer_load_dwordx4 a[172:175], v240, s[72:75], 0 offen offset:192 nt
    v_lshrrev_b32 v2, 8, v240
    v_lshlrev_b32 v2, 1, v2
    buffer_load_ushort v232, v2, s[96:99], 0 offen
    v_lshlrev_b32 v2, 7, v0
    buffer_load_dword v42, v2, s[68:71], 0 offen sc1
    s_waitcnt vmcnt(0)
    s_branch L_k2_tail
L_k2_slow:
    buffer_load_dwordx4 a[192:195], v1, s[12:15], s54 offen offset:0 sc1
    buffer_load_dwordx4 a[196:199], v1, s[12:15], s54 offen offset:1024 sc1
    buffer_load_dwordx4 a[200:203], v1, s[12:15], s54 offen offset:2048 sc1
    buffer_load_dwordx4 a[204:207], v1, s[12:15], s54 offen offset:3072 sc1
    buffer_load_dwordx4 a[208:211], v1, s[12:15], s55 offen offset:0 sc1
    buffer_load_dwordx4 a[212:215], v1, s[12:15], s55 offen offset:1024 sc1
    buffer_load_dwordx4 a[216:219], v1, s[12:15], s55 offen offset:2048 sc1
    buffer_load_dwordx4 a[220:223], v1, s[12:15], s55 offen offset:3072 sc1
    buffer_load_dwordx4 a[224:227], v1, s[12:15], s56 offen offset:0 sc1
    buffer_load_dwordx4 a[228:231], v1, s[12:15], s56 offen offset:1024 sc1
    buffer_load_dwordx4 a[232:235], v1, s[12:15], s56 offen offset:2048 sc1
    buffer_load_dwordx4 a[236:239], v1, s[12:15], s56 offen offset:3072 sc1
    s_add_u32 s45, s45, 24576
    s_add_u32 s47, s46, s42
    s_mov_b32 m0, s47
    s_nop 0
    buffer_load_dwordx4 v232, s[8:11], s45 offen offset:0 lds
    buffer_load_dwordx4 v232, s[8:11], s45 offen offset:1024 lds
    buffer_load_dwordx4 v232, s[8:11], s45 offen offset:2048 lds
    buffer_load_dwordx4 v232, s[8:11], s45 offen offset:3072 lds
    s_add_u32 s45, s45, 4096
    s_add_u32 m0, m0, 4096
    s_nop 0
    buffer_load_dwordx4 v232, s[8:11], s45 offen offset:0 lds
    buffer_load_dwordx4 v232, s[8:11], s45 offen offset:1024 lds
    s_add_u32 s45, s45, 20480
    s_lshl_b32 s36, s20, 20
    s_lshr_b32 s38, s6, 2
    s_lshl_b32 s38, s38, 7
    s_add_u32 s36, s36, s38
    s_and_b32 s38, s6, 3
    s_lshl_b32 s38, s38, 2
    s_add_u32 s36, s36, s38
    s_add_u32 s36, s36, 32768
    v_mov_b32 v250, s34
    v_lshl_add_u32 v251, v0, 24, s36
    s_add_u32 s96, s4, 0x1a00000
    s_addc_u32 s97, s5, 0
    s_mov_b32 s98, 0x2c000
    s_mov_b32 s99, 0x20000
    buffer_store_dword v250, v251, s[96:99], 0 offen sc1
    s_mul_i32 s36, s20, 17
    v_min_u32 v2, 16, v0
    v_add_u32 v2, s36, v2
    s_mul_i32 s36, s22, 78
    s_add_u32 s36, s36, 12
    v_cmp_gt_u32 vcc, 66, v2
    v_add_u32 v2, s36, v2
    v_mov_b32 v3, 624
    v_cndmask_b32 v2, v3, v2, vcc
    v_mov_b32 v3, 65536
    v_lshl_add_u32 v249, v2, 7, v3
    v_mov_b32 v3, 32768
    v_lshl_add_u32 v233, v0, 7, v3
    v_lshlrev_b32 v235, 7, v0
    s_mov_b32 s49, 2555904
    s_lshl_b32 s37, s20, 12
    s_add_u32 s37, s37, 73728
    s_lshl_b32 s51, s20, 14
    s_add_u32 s64, s4, 0x560000
    s_addc_u32 s65, s5, 0
    s_mov_b32 s66, 0x9c400
    s_mov_b32 s67, 0x20000
    s_add_u32 s60, s4, 0x1a08000
    s_addc_u32 s61, s5, 0
    s_mov_b32 s62, 0x2000
    s_mov_b32 s63, 0x20000
    s_mov_b32 s12, -8192
    s_bfe_u32 s36, s2, 0x10003
    s_add_u32 s36, s36, 1
    s_mov_b32 s48, -1
    s_sub_u32 s14, s36, 4
    s_mov_b32 s13, 0
    s_add_u32 s50, s51, 14336
    s_lshl_b32 s36, s21, 3
    s_add_u32 s36, s36, s22
    s_mul_i32 s36, s36, 81920
    s_add_u32 s36, s36, 0x600000
    s_add_u32 s24, s4, s36
    s_addc_u32 s25, s5, 0
    s_mov_b32 s26, 81920
    s_lshl_b32 s58, s23, 10
    s_lshr_b32 s52, s52, 2
    s_sub_u32 s52, s52, s58
    s_lshr_b32 s53, s53, 2
    s_sub_u32 s53, s53, s58
    s_lshr_b32 s54, s54, 2
    s_sub_u32 s54, s54, s58
    s_lshr_b32 s55, s55, 2
    s_sub_u32 s55, s55, s58
    s_lshr_b32 s56, s56, 2
    s_sub_u32 s56, s56, s58
    s_mov_b32 s27, 0x20000
    s_add_u32 s28, s4, 0x500000
    s_addc_u32 s29, s5, 0
    s_mov_b32 s30, 0x10000
    s_mov_b32 s31, 0x20000
    s_lshl_b32 s36, s21, 10
    s_add_u32 s36, s36, 0x1a24000
    s_add_u32 s68, s4, s36
    s_addc_u32 s69, s5, 0
    s_mov_b32 s70, 512
    s_mov_b32 s71, 0x20000
    s_add_u32 s36, s22, 1
    s_mul_i32 s7, s36, 319488
    s_mov_b32 s6, 8192
    v_and_b32 v238, 15, v0
    v_lshrrev_b32 v239, 4, v0
    s_sub_u32 s36, s32, s20
    s_mul_i32 s36, s36, 10
    s_lshl_b32 s38, s20, 4
    v_add_u32 v3, s38, v238
    v_add_u32 v2, s36, v3
    v_lshlrev_b32 v2, 8, v2
    v_lshl_add_u32 v2, v239, 4, v2
    v_cmp_gt_u32 vcc, 40, v3
    v_mov_b32 v240, 0x10000000
    s_nop 0
    v_cndmask_b32 v240, v240, v2, vcc
    v_mov_b32 v242, 0
    v_mov_b32 v243, 0
    v_mov_b32 v244, 0
    v_mov_b32 v245, 0
    v_mov_b32 v246, 0
    s_mov_b32 s16, 0x00ffffff
    s_mov_b32 s17, 0x070c030c
    s_mov_b32 s18, 0x10001000
    s_mov_b32 s19, 0x05040100
    s_mov_b32 s23, 0x07060302
    buffer_load_dwordx4 v[248:251], v233, s[96:99], 0 offen sc1
    s_waitcnt vmcnt(0)
    v_xor_b32 v248, s34, v248
    v_xor_b32 v249, s34, v249
    v_xor_b32 v250, s34, v250
    v_xor_b32 v251, s34, v251
    v_or_b32 v248, v248, v249
    v_or3_b32 v248, v248, v250, v251
    v_cmp_lt_u32 vcc, 7, v248
    s_cmp_lg_u64 vcc, 0
    s_cbranch_scc1 L_km_rdys
L_km_rdyes:
    s_add_u32 s96, s4, 0x520000
    s_addc_u32 s97, s5, 0
    s_mov_b32 s98, 0x40000
    s_mov_b32 s99, 0x20000
    s_lshl_b32 s38, s32, 2
    v_lshlrev_b32 v233, 12, v0
    buffer_load_dword v247, v233, s[96:99], s38 offen
    s_waitcnt vmcnt(0)
    s_barrier
    v_mul_u32_u24 v233, 2500, v0
    v_and_b32 v2, 0xffff, v247
    v_lshrrev_b32 v247, 16, v247
    v_add_lshl_u32 v233, v233, v2, 2
    buffer_load_dwordx4 a[240:243], v233, s[64:67], 0 offen offset:0
    buffer_load_dwordx4 a[244:247], v233, s[64:67], 0 offen offset:16
    buffer_load_dwordx4 a[248:251], v233, s[64:67], 0 offen offset:32
    buffer_load_dwordx4 a[252:255], v233, s[64:67], 0 offen offset:48
    s_mov_b32 s45, s49
    s_mov_b32 s42, 24576
    s_add_u32 s47, s46, s42
    s_mov_b32 m0, s47
    s_nop 0
    buffer_load_dwordx4 v232, s[8:11], s45 offen offset:0 lds
    buffer_load_dwordx4 v232, s[8:11], s45 offen offset:1024 lds
    buffer_load_dwordx4 v232, s[8:11], s45 offen offset:2048 lds
    buffer_load_dwordx4 v232, s[8:11], s45 offen offset:3072 lds
    s_add_u32 s45, s45, 4096
    s_add_u32 m0, m0, 4096
    s_nop 0
    buffer_load_dwordx4 v232, s[8:11], s45 offen offset:0 lds
    buffer_load_dwordx4 v232, s[8:11], s45 offen offset:1024 lds
    s_add_u32 s45, s45, 20480
    s_add_u32 s50, s51, 0
    s_add_u32 m0, s50, 90112
    s_nop 0
    buffer_load_dwordx4 v1, s[28:31], s50 offen offset:0 lds
    buffer_load_dwordx4 v1, s[28:31], s50 offen offset:1024 lds
    buffer_load_dwordx4 v1, s[28:31], s50 offen offset:2048 lds
    buffer_load_dwordx4 v1, s[28:31], s50 offen offset:3072 lds
    s_add_u32 s50, s51, 4096
    s_add_u32 m0, s50, 90112
    s_nop 0
    buffer_load_dwordx4 v1, s[28:31], s50 offen offset:0 lds
    buffer_load_dwordx4 v1, s[28:31], s50 offen offset:1024 lds
    buffer_load_dwordx4 v1, s[28:31], s50 offen offset:2048 lds
    buffer_load_dwordx4 v1, s[28:31], s50 offen offset:3072 lds
    s_add_u32 s50, s51, 8192
    s_add_u32 m0, s50, 90112
    s_nop 0
    buffer_load_dwordx4 v1, s[28:31], s50 offen offset:0 lds
    buffer_load_dwordx4 v1, s[28:31], s50 offen offset:1024 lds
    buffer_load_dwordx4 v1, s[28:31], s50 offen offset:2048 lds
    buffer_load_dwordx4 v1, s[28:31], s50 offen offset:3072 lds
    s_add_u32 s50, s51, 12288
    s_add_u32 m0, s50, 90112
    s_nop 0
    buffer_load_dwordx4 v1, s[28:31], s50 offen offset:0 lds
    buffer_load_dwordx4 v1, s[28:31], s50 offen offset:1024 lds
    buffer_load_dwordx4 v1, s[28:31], s50 offen offset:2048 lds
    buffer_load_dwordx4 v1, s[28:31], s50 offen offset:3072 lds
    s_mov_b32 s13, 2
    s_branch L_k2_local
L_k2_slow_back:
    s_waitcnt vmcnt(0) lgkmcnt(0)
    s_barrier
    s_cmp_ge_u32 s33, 625
    s_cbranch_scc1 L_k2_idle_tail
    s_lshl_b32 s40, s20, 13
    s_add_u32 s40, s40, 32768
    v_and_b32 v4, 15, v0
    v_lshrrev_b32 v5, 4, v0
    v_lshrrev_b32 v10, 3, v4
    v_and_b32 v11, 7, v4
    v_lshlrev_b32 v11, 1, v11
    v_or_b32 v6, v11, v10
    v_lshlrev_b32 v10, 3, v10
    v_xor_b32 v6, v6, v10
    v_xor_b32 v6, v6, v5
    v_xor_b32 v7, 0, v6
    v_lshlrev_b32 v7, 4, v7
    v_lshl_add_u32 v220, v4, 8, v7
    v_add_u32 v220, s40, v220
    v_xor_b32 v7, 4, v6
    v_lshlrev_b32 v7, 4, v7
    v_lshl_add_u32 v221, v4, 8, v7
    v_add_u32 v221, s40, v221
    v_xor_b32 v7, 8, v6
    v_lshlrev_b32 v7, 4, v7
    v_lshl_add_u32 v222, v4, 8, v7
    v_add_u32 v222, s40, v222
    v_xor_b32 v7, 12, v6
    v_lshlrev_b32 v7, 4, v7
    v_lshl_add_u32 v223, v4, 8, v7
    v_add_u32 v223, s40, v223
    v_lshrrev_b32 v7, 2, v4
    v_lshl_add_u32 v7, v5, 2, v7
    v_lshrrev_b32 v10, 3, v7
    v_and_b32 v11, 7, v7
    v_lshlrev_b32 v11, 1, v11
    v_or_b32 v6, v11, v10
    v_lshlrev_b32 v10, 3, v10
    v_xor_b32 v6, v6, v10
    v_bfe_u32 v8, v0, 1, 1
    v_xor_b32 v6, v6, v8
    v_and_b32 v8, 1, v0
    v_lshlrev_b32 v8, 3, v8
    v_lshl_add_u32 v8, v7, 8, v8
    v_add_u32 v8, s40, v8
    v_xor_b32 v9, 0, v6
    v_lshl_add_u32 v224, v9, 4, v8
    v_xor_b32 v9, 2, v6
    v_lshl_add_u32 v225, v9, 4, v8
    v_xor_b32 v9, 4, v6
    v_lshl_add_u32 v226, v9, 4, v8
    v_xor_b32 v9, 6, v6
    v_lshl_add_u32 v227, v9, 4, v8
    v_xor_b32 v9, 8, v6
    v_lshl_add_u32 v228, v9, 4, v8
    v_xor_b32 v9, 10, v6
    v_lshl_add_u32 v229, v9, 4, v8
    v_xor_b32 v9, 12, v6
    v_lshl_add_u32 v230, v9, 4, v8
    v_xor_b32 v9, 14, v6
    v_lshl_add_u32 v231, v9, 4, v8
    v_mov_b32 v242, 0xff800000
    v_mov_b32 v243, 0xff800000
    v_mov_b32 v244, 0xff800000
    v_mov_b32 v245, 0xff800000
    v_mov_b32 v246, 0xff800000
    s_mov_b32 s41, 0
L_k2_s1:
    s_add_u32 m0, s40, 0
    s_add_u32 s38, s41, 0
    buffer_load_dwordx4 v1, s[8:11], s38 offen offset:0 lds
    buffer_load_dwordx4 v1, s[8:11], s38 offen offset:1024 lds
    buffer_load_dwordx4 v1, s[8:11], s38 offen offset:2048 lds
    buffer_load_dwordx4 v1, s[8:11], s38 offen offset:3072 lds
    s_add_u32 m0, s40, 4096
    s_add_u32 s38, s41, 4096
    buffer_load_dwordx4 v1, s[8:11], s38 offen offset:0 lds
    buffer_load_dwordx4 v1, s[8:11], s38 offen offset:1024 lds
    buffer_load_dwordx4 v1, s[8:11], s38 offen offset:2048 lds
    buffer_load_dwordx4 v1, s[8:11], s38 offen offset:3072 lds
    s_waitcnt vmcnt(0)
    ds_read_b128 v[164:167], v220 offset:0
    ds_read_b128 v[168:171], v221 offset:0
    ds_read_b128 v[172:175], v222 offset:0
    ds_read_b128 v[176:179], v223 offset:0
    ds_read_b128 v[180:183], v220 offset:4096
    ds_read_b128 v[184:187], v221 offset:4096
    ds_read_b128 v[188:191], v222 offset:4096
    ds_read_b128 v[192:195], v223 offset:4096
    s_waitcnt lgkmcnt(0)
    v_mfma_f32_16x16x32_bf16 v[4:7], v[164:167], a[160:163], 0
    v_mfma_f32_16x16x32_bf16 v[4:7], v[168:171], a[164:167], v[4:7]
    v_mfma_f32_16x16x32_bf16 v[4:7], v[172:175], a[168:171], v[4:7]
    v_mfma_f32_16x16x32_bf16 v[4:7], v[176:179], a[172:175], v[4:7]
    v_mfma_f32_16x16x32_bf16 v[8:11], v[164:167], a[176:179], 0
    v_mfma_f32_16x16x32_bf16 v[8:11], v[168:171], a[180:183], v[8:11]
    v_mfma_f32_16x16x32_bf16 v[8:11], v[172:175], a[184:187], v[8:11]
    v_mfma_f32_16x16x32_bf16 v[8:11], v[176:179], a[188:191], v[8:11]
    v_mfma_f32_16x16x32_bf16 v[12:15], v[164:167], a[192:195], 0
    v_mfma_f32_16x16x32_bf16 v[12:15], v[168:171], a[196:199], v[12:15]
    v_mfma_f32_16x16x32_bf16 v[12:15], v[172:175], a[200:203], v[12:15]
    v_mfma_f32_16x16x32_bf16 v[12:15], v[176:179], a[204:207], v[12:15]
    v_mfma_f32_16x16x32_bf16 v[16:19], v[164:167], a[208:211], 0
    v_mfma_f32_16x16x32_bf16 v[16:19], v[168:171], a[212:215], v[16:19]
    v_mfma_f32_16x16x32_bf16 v[16:19], v[172:175], a[216:219], v[16:19]
    v_mfma_f32_16x16x32_bf16 v[16:19], v[176:179], a[220:223], v[16:19]
    v_mfma_f32_16x16x32_bf16 v[20:23], v[164:167], a[224:227], 0
    v_mfma_f32_16x16x32_bf16 v[20:23], v[168:171], a[228:231], v[20:23]
    v_mfma_f32_16x16x32_bf16 v[20:23], v[172:175], a[232:235], v[20:23]
    v_mfma_f32_16x16x32_bf16 v[20:23], v[176:179], a[236:239], v[20:23]
    v_mfma_f32_16x16x32_bf16 v[24:27], v[180:183], a[160:163], 0
    v_mfma_f32_16x16x32_bf16 v[24:27], v[184:187], a[164:167], v[24:27]
    v_mfma_f32_16x16x32_bf16 v[24:27], v[188:191], a[168:171], v[24:27]
    v_mfma_f32_16x16x32_bf16 v[24:27], v[192:195], a[172:175], v[24:27]
    v_mfma_f32_16x16x32_bf16 v[28:31], v[180:183], a[176:179], 0
    v_mfma_f32_16x16x32_bf16 v[28:31], v[184:187], a[180:183], v[28:31]
    v_mfma_f32_16x16x32_bf16 v[28:31], v[188:191], a[184:187], v[28:31]
    v_mfma_f32_16x16x32_bf16 v[28:31], v[192:195], a[188:191], v[28:31]
    v_mfma_f32_16x16x32_bf16 v[32:35], v[180:183], a[192:195], 0
    v_mfma_f32_16x16x32_bf16 v[32:35], v[184:187], a[196:199], v[32:35]
    v_mfma_f32_16x16x32_bf16 v[32:35], v[188:191], a[200:203], v[32:35]
    v_mfma_f32_16x16x32_bf16 v[32:35], v[192:195], a[204:207], v[32:35]
    v_mfma_f32_16x16x32_bf16 v[36:39], v[180:183], a[208:211], 0
    v_mfma_f32_16x16x32_bf16 v[36:39], v[184:187], a[212:215], v[36:39]
    v_mfma_f32_16x16x32_bf16 v[36:39], v[188:191], a[216:219], v[36:39]
    v_mfma_f32_16x16x32_bf16 v[36:39], v[192:195], a[220:223], v[36:39]
    v_mfma_f32_16x16x32_bf16 v[40:43], v[180:183], a[224:227], 0
    v_mfma_f32_16x16x32_bf16 v[40:43], v[184:187], a[228:231], v[40:43]
    v_mfma_f32_16x16x32_bf16 v[40:43], v[188:191], a[232:235], v[40:43]
    v_mfma_f32_16x16x32_bf16 v[40:43], v[192:195], a[236:239], v[40:43]
    s_nop 7
    v_max3_f32 v242, v242, v4, v5
    v_max3_f32 v242, v242, v6, v7
    v_max3_f32 v243, v243, v8, v9
    v_max3_f32 v243, v243, v10, v11
    v_max3_f32 v244, v244, v12, v13
    v_max3_f32 v244, v244, v14, v15
    v_max3_f32 v245, v245, v16, v17
    v_max3_f32 v245, v245, v18, v19
    v_max3_f32 v246, v246, v20, v21
    v_max3_f32 v246, v246, v22, v23
    s_cmp_ge_u32 s41, 2555904
    s_cbranch_scc1 L_k2_s1_done
    v_max3_f32 v242, v242, v24, v25
    v_max3_f32 v242, v242, v26, v27
    v_max3_f32 v243, v243, v28, v29
    v_max3_f32 v243, v243, v30, v31
    v_max3_f32 v244, v244, v32, v33
    v_max3_f32 v244, v244, v34, v35
    v_max3_f32 v245, v245, v36, v37
    v_max3_f32 v245, v245, v38, v39
    v_max3_f32 v246, v246, v40, v41
    v_max3_f32 v246, v246, v42, v43
    s_add_u32 s41, s41, 8192
    s_branch L_k2_s1
L_k2_s1_done:
    v_mov_b32 v3, v242
    s_nop 1
    v_permlane32_swap_b32 v242, v3
    v_max_f32 v242, v242, v3
    v_mov_b32 v3, v242
    s_nop 1
    v_permlane16_swap_b32 v242, v3
    v_max_f32 v242, v242, v3
    v_mov_b32 v3, v243
    s_nop 1
    v_permlane32_swap_b32 v243, v3
    v_max_f32 v243, v243, v3
    v_mov_b32 v3, v243
    s_nop 1
    v_permlane16_swap_b32 v243, v3
    v_max_f32 v243, v243, v3
    v_mov_b32 v3, v244
    s_nop 1
    v_permlane32_swap_b32 v244, v3
    v_max_f32 v244, v244, v3
    v_mov_b32 v3, v244
    s_nop 1
    v_permlane16_swap_b32 v244, v3
    v_max_f32 v244, v244, v3
    v_mov_b32 v3, v245
    s_nop 1
    v_permlane32_swap_b32 v245, v3
    v_max_f32 v245, v245, v3
    v_mov_b32 v3, v245
    s_nop 1
    v_permlane16_swap_b32 v245, v3
    v_max_f32 v245, v245, v3
    v_mov_b32 v3, v246
    s_nop 1
    v_permlane32_swap_b32 v246, v3
    v_max_f32 v246, v246, v3
    v_mov_b32 v3, v246
    s_nop 1
    v_permlane16_swap_b32 v246, v3
    v_max_f32 v246, v246, v3
    s_mul_i32 s41, s22, 319488
    s_add_u32 s50, s41, 319488
L_k2_s2:
    s_add_u32 m0, s40, 0
    s_add_u32 s38, s41, 0
    buffer_load_dwordx4 v1, s[8:11], s38 offen offset:0 lds
    buffer_load_dwordx4 v1, s[8:11], s38 offen offset:1024 lds
    buffer_load_dwordx4 v1, s[8:11], s38 offen offset:2048 lds
    buffer_load_dwordx4 v1, s[8:11], s38 offen offset:3072 lds
    s_add_u32 m0, s40, 4096
    s_add_u32 s38, s41, 4096
    buffer_load_dwordx4 v1, s[8:11], s38 offen offset:0 lds
    buffer_load_dwordx4 v1, s[8:11], s38 offen offset:1024 lds
    buffer_load_dwordx4 v1, s[8:11], s38 offen offset:2048 lds
    buffer_load_dwordx4 v1, s[8:11], s38 offen offset:3072 lds
    s_waitcnt vmcnt(0)
    ds_read_b128 v[164:167], v220 offset:0
    ds_read_b128 v[168:171], v221 offset:0
    ds_read_b128 v[172:175], v222 offset:0
    ds_read_b128 v[176:179], v223 offset:0
    ds_read_b128 v[180:183], v220 offset:4096
    ds_read_b128 v[184:187], v221 offset:4096
    ds_read_b128 v[188:191], v222 offset:4096
    ds_read_b128 v[192:195], v223 offset:4096
    s_waitcnt lgkmcnt(0)
    v_mfma_f32_16x16x32_bf16 v[4:7], v[164:167], a[160:163], 0
    v_mfma_f32_16x16x32_bf16 v[4:7], v[168:171], a[164:167], v[4:7]
    v_mfma_f32_16x16x32_bf16 v[4:7], v[172:175], a[168:171], v[4:7]
    v_mfma_f32_16x16x32_bf16 v[4:7], v[176:179], a[172:175], v[4:7]
    v_mfma_f32_16x16x32_bf16 v[8:11], v[164:167], a[176:179], 0
    v_mfma_f32_16x16x32_bf16 v[8:11], v[168:171], a[180:183], v[8:11]
    v_mfma_f32_16x16x32_bf16 v[8:11], v[172:175], a[184:187], v[8:11]
    v_mfma_f32_16x16x32_bf16 v[8:11], v[176:179], a[188:191], v[8:11]
    v_mfma_f32_16x16x32_bf16 v[12:15], v[164:167], a[192:195], 0
    v_mfma_f32_16x16x32_bf16 v[12:15], v[168:171], a[196:199], v[12:15]
    v_mfma_f32_16x16x32_bf16 v[12:15], v[172:175], a[200:203], v[12:15]
    v_mfma_f32_16x16x32_bf16 v[12:15], v[176:179], a[204:207], v[12:15]
    v_mfma_f32_16x16x32_bf16 v[16:19], v[164:167], a[208:211], 0
    v_mfma_f32_16x16x32_bf16 v[16:19], v[168:171], a[212:215], v[16:19]
    v_mfma_f32_16x16x32_bf16 v[16:19], v[172:175], a[216:219], v[16:19]
    v_mfma_f32_16x16x32_bf16 v[16:19], v[176:179], a[220:223], v[16:19]
    v_mfma_f32_16x16x32_bf16 v[20:23], v[164:167], a[224:227], 0
    v_mfma_f32_16x16x32_bf16 v[20:23], v[168:171], a[228:231], v[20:23]
    v_mfma_f32_16x16x32_bf16 v[20:23], v[172:175], a[232:235], v[20:23]
    v_mfma_f32_16x16x32_bf16 v[20:23], v[176:179], a[236:239], v[20:23]
    v_mfma_f32_16x16x32_bf16 v[24:27], v[180:183], a[160:163], 0
    v_mfma_f32_16x16x32_bf16 v[24:27], v[184:187], a[164:167], v[24:27]
    v_mfma_f32_16x16x32_bf16 v[24:27], v[188:191], a[168:171], v[24:27]
    v_mfma_f32_16x16x32_bf16 v[24:27], v[192:195], a[172:175], v[24:27]
    v_mfma_f32_16x16x32_bf16 v[28:31], v[180:183], a[176:179], 0
    v_mfma_f32_16x16x32_bf16 v[28:31], v[184:187], a[180:183], v[28:31]
    v_mfma_f32_16x16x32_bf16 v[28:31], v[188:191], a[184:187], v[28:31]
    v_mfma_f32_16x16x32_bf16 v[28:31], v[192:195], a[188:191], v[28:31]
    v_mfma_f32_16x16x32_bf16 v[32:35], v[180:183], a[192:195], 0
    v_mfma_f32_16x16x32_bf16 v[32:35], v[184:187], a[196:199], v[32:35]
    v_mfma_f32_16x16x32_bf16 v[32:35], v[188:191], a[200:203], v[32:35]
    v_mfma_f32_16x16x32_bf16 v[32:35], v[192:195], a[204:207], v[32:35]
    v_mfma_f32_16x16x32_bf16 v[36:39], v[180:183], a[208:211], 0
    v_mfma_f32_16x16x32_bf16 v[36:39], v[184:187], a[212:215], v[36:39]
    v_mfma_f32_16x16x32_bf16 v[36:39], v[188:191], a[216:219], v[36:39]
    v_mfma_f32_16x16x32_bf16 v[36:39], v[192:195], a[220:223], v[36:39]
    v_mfma_f32_16x16x32_bf16 v[40:43], v[180:183], a[224:227], 0
    v_mfma_f32_16x16x32_bf16 v[40:43], v[184:187], a[228:231], v[40:43]
    v_mfma_f32_16x16x32_bf16 v[40:43], v[188:191], a[232:235], v[40:43]
    v_mfma_f32_16x16x32_bf16 v[40:43], v[192:195], a[236:239], v[40:43]
    s_nop 7
    v_sub_f32 v4, v4, v242
    v_sub_f32 v5, v5, v242
    v_sub_f32 v6, v6, v242
    v_sub_f32 v7, v7, v242
    v_exp_f32 v4, v4
    v_exp_f32 v5, v5
    v_exp_f32 v6, v6
    v_exp_f32 v7, v7
    v_cvt_pk_bf16_f32 v44, v4, v5
    v_cvt_pk_bf16_f32 v45, v6, v7
    v_sub_f32 v8, v8, v243
    v_sub_f32 v9, v9, v243
    v_sub_f32 v10, v10, v243
    v_sub_f32 v11, v11, v243
    v_exp_f32 v8, v8
    v_exp_f32 v9, v9
    v_exp_f32 v10, v10
    v_exp_f32 v11, v11
    v_cvt_pk_bf16_f32 v48, v8, v9
    v_cvt_pk_bf16_f32 v49, v10, v11
    v_sub_f32 v12, v12, v244
    v_sub_f32 v13, v13, v244
    v_sub_f32 v14, v14, v244
    v_sub_f32 v15, v15, v244
    v_exp_f32 v12, v12
    v_exp_f32 v13, v13
    v_exp_f32 v14, v14
    v_exp_f32 v15, v15
    v_cvt_pk_bf16_f32 v52, v12, v13
    v_cvt_pk_bf16_f32 v53, v14, v15
    v_sub_f32 v16, v16, v245
    v_sub_f32 v17, v17, v245
    v_sub_f32 v18, v18, v245
    v_sub_f32 v19, v19, v245
    v_exp_f32 v16, v16
    v_exp_f32 v17, v17
    v_exp_f32 v18, v18
    v_exp_f32 v19, v19
    v_cvt_pk_bf16_f32 v56, v16, v17
    v_cvt_pk_bf16_f32 v57, v18, v19
    v_sub_f32 v20, v20, v246
    v_sub_f32 v21, v21, v246
    v_sub_f32 v22, v22, v246
    v_sub_f32 v23, v23, v246
    v_exp_f32 v20, v20
    v_exp_f32 v21, v21
    v_exp_f32 v22, v22
    v_exp_f32 v23, v23
    v_cvt_pk_bf16_f32 v60, v20, v21
    v_cvt_pk_bf16_f32 v61, v22, v23
    v_sub_f32 v24, v24, v242
    v_sub_f32 v25, v25, v242
    v_sub_f32 v26, v26, v242
    v_sub_f32 v27, v27, v242
    v_exp_f32 v24, v24
    v_exp_f32 v25, v25
    v_exp_f32 v26, v26
    v_exp_f32 v27, v27
    v_cvt_pk_bf16_f32 v46, v24, v25
    v_cvt_pk_bf16_f32 v47, v26, v27
    v_sub_f32 v28, v28, v243
    v_sub_f32 v29, v29, v243
    v_sub_f32 v30, v30, v243
    v_sub_f32 v31, v31, v243
    v_exp_f32 v28, v28
    v_exp_f32 v29, v29
    v_exp_f32 v30, v30
    v_exp_f32 v31, v31
    v_cvt_pk_bf16_f32 v50, v28, v29
    v_cvt_pk_bf16_f32 v51, v30, v31
    v_sub_f32 v32, v32, v244
    v_sub_f32 v33, v33, v244
    v_sub_f32 v34, v34, v244
    v_sub_f32 v35, v35, v244
    v_exp_f32 v32, v32
    v_exp_f32 v33, v33
    v_exp_f32 v34, v34
    v_exp_f32 v35, v35
    v_cvt_pk_bf16_f32 v54, v32, v33
    v_cvt_pk_bf16_f32 v55, v34, v35
    v_sub_f32 v36, v36, v245
    v_sub_f32 v37, v37, v245
    v_sub_f32 v38, v38, v245
    v_sub_f32 v39, v39, v245
    v_exp_f32 v36, v36
    v_exp_f32 v37, v37
    v_exp_f32 v38, v38
    v_exp_f32 v39, v39
    v_cvt_pk_bf16_f32 v58, v36, v37
    v_cvt_pk_bf16_f32 v59, v38, v39
    v_sub_f32 v40, v40, v246
    v_sub_f32 v41, v41, v246
    v_sub_f32 v42, v42, v246
    v_sub_f32 v43, v43, v246
    v_exp_f32 v40, v40
    v_exp_f32 v41, v41
    v_exp_f32 v42, v42
    v_exp_f32 v43, v43
    v_cvt_pk_bf16_f32 v62, v40, v41
    v_cvt_pk_bf16_f32 v63, v42, v43
    ds_read_b64_tr_b16 v[76:77], v224
    ds_read_b64_tr_b16 v[78:79], v224 offset:4096
    ds_read_b64_tr_b16 v[80:81], v225
    ds_read_b64_tr_b16 v[82:83], v225 offset:4096
    ds_read_b64_tr_b16 v[84:85], v226
    ds_read_b64_tr_b16 v[86:87], v226 offset:4096
    ds_read_b64_tr_b16 v[88:89], v227
    ds_read_b64_tr_b16 v[90:91], v227 offset:4096
    s_waitcnt lgkmcnt(0)
    ds_read_b64_tr_b16 v[92:93], v228
    ds_read_b64_tr_b16 v[94:95], v228 offset:4096
    ds_read_b64_tr_b16 v[96:97], v229
    ds_read_b64_tr_b16 v[98:99], v229 offset:4096
    ds_read_b64_tr_b16 v[100:101], v230
    ds_read_b64_tr_b16 v[102:103], v230 offset:4096
    ds_read_b64_tr_b16 v[104:105], v231
    ds_read_b64_tr_b16 v[106:107], v231 offset:4096
    s_waitcnt lgkmcnt(0)
    v_mfma_f32_16x16x32_bf16 a[0:3], v[76:79], v[44:47], a[0:3]
    v_mfma_f32_16x16x32_bf16 a[32:35], v[76:79], v[48:51], a[32:35]
    v_mfma_f32_16x16x32_bf16 a[64:67], v[76:79], v[52:55], a[64:67]
    v_mfma_f32_16x16x32_bf16 a[96:99], v[76:79], v[56:59], a[96:99]
    v_mfma_f32_16x16x32_bf16 a[128:131], v[76:79], v[60:63], a[128:131]
    v_mfma_f32_16x16x32_bf16 a[4:7], v[80:83], v[44:47], a[4:7]
    v_mfma_f32_16x16x32_bf16 a[36:39], v[80:83], v[48:51], a[36:39]
    v_mfma_f32_16x16x32_bf16 a[68:71], v[80:83], v[52:55], a[68:71]
    v_mfma_f32_16x16x32_bf16 a[100:103], v[80:83], v[56:59], a[100:103]
    v_mfma_f32_16x16x32_bf16 a[132:135], v[80:83], v[60:63], a[132:135]
    v_mfma_f32_16x16x32_bf16 a[8:11], v[84:87], v[44:47], a[8:11]
    v_mfma_f32_16x16x32_bf16 a[40:43], v[84:87], v[48:51], a[40:43]
    v_mfma_f32_16x16x32_bf16 a[72:75], v[84:87], v[52:55], a[72:75]
    v_mfma_f32_16x16x32_bf16 a[104:107], v[84:87], v[56:59], a[104:107]
    v_mfma_f32_16x16x32_bf16 a[136:139], v[84:87], v[60:63], a[136:139]
    v_mfma_f32_16x16x32_bf16 a[12:15], v[88:91], v[44:47], a[12:15]
    v_mfma_f32_16x16x32_bf16 a[44:47], v[88:91], v[48:51], a[44:47]
    v_mfma_f32_16x16x32_bf16 a[76:79], v[88:91], v[52:55], a[76:79]
    v_mfma_f32_16x16x32_bf16 a[108:111], v[88:91], v[56:59], a[108:111]
    v_mfma_f32_16x16x32_bf16 a[140:143], v[88:91], v[60:63], a[140:143]
    v_mfma_f32_16x16x32_bf16 a[16:19], v[92:95], v[44:47], a[16:19]
    v_mfma_f32_16x16x32_bf16 a[48:51], v[92:95], v[48:51], a[48:51]
    v_mfma_f32_16x16x32_bf16 a[80:83], v[92:95], v[52:55], a[80:83]
    v_mfma_f32_16x16x32_bf16 a[112:115], v[92:95], v[56:59], a[112:115]
    v_mfma_f32_16x16x32_bf16 a[144:147], v[92:95], v[60:63], a[144:147]
    v_mfma_f32_16x16x32_bf16 a[20:23], v[96:99], v[44:47], a[20:23]
    v_mfma_f32_16x16x32_bf16 a[52:55], v[96:99], v[48:51], a[52:55]
    v_mfma_f32_16x16x32_bf16 a[84:87], v[96:99], v[52:55], a[84:87]
    v_mfma_f32_16x16x32_bf16 a[116:119], v[96:99], v[56:59], a[116:119]
    v_mfma_f32_16x16x32_bf16 a[148:151], v[96:99], v[60:63], a[148:151]
    v_mfma_f32_16x16x32_bf16 a[24:27], v[100:103], v[44:47], a[24:27]
    v_mfma_f32_16x16x32_bf16 a[56:59], v[100:103], v[48:51], a[56:59]
    v_mfma_f32_16x16x32_bf16 a[88:91], v[100:103], v[52:55], a[88:91]
    v_mfma_f32_16x16x32_bf16 a[120:123], v[100:103], v[56:59], a[120:123]
    v_mfma_f32_16x16x32_bf16 a[152:155], v[100:103], v[60:63], a[152:155]
    v_mfma_f32_16x16x32_bf16 a[28:31], v[104:107], v[44:47], a[28:31]
    v_mfma_f32_16x16x32_bf16 a[60:63], v[104:107], v[48:51], a[60:63]
    v_mfma_f32_16x16x32_bf16 a[92:95], v[104:107], v[52:55], a[92:95]
    v_mfma_f32_16x16x32_bf16 a[124:127], v[104:107], v[56:59], a[124:127]
    v_mfma_f32_16x16x32_bf16 a[156:159], v[104:107], v[60:63], a[156:159]
    s_add_u32 s41, s41, 8192
    s_cmp_lt_u32 s41, s50
    s_cbranch_scc1 L_k2_s2
    s_mov_b32 s40, 0
    v_and_b32 v4, 15, v0
    v_lshrrev_b32 v5, 4, v0
    v_lshrrev_b32 v10, 3, v4
    v_and_b32 v11, 7, v4
    v_lshlrev_b32 v11, 1, v11
    v_or_b32 v6, v11, v10
    v_lshlrev_b32 v10, 3, v10
    v_xor_b32 v6, v6, v10
    v_xor_b32 v6, v6, v5
    v_xor_b32 v7, 0, v6
    v_lshlrev_b32 v7, 4, v7
    v_lshl_add_u32 v220, v4, 8, v7
    v_add_u32 v220, s40, v220
    v_xor_b32 v7, 4, v6
    v_lshlrev_b32 v7, 4, v7
    v_lshl_add_u32 v221, v4, 8, v7
    v_add_u32 v221, s40, v221
    v_xor_b32 v7, 8, v6
    v_lshlrev_b32 v7, 4, v7
    v_lshl_add_u32 v222, v4, 8, v7
    v_add_u32 v222, s40, v222
    v_xor_b32 v7, 12, v6
    v_lshlrev_b32 v7, 4, v7
    v_lshl_add_u32 v223, v4, 8, v7
    v_add_u32 v223, s40, v223
    v_lshrrev_b32 v7, 2, v4
    v_lshl_add_u32 v7, v5, 2, v7
    v_lshrrev_b32 v10, 3, v7
    v_and_b32 v11, 7, v7
    v_lshlrev_b32 v11, 1, v11
    v_or_b32 v6, v11, v10
    v_lshlrev_b32 v10, 3, v10
    v_xor_b32 v6, v6, v10
    v_bfe_u32 v8, v0, 1, 1
    v_xor_b32 v6, v6, v8
    v_and_b32 v8, 1, v0
    v_lshlrev_b32 v8, 3, v8
    v_lshl_add_u32 v8, v7, 8, v8
    v_add_u32 v8, s40, v8
    v_xor_b32 v9, 0, v6
    v_lshl_add_u32 v224, v9, 4, v8
    v_xor_b32 v9, 2, v6
    v_lshl_add_u32 v225, v9, 4, v8
    v_xor_b32 v9, 4, v6
    v_lshl_add_u32 v226, v9, 4, v8
    v_xor_b32 v9, 6, v6
    v_lshl_add_u32 v227, v9, 4, v8
    v_xor_b32 v9, 8, v6
    v_lshl_add_u32 v228, v9, 4, v8
    v_xor_b32 v9, 10, v6
    v_lshl_add_u32 v229, v9, 4, v8
    v_xor_b32 v9, 12, v6
    v_lshl_add_u32 v230, v9, 4, v8
    v_xor_b32 v9, 14, v6
    v_lshl_add_u32 v231, v9, 4, v8
    ds_read_b128 v[164:167], v220 offset:24576
    ds_read_b128 v[168:171], v221 offset:24576
    ds_read_b128 v[172:175], v222 offset:24576
    ds_read_b128 v[176:179], v223 offset:24576
    ds_read_b64_tr_b16 v[8:9], v224 offset:24576
    ds_read_b64_tr_b16 v[10:11], v225 offset:24576
    ds_read_b64_tr_b16 v[12:13], v226 offset:24576
    ds_read_b64_tr_b16 v[14:15], v227 offset:24576
    ds_read_b64_tr_b16 v[16:17], v228 offset:24576
    ds_read_b64_tr_b16 v[18:19], v229 offset:24576
    ds_read_b64_tr_b16 v[20:21], v230 offset:24576
    ds_read_b64_tr_b16 v[22:23], v231 offset:24576
    s_waitcnt lgkmcnt(0)
    v_mfma_f32_16x16x32_bf16 v[4:7], v[164:167], a[224:227], 0
    v_mfma_f32_16x16x32_bf16 v[4:7], v[168:171], a[228:231], v[4:7]
    v_mfma_f32_16x16x32_bf16 v[4:7], v[172:175], a[232:235], v[4:7]
    v_mfma_f32_16x16x32_bf16 v[4:7], v[176:179], a[236:239], v[4:7]
    s_cmp_eq_u32 s57, 1
    s_cselect_b32 s38, 0, 0x7f800000
    v_add_f32 v3, s38, v246
    s_nop 4
    v_sub_f32 v4, v4, v3
    v_sub_f32 v5, v5, v3
    v_sub_f32 v6, v6, v3
    v_sub_f32 v7, v7, v3
    v_exp_f32 v4, v4
    v_exp_f32 v5, v5
    v_exp_f32 v6, v6
    v_exp_f32 v7, v7
    s_nop 0
    v_cvt_pk_bf16_f32 v40, v4, v5
    v_cvt_pk_bf16_f32 v41, v6, v7
    s_nop 1
    v_mfma_f32_16x16x16_bf16 a[132:135], v[10:11], v[40:41], a[132:135]
    v_mfma_f32_16x16x16_bf16 a[136:139], v[12:13], v[40:41], a[136:139]
    v_mfma_f32_16x16x16_bf16 a[140:143], v[14:15], v[40:41], a[140:143]
    v_mfma_f32_16x16x16_bf16 a[144:147], v[16:17], v[40:41], a[144:147]
    v_mfma_f32_16x16x16_bf16 a[148:151], v[18:19], v[40:41], a[148:151]
    v_mfma_f32_16x16x16_bf16 a[152:155], v[20:21], v[40:41], a[152:155]
    v_mfma_f32_16x16x16_bf16 a[156:159], v[22:23], v[40:41], a[156:159]
    v_mfma_f32_16x16x16_bf16 a[128:131], v[8:9], v[40:41], a[128:131]
    v_add_u32 v24, 0, v1
    v_add_u32 v25, 20480, v1
    v_add_u32 v26, 40960, v1
    v_add_u32 v27, 61440, v1
    buffer_load_dwordx4 a[160:163], v240, s[72:75], 0 offen offset:0 nt
    buffer_load_dwordx4 a[164:167], v240, s[72:75], 0 offen offset:64 nt
    buffer_load_dwordx4 a[168:171], v240, s[72:75], 0 offen offset:128 nt
    buffer_load_dwordx4 a[172:175], v240, s[72:75], 0 offen offset:192 nt
    v_lshrrev_b32 v2, 8, v240
    v_lshlrev_b32 v2, 1, v2
    buffer_load_ushort v232, v2, s[96:99], 0 offen
    v_lshlrev_b32 v2, 7, v0
    buffer_load_dword v42, v2, s[68:71], 0 offen sc1
    v_accvgpr_read_b32 v108, a0
    v_accvgpr_read_b32 v109, a1
    v_accvgpr_read_b32 v110, a2
    v_accvgpr_read_b32 v111, a3
    v_accvgpr_read_b32 v112, a4
    v_accvgpr_read_b32 v113, a5
    v_accvgpr_read_b32 v114, a6
    v_accvgpr_read_b32 v115, a7
    v_cvt_pk_bf16_f32 v104, v108, v109
    v_cvt_pk_bf16_f32 v105, v110, v111
    v_cvt_pk_bf16_f32 v106, v112, v113
    v_cvt_pk_bf16_f32 v107, v114, v115
    buffer_store_dwordx4 v[104:107], v24, s[24:27], s52 offen
    v_accvgpr_read_b32 v120, a32
    v_accvgpr_read_b32 v121, a33
    v_accvgpr_read_b32 v122, a34
    v_accvgpr_read_b32 v123, a35
    v_accvgpr_read_b32 v124, a36
    v_accvgpr_read_b32 v125, a37
    v_accvgpr_read_b32 v126, a38
    v_accvgpr_read_b32 v127, a39
    v_cvt_pk_bf16_f32 v116, v120, v121
    v_cvt_pk_bf16_f32 v117, v122, v123
    v_cvt_pk_bf16_f32 v118, v124, v125
    v_cvt_pk_bf16_f32 v119, v126, v127
    buffer_store_dwordx4 v[116:119], v24, s[24:27], s53 offen
    v_accvgpr_read_b32 v108, a64
    v_accvgpr_read_b32 v109, a65
    v_accvgpr_read_b32 v110, a66
    v_accvgpr_read_b32 v111, a67
    v_accvgpr_read_b32 v112, a68
    v_accvgpr_read_b32 v113, a69
    v_accvgpr_read_b32 v114, a70
    v_accvgpr_read_b32 v115, a71
    v_cvt_pk_bf16_f32 v104, v108, v109
    v_cvt_pk_bf16_f32 v105, v110, v111
    v_cvt_pk_bf16_f32 v106, v112, v113
    v_cvt_pk_bf16_f32 v107, v114, v115
    buffer_store_dwordx4 v[104:107], v24, s[24:27], s54 offen
    v_accvgpr_read_b32 v120, a96
    v_accvgpr_read_b32 v121, a97
    v_accvgpr_read_b32 v122, a98
    v_accvgpr_read_b32 v123, a99
    v_accvgpr_read_b32 v124, a100
    v_accvgpr_read_b32 v125, a101
    v_accvgpr_read_b32 v126, a102
    v_accvgpr_read_b32 v127, a103
    v_cvt_pk_bf16_f32 v116, v120, v121
    v_cvt_pk_bf16_f32 v117, v122, v123
    v_cvt_pk_bf16_f32 v118, v124, v125
    v_cvt_pk_bf16_f32 v119, v126, v127
    buffer_store_dwordx4 v[116:119], v24, s[24:27], s55 offen
    v_accvgpr_read_b32 v108, a128
    v_accvgpr_read_b32 v109, a129
    v_accvgpr_read_b32 v110, a130
    v_accvgpr_read_b32 v111, a131
    v_accvgpr_read_b32 v112, a132
    v_accvgpr_read_b32 v113, a133
    v_accvgpr_read_b32 v114, a134
    v_accvgpr_read_b32 v115, a135
    v_cvt_pk_bf16_f32 v104, v108, v109
    v_cvt_pk_bf16_f32 v105, v110, v111
    v_cvt_pk_bf16_f32 v106, v112, v113
    v_cvt_pk_bf16_f32 v107, v114, v115
    buffer_store_dwordx4 v[104:107], v24, s[24:27], s56 offen
    v_accvgpr_read_b32 v120, a8
    v_accvgpr_read_b32 v121, a9
    v_accvgpr_read_b32 v122, a10
    v_accvgpr_read_b32 v123, a11
    v_accvgpr_read_b32 v124, a12
    v_accvgpr_read_b32 v125, a13
    v_accvgpr_read_b32 v126, a14
    v_accvgpr_read_b32 v127, a15
    v_cvt_pk_bf16_f32 v116, v120, v121
    v_cvt_pk_bf16_f32 v117, v122, v123
    v_cvt_pk_bf16_f32 v118, v124, v125
    v_cvt_pk_bf16_f32 v119, v126, v127
    buffer_store_dwordx4 v[116:119], v25, s[24:27], s52 offen
    v_accvgpr_read_b32 v108, a40
    v_accvgpr_read_b32 v109, a41
    v_accvgpr_read_b32 v110, a42
    v_accvgpr_read_b32 v111, a43
    v_accvgpr_read_b32 v112, a44
    v_accvgpr_read_b32 v113, a45
    v_accvgpr_read_b32 v114, a46
    v_accvgpr_read_b32 v115, a47
    v_cvt_pk_bf16_f32 v104, v108, v109
    v_cvt_pk_bf16_f32 v105, v110, v111
    v_cvt_pk_bf16_f32 v106, v112, v113
    v_cvt_pk_bf16_f32 v107, v114, v115
    buffer_store_dwordx4 v[104:107], v25, s[24:27], s53 offen
    v_accvgpr_read_b32 v120, a72
    v_accvgpr_read_b32 v121, a73
    v_accvgpr_read_b32 v122, a74
    v_accvgpr_read_b32 v123, a75
    v_accvgpr_read_b32 v124, a76
    v_accvgpr_read_b32 v125, a77
    v_accvgpr_read_b32 v126, a78
    v_accvgpr_read_b32 v127, a79
    v_cvt_pk_bf16_f32 v116, v120, v121
    v_cvt_pk_bf16_f32 v117, v122, v123
    v_cvt_pk_bf16_f32 v118, v124, v125
    v_cvt_pk_bf16_f32 v119, v126, v127
    buffer_store_dwordx4 v[116:119], v25, s[24:27], s54 offen
    v_accvgpr_read_b32 v108, a104
    v_accvgpr_read_b32 v109, a105
    v_accvgpr_read_b32 v110, a106
    v_accvgpr_read_b32 v111, a107
    v_accvgpr_read_b32 v112, a108
    v_accvgpr_read_b32 v113, a109
    v_accvgpr_read_b32 v114, a110
    v_accvgpr_read_b32 v115, a111
    v_cvt_pk_bf16_f32 v104, v108, v109
    v_cvt_pk_bf16_f32 v105, v110, v111
    v_cvt_pk_bf16_f32 v106, v112, v113
    v_cvt_pk_bf16_f32 v107, v114, v115
    buffer_store_dwordx4 v[104:107], v25, s[24:27], s55 offen
    v_accvgpr_read_b32 v120, a136
    v_accvgpr_read_b32 v121, a137
    v_accvgpr_read_b32 v122, a138
    v_accvgpr_read_b32 v123, a139
    v_accvgpr_read_b32 v124, a140
    v_accvgpr_read_b32 v125, a141
    v_accvgpr_read_b32 v126, a142
    v_accvgpr_read_b32 v127, a143
    v_cvt_pk_bf16_f32 v116, v120, v121
    v_cvt_pk_bf16_f32 v117, v122, v123
    v_cvt_pk_bf16_f32 v118, v124, v125
    v_cvt_pk_bf16_f32 v119, v126, v127
    buffer_store_dwordx4 v[116:119], v25, s[24:27], s56 offen
    v_accvgpr_read_b32 v108, a16
    v_accvgpr_read_b32 v109, a17
    v_accvgpr_read_b32 v110, a18
    v_accvgpr_read_b32 v111, a19
    v_accvgpr_read_b32 v112, a20
    v_accvgpr_read_b32 v113, a21
    v_accvgpr_read_b32 v114, a22
    v_accvgpr_read_b32 v115, a23
    v_cvt_pk_bf16_f32 v104, v108, v109
    v_cvt_pk_bf16_f32 v105, v110, v111
    v_cvt_pk_bf16_f32 v106, v112, v113
    v_cvt_pk_bf16_f32 v107, v114, v115
    buffer_store_dwordx4 v[104:107], v26, s[24:27], s52 offen
    v_accvgpr_read_b32 v120, a48
    v_accvgpr_read_b32 v121, a49
    v_accvgpr_read_b32 v122, a50
    v_accvgpr_read_b32 v123, a51
    v_accvgpr_read_b32 v124, a52
    v_accvgpr_read_b32 v125, a53
    v_accvgpr_read_b32 v126, a54
    v_accvgpr_read_b32 v127, a55
    v_cvt_pk_bf16_f32 v116, v120, v121
    v_cvt_pk_bf16_f32 v117, v122, v123
    v_cvt_pk_bf16_f32 v118, v124, v125
    v_cvt_pk_bf16_f32 v119, v126, v127
    buffer_store_dwordx4 v[116:119], v26, s[24:27], s53 offen
    v_accvgpr_read_b32 v108, a80
    v_accvgpr_read_b32 v109, a81
    v_accvgpr_read_b32 v110, a82
    v_accvgpr_read_b32 v111, a83
    v_accvgpr_read_b32 v112, a84
    v_accvgpr_read_b32 v113, a85
    v_accvgpr_read_b32 v114, a86
    v_accvgpr_read_b32 v115, a87
    v_cvt_pk_bf16_f32 v104, v108, v109
    v_cvt_pk_bf16_f32 v105, v110, v111
    v_cvt_pk_bf16_f32 v106, v112, v113
    v_cvt_pk_bf16_f32 v107, v114, v115
    buffer_store_dwordx4 v[104:107], v26, s[24:27], s54 offen
    v_accvgpr_read_b32 v120, a112
    v_accvgpr_read_b32 v121, a113
    v_accvgpr_read_b32 v122, a114
    v_accvgpr_read_b32 v123, a115
    v_accvgpr_read_b32 v124, a116
    v_accvgpr_read_b32 v125, a117
    v_accvgpr_read_b32 v126, a118
    v_accvgpr_read_b32 v127, a119
    v_cvt_pk_bf16_f32 v116, v120, v121
    v_cvt_pk_bf16_f32 v117, v122, v123
    v_cvt_pk_bf16_f32 v118, v124, v125
    v_cvt_pk_bf16_f32 v119, v126, v127
    buffer_store_dwordx4 v[116:119], v26, s[24:27], s55 offen
    v_accvgpr_read_b32 v108, a144
    v_accvgpr_read_b32 v109, a145
    v_accvgpr_read_b32 v110, a146
    v_accvgpr_read_b32 v111, a147
    v_accvgpr_read_b32 v112, a148
    v_accvgpr_read_b32 v113, a149
    v_accvgpr_read_b32 v114, a150
    v_accvgpr_read_b32 v115, a151
    v_cvt_pk_bf16_f32 v104, v108, v109
    v_cvt_pk_bf16_f32 v105, v110, v111
    v_cvt_pk_bf16_f32 v106, v112, v113
    v_cvt_pk_bf16_f32 v107, v114, v115
    buffer_store_dwordx4 v[104:107], v26, s[24:27], s56 offen
    v_accvgpr_read_b32 v120, a24
    v_accvgpr_read_b32 v121, a25
    v_accvgpr_read_b32 v122, a26
    v_accvgpr_read_b32 v123, a27
    v_accvgpr_read_b32 v124, a28
    v_accvgpr_read_b32 v125, a29
    v_accvgpr_read_b32 v126, a30
    v_accvgpr_read_b32 v127, a31
    v_cvt_pk_bf16_f32 v116, v120, v121
    v_cvt_pk_bf16_f32 v117, v122, v123
    v_cvt_pk_bf16_f32 v118, v124, v125
    v_cvt_pk_bf16_f32 v119, v126, v127
    buffer_store_dwordx4 v[116:119], v27, s[24:27], s52 offen
    v_accvgpr_read_b32 v108, a56
    v_accvgpr_read_b32 v109, a57
    v_accvgpr_read_b32 v110, a58
    v_accvgpr_read_b32 v111, a59
    v_accvgpr_read_b32 v112, a60
    v_accvgpr_read_b32 v113, a61
    v_accvgpr_read_b32 v114, a62
    v_accvgpr_read_b32 v115, a63
    v_cvt_pk_bf16_f32 v104, v108, v109
    v_cvt_pk_bf16_f32 v105, v110, v111
    v_cvt_pk_bf16_f32 v106, v112, v113
    v_cvt_pk_bf16_f32 v107, v114, v115
    buffer_store_dwordx4 v[104:107], v27, s[24:27], s53 offen
    v_accvgpr_read_b32 v120, a88
    v_accvgpr_read_b32 v121, a89
    v_accvgpr_read_b32 v122, a90
    v_accvgpr_read_b32 v123, a91
    v_accvgpr_read_b32 v124, a92
    v_accvgpr_read_b32 v125, a93
    v_accvgpr_read_b32 v126, a94
    v_accvgpr_read_b32 v127, a95
    v_cvt_pk_bf16_f32 v116, v120, v121
    v_cvt_pk_bf16_f32 v117, v122, v123
    v_cvt_pk_bf16_f32 v118, v124, v125
    v_cvt_pk_bf16_f32 v119, v126, v127
    buffer_store_dwordx4 v[116:119], v27, s[24:27], s54 offen
    v_accvgpr_read_b32 v108, a120
    v_accvgpr_read_b32 v109, a121
    v_accvgpr_read_b32 v110, a122
    v_accvgpr_read_b32 v111, a123
    v_accvgpr_read_b32 v112, a124
    v_accvgpr_read_b32 v113, a125
    v_accvgpr_read_b32 v114, a126
    v_accvgpr_read_b32 v115, a127
    v_cvt_pk_bf16_f32 v104, v108, v109
    v_cvt_pk_bf16_f32 v105, v110, v111
    v_cvt_pk_bf16_f32 v106, v112, v113
    v_cvt_pk_bf16_f32 v107, v114, v115
    buffer_store_dwordx4 v[104:107], v27, s[24:27], s55 offen
    v_accvgpr_read_b32 v120, a152
    v_accvgpr_read_b32 v121, a153
    v_accvgpr_read_b32 v122, a154
    v_accvgpr_read_b32 v123, a155
    v_accvgpr_read_b32 v124, a156
    v_accvgpr_read_b32 v125, a157
    v_accvgpr_read_b32 v126, a158
    v_accvgpr_read_b32 v127, a159
    v_cvt_pk_bf16_f32 v116, v120, v121
    v_cvt_pk_bf16_f32 v117, v122, v123
    v_cvt_pk_bf16_f32 v118, v124, v125
    v_cvt_pk_bf16_f32 v119, v126, v127
    buffer_store_dwordx4 v[116:119], v27, s[24:27], s56 offen
    s_branch L_k2_tail
L_km_rdyf:
    s_mov_b32 s38, 0
L_km_rdylf:
    s_sleep 4
    buffer_load_dword v248, v249, s[96:99], 0 offen sc1
    s_waitcnt vmcnt(0)
    v_xor_b32 v248, s34, v248
    v_cmp_lt_u32 vcc, 7, v248
    s_cmp_eq_u64 vcc, 0
    s_cbranch_scc1 L_km_rdyef
    s_add_u32 s38, s38, 1
    s_cmp_lt_u32 s38, 262144
    s_cbranch_scc1 L_km_rdylf
    s_branch L_km_rdyef
L_km_rdyi:
    s_mov_b32 s38, 0
L_km_rdyli:
    s_sleep 4
    buffer_load_dword v248, v249, s[96:99], 0 offen sc1
    s_waitcnt vmcnt(0)
    v_xor_b32 v248, s34, v248
    v_cmp_lt_u32 vcc, 7, v248
    s_cmp_eq_u64 vcc, 0
    s_cbranch_scc1 L_km_rdyei
    s_add_u32 s38, s38, 1
    s_cmp_lt_u32 s38, 262144
    s_cbranch_scc1 L_km_rdyli
    s_branch L_km_rdyei
L_km_rdyh:
    s_mov_b32 s38, 0
L_km_rdylh:
    s_sleep 4
    buffer_load_dwordx4 v[248:251], v233, s[96:99], 0 offen sc1
    s_waitcnt vmcnt(0)
    v_xor_b32 v248, s34, v248
    v_xor_b32 v249, s34, v249
    v_xor_b32 v250, s34, v250
    v_xor_b32 v251, s34, v251
    v_or_b32 v248, v248, v249
    v_or3_b32 v248, v248, v250, v251
    v_cmp_lt_u32 vcc, 7, v248
    s_cmp_eq_u64 vcc, 0
    s_cbranch_scc1 L_km_rdyeh
    s_add_u32 s38, s38, 1
    s_cmp_lt_u32 s38, 262144
    s_cbranch_scc1 L_km_rdylh
    s_branch L_km_rdyeh
L_km_rdyj:
    s_mov_b32 s38, 0
L_km_rdylj:
    s_sleep 4
    buffer_load_dwordx4 v[248:251], v233, s[96:99], 0 offen sc1
    s_waitcnt vmcnt(0)
    v_xor_b32 v248, s34, v248
    v_xor_b32 v249, s34, v249
    v_xor_b32 v250, s34, v250
    v_xor_b32 v251, s34, v251
    v_or_b32 v248, v248, v249
    v_or3_b32 v248, v248, v250, v251
    v_cmp_lt_u32 vcc, 7, v248
    s_cmp_eq_u64 vcc, 0
    s_cbranch_scc1 L_km_rdyej
    s_add_u32 s38, s38, 1
    s_cmp_lt_u32 s38, 262144
    s_cbranch_scc1 L_km_rdylj
    s_branch L_km_rdyej
L_km_rdys:
    s_mov_b32 s38, 0
L_km_rdyls:
    s_sleep 4
    buffer_load_dwordx4 v[248:251], v233, s[96:99], 0 offen sc1
    s_waitcnt vmcnt(0)
    v_xor_b32 v248, s34, v248
    v_xor_b32 v249, s34, v249
    v_xor_b32 v250, s34, v250
    v_xor_b32 v251, s34, v251
    v_or_b32 v248, v248, v249
    v_or3_b32 v248, v248, v250, v251
    v_cmp_lt_u32 vcc, 7, v248
    s_cmp_eq_u64 vcc, 0
    s_cbranch_scc1 L_km_rdyes
    s_add_u32 s38, s38, 1
    s_cmp_lt_u32 s38, 262144
    s_cbranch_scc1 L_km_rdyls
    s_branch L_km_rdyes
L_k2_end:
    s_endpgm
.section .rodata,"a"
.p2align 6
.amdhsa_kernel gather_scatter__hybrid_graph_tf_graphgps__graph_kernel
  .amdhsa_next_free_vgpr 512
  .amdhsa_next_free_sgpr 102
  .amdhsa_accum_offset 256
  .amdhsa_group_segment_fixed_size 0
  .amdhsa_kernarg_size 96
  .amdhsa_user_sgpr_count 2
  .amdhsa_user_sgpr_kernarg_segment_ptr 1
  .amdhsa_system_sgpr_workgroup_id_x 1
.end_amdhsa_kernel
```
